```python
import torch

def _softmax(x, axis=-1):
    return torch.softmax(x, dim=axis)
def _gelu(x):
    return torch.nn.functional.gelu(x, approximate="tanh")
def _silu(x):
    return torch.nn.functional.silu(x)
def _sigmoid(x):
    return torch.sigmoid(x)
def _layernorm(x, axis=-1, eps=1e-5):
    m = x.mean(dim=axis, keepdim=True)
    v = x.var(dim=axis, keepdim=True, unbiased=False)
    return (x - m) / torch.sqrt(v + eps)
def _scatter_add(tgt, idx, src, axis=0):
    return tgt.clone().index_add_(axis, idx, src)
def _segment_sum(src, seg, n):
    out = torch.zeros((n,) + src.shape[1:], dtype=src.dtype)
    return out.index_add_(0, seg, src)
def _pad(x, pw):
    flat = tuple(v for pair in reversed(pw) for v in pair)
    return torch.nn.functional.pad(x, flat)

kernel_name = 'sequential_preLN__sliding_block__glu_gated_swiglu__prompt'

def setup_inputs():

    _w = (lambda a: (lambda t: t.to(torch.bfloat16) if t.is_floating_point() else t)(torch.as_tensor(a)))
    def _A_setup():
        B, S, D = 1, 2048, 512
        return {
            "x": _w((lambda *s: torch.randn(*s, dtype=torch.bfloat16) * 0.05)(B, S, D)),
            "wqkv": _w((lambda *s: torch.randn(*s, dtype=torch.bfloat16) * 0.05)(D, 3 * D)),
            "wo": _w((lambda *s: torch.randn(*s, dtype=torch.bfloat16) * 0.05)(D, D)),
        }
    _A_in = _A_setup()

    def _B_setup():
        B, S, D, F = 1, 2048, 512, 1792
        return {
            "x": _w((lambda *s: torch.randn(*s, dtype=torch.bfloat16) * 0.05)(B, S, D)),
            "w1": _w((lambda *s: torch.randn(*s, dtype=torch.bfloat16) * 0.8)(D, F) * (2.0 / D) ** 0.5),
            "w3": _w((lambda *s: torch.randn(*s, dtype=torch.bfloat16) * 0.8)(D, F) * (2.0 / D) ** 0.5),
            "w2": _w((lambda *s: torch.randn(*s, dtype=torch.bfloat16) * 0.8)(F, D) * (2.0 / F) ** 0.5),
        }
    _B_in = _B_setup()

    return {
        "A_x": _A_in["x"],
        "A_wqkv": _A_in["wqkv"],
        "A_wo": _A_in["wo"],
        "B_x": _B_in["x"],
        "B_w1": _B_in["w1"],
        "B_w3": _B_in["w3"],
        "B_w2": _B_in["w2"],
    }

def reference(A_x, A_wqkv, A_wo, B_x, B_w1, B_w3, B_w2):
    def _A_ref(x, wqkv, wo):
        B, S, D = x.shape
        H = 32; Dh = D // H; W = 256
        qkv = (lambda x, *d: x.permute(*d))((x @ wqkv).reshape(B, S, 3, H, Dh), 2, 0, 3, 1, 4)
        q, k, v = qkv[0], qkv[1], qkv[2]
        scores = torch.einsum("bhqd,bhkd->bhqk", q, k) * (Dh ** -0.5)
        idx = torch.arange(S)
        mask = (idx[:, None] - idx[None, :] >= 0) & (idx[:, None] - idx[None, :] < W)
        scores = torch.where(mask[None, None], scores, -1e9)
        p = _softmax(scores, axis=-1)
        o = torch.einsum("bhqk,bhkd->bhqd", p, v)
        return (lambda x, *d: x.permute(*d))(o, 0, 2, 1, 3).reshape(B, S, D) @ wo

    def _B_ref(x, w1, w3, w2):
        gate = torch.einsum("bsd,df->bsf", x, w1)
        up = torch.einsum("bsd,df->bsf", x, w3)
        h = _silu(gate) * up
        out = torch.einsum("bsf,fd->bsd", h, w2)
        return out

    x = A_x
    h = x + _A_ref(_layernorm(x, axis=-1), A_wqkv, A_wo)
    h2 = h + _B_ref(_layernorm(h, axis=-1), B_w1, B_w3, B_w2)
    return h2
```

```asm
; @launch kernel=k1_kernel grid=(256,1,1) block=(512,1,1) lds=145408
; @launch kernel=kf_kernel grid=(256,1,1) block=(512,1,1) lds=156928
.amdgcn_target "amdgcn-amd-amdhsa--gfx950"
.text
.globl k1_kernel
.p2align 8
.type k1_kernel,@function
k1_kernel:
    s_cmp_ge_u32 s2, 256
    s_cbranch_scc1 K1_done
    s_load_dwordx4 s[4:7], s[0:1], 0
    s_load_dwordx2 s[8:9], s[0:1], 72
    s_load_dwordx2 s[48:49], s[0:1], 16
    s_load_dwordx2 s[50:51], s[0:1], 48
    s_load_dwordx4 s[52:55], s[0:1], 32
    s_getpc_b64 s[40:41]
K1_pc0:
    s_cmp_ge_u32 s2, 8
    s_cbranch_scc1 K1_pc1
    v_lshlrev_b32 v4, 7, v0
    v_min_u32 v4, KF_END-K1_pc0-4, v4
    global_load_dword v212, v4, s[40:41]
K1_pc1:
    s_and_b32 s10, s2, 7
    s_lshr_b32 s11, s2, 3
    s_and_b32 s20, s10, 3
    s_lshl_b32 s20, s20, 2
    s_and_b32 s21, s11, 3
    s_add_u32 s20, s20, s21
    s_lshr_b32 s21, s10, 2
    s_lshl_b32 s21, s21, 3
    s_lshr_b32 s22, s11, 2
    s_add_u32 s21, s21, s22
    v_lshrrev_b32 v1, 6, v0
    s_nop 0
    v_readfirstlane_b32 s22, v1
    v_and_b32 v1, 63, v0
    v_and_b32 v2, 15, v1
    v_lshrrev_b32 v3, 4, v1
    v_lshlrev_b32 v4, 3, v3
    v_lshrrev_b32 v5, 2, v2
    v_add_u32 v4, v4, v5
    v_lshlrev_b32 v4, 6, v4
    v_and_b32 v5, 3, v2
    v_lshl_add_u32 v7, v5, 3, v4
    v_and_b32 v6, 1, v3
    v_mov_b32 v22, 0x3f803f80
    v_mov_b32 v23, 0x3f803f80
    v_mov_b32 v24, 0x3f803f80
    v_mov_b32 v25, 0x3f803f80
    s_mul_i32 s47, s10, 1
    s_cmp_lt_u32 s22, 4
    s_cbranch_scc1 J_K1_comp
    s_and_b32 s22, s22, 3
    v_lshrrev_b32 v4, 3, v1
    v_and_b32 v5, 7, v1
    v_xor_b32 v5, v5, v4
    v_lshlrev_b32 v4, 10, v4
    v_lshl_add_u32 v8, v5, 4, v4
    s_lshl_b32 s24, s20, 17
    s_lshl_b32 s23, s22, 15
    s_add_u32 s24, s24, s23
    s_add_u32 s25, s24, 8192
    s_add_u32 s26, s24, 16384
    s_add_u32 s27, s24, 24576
    s_lshl_b32 s28, s22, 12
    s_add_u32 s28, s28, 12288
    v_lshrrev_b32 v4, 2, v1
    v_mul_u32_u24 v4, 0xc00, v4
    v_lshrrev_b32 v5, 5, v1
    v_lshlrev_b32 v5, 1, v5
    v_and_b32 v9, 3, v1
    v_xor_b32 v5, v5, v9
    v_lshl_add_u32 v9, v5, 4, v4
    s_mul_i32 s29, s22, 3
    s_mul_i32 s23, s21, 192
    s_add_u32 s36, s29, 0
    s_and_b32 s37, s36, 1
    s_lshr_b32 s36, s36, 1
    s_mul_i32 s37, s37, 49152
    s_cmp_ge_u32 s36, 3
    s_cselect_b32 s38, 98112, 0
    s_lshl_b32 s36, s36, 6
    s_add_u32 s37, s37, s38
    s_add_u32 s37, s37, s36
    s_add_u32 s44, s37, s23
    s_add_u32 s36, s29, 1
    s_and_b32 s37, s36, 1
    s_lshr_b32 s36, s36, 1
    s_mul_i32 s37, s37, 49152
    s_cmp_ge_u32 s36, 3
    s_cselect_b32 s38, 98112, 0
    s_lshl_b32 s36, s36, 6
    s_add_u32 s37, s37, s38
    s_add_u32 s37, s37, s36
    s_add_u32 s45, s37, s23
    s_add_u32 s36, s29, 2
    s_and_b32 s37, s36, 1
    s_lshr_b32 s36, s36, 1
    s_mul_i32 s37, s37, 49152
    s_cmp_ge_u32 s36, 3
    s_cselect_b32 s38, 98112, 0
    s_lshl_b32 s36, s36, 6
    s_add_u32 s37, s37, s38
    s_add_u32 s37, s37, s36
    s_add_u32 s46, s37, s23
    s_mul_i32 s29, s22, 3072
    s_and_b32 s36, s22, 1
    s_mul_i32 s36, s36, 3
    s_lshr_b32 s37, s22, 1
    s_mul_i32 s37, s37, 3
    s_add_u32 s38, s36, 0
    s_and_b32 s39, s38, 1
    s_lshr_b32 s38, s38, 1
    s_add_u32 s38, s38, s37
    s_lshl_b32 s38, s38, 11
    v_xor_b32 v4, s39, v6
    v_lshl_add_u32 v4, v4, 5, v7
    v_add_u32 v10, s38, v4
    v_add_u32 v13, 57344, v10
    v_add_u32 v16, 114688, v10
    s_add_u32 s38, s36, 1
    s_and_b32 s39, s38, 1
    s_lshr_b32 s38, s38, 1
    s_add_u32 s38, s38, s37
    s_lshl_b32 s38, s38, 11
    v_xor_b32 v4, s39, v6
    v_lshl_add_u32 v4, v4, 5, v7
    v_add_u32 v11, s38, v4
    v_add_u32 v14, 57344, v11
    v_add_u32 v17, 114688, v11
    s_add_u32 s38, s36, 2
    s_and_b32 s39, s38, 1
    s_lshr_b32 s38, s38, 1
    s_add_u32 s38, s38, s37
    s_lshl_b32 s38, s38, 11
    v_xor_b32 v4, s39, v6
    v_lshl_add_u32 v4, v4, 5, v7
    v_add_u32 v12, s38, v4
    v_add_u32 v15, 57344, v12
    v_add_u32 v18, 114688, v12
    s_lshl_b32 s38, s37, 7
    s_lshl_b32 s39, s36, 6
    s_add_u32 s38, s38, s39
    s_add_u32 s38, s38, 143360
    v_lshlrev_b32 v4, 2, v2
    v_add_u32 v20, s38, v4
    s_waitcnt lgkmcnt(0)
    s_mov_b32 s12, s4
    s_mov_b32 s13, s5
    s_mov_b32 s14, 0x200000
    s_mov_b32 s15, 0x00020000
    s_mov_b32 s16, s6
    s_mov_b32 s17, s7
    s_mov_b32 s18, 0x180000
    s_mov_b32 s19, 0x00020000
    s_mov_b32 s32, s8
    s_mov_b32 s33, s9
    s_mov_b32 s34, 0x10000000
    s_mov_b32 s35, 0x00020000
    s_lshl_b32 s30, s2, 2
    s_add_u32 s30, s30, s22
    s_lshl_b32 s36, s30, 7
    s_add_u32 s36, s36, 0x1500000
    v_lshlrev_b32 v4, 1, v1
    v_mov_b32 v5, 0
    buffer_store_short v5, v4, s[32:35], s36 offen
    s_lshr_b32 s36, s30, 4
    s_and_b32 s37, s30, 15
    s_cmp_ge_u32 s36, 28
    s_cselect_b32 s56, s54, s52
    s_cselect_b32 s57, s55, s53
    s_cselect_b32 s38, 28, 0
    s_cselect_b32 s39, 7168, 0
    s_sub_u32 s36, s36, s38
    s_mov_b32 s58, 0x1c0000
    s_mov_b32 s59, 0x00020000
    s_mul_i32 s60, s37, 114688
    s_lshl_b32 s38, s36, 7
    s_add_u32 s60, s60, s38
    s_mul_i32 s61, s37, 14336
    s_add_u32 s61, s61, s39
    s_lshl_b32 s38, s36, 8
    s_add_u32 s61, s61, s38
    s_add_u32 s61, s61, 0x1440000
    s_mov_b32 s62, 28672
    v_lshrrev_b32 v4, 3, v1
    v_mul_u32_u24 v4, 0xe00, v4
    v_and_b32 v5, 7, v1
    v_lshl_add_u32 v30, v5, 4, v4
    v_lshlrev_b32 v31, 5, v5
    v_min_u32 v4, 13, v1
    v_lshlrev_b32 v29, 7, v4
    s_mul_i32 s63, s30, 1792
    s_mov_b32 s52, s50
    s_mov_b32 s53, s51
    s_mov_b32 s54, 0x1c0000
    s_mov_b32 s55, 0x00020000
    s_cmp_lt_u32 s30, 896
    s_cbranch_scc1 K1_cs1
    s_mov_b32 s56, s48
    s_mov_b32 s57, s49
    s_mov_b32 s58, 0x80000
    s_sub_u32 s60, s30, 896
    s_lshl_b32 s60, s60, 12
    s_mov_b32 s62, 1024
    v_lshlrev_b32 v30, 4, v1
K1_cs1:
    s_add_u32 s36, s47, 0
    s_and_b32 s36, s36, 7
    s_lshl_b32 s37, s36, 7
    s_mul_i32 s38, s36, 196608
    s_add_u32 s31, s24, s37
    s_add_u32 m0, s28, 0
    s_nop 0
    buffer_load_dwordx4 v8, s[12:15], s31 offen lds
    s_add_u32 s31, s25, s37
    s_add_u32 m0, s28, 1024
    s_nop 0
    buffer_load_dwordx4 v8, s[12:15], s31 offen lds
    s_add_u32 s31, s26, s37
    s_add_u32 m0, s28, 2048
    s_nop 0
    buffer_load_dwordx4 v8, s[12:15], s31 offen lds
    s_add_u32 s31, s27, s37
    s_add_u32 m0, s28, 3072
    s_nop 0
    buffer_load_dwordx4 v8, s[12:15], s31 offen lds
    s_add_u32 s31, s44, s38
    s_add_u32 m0, s29, 0
    s_nop 0
    buffer_load_dwordx4 v9, s[16:19], s31 offen lds
    s_add_u32 s31, s45, s38
    s_add_u32 m0, s29, 1024
    s_nop 0
    buffer_load_dwordx4 v9, s[16:19], s31 offen lds
    s_add_u32 s31, s46, s38
    s_add_u32 m0, s29, 2048
    s_nop 0
    buffer_load_dwordx4 v9, s[16:19], s31 offen lds
    s_add_u32 s36, s47, 1
    s_and_b32 s36, s36, 7
    s_lshl_b32 s37, s36, 7
    s_mul_i32 s38, s36, 196608
    s_add_u32 s31, s24, s37
    s_add_u32 m0, s28, 28672
    s_nop 0
    buffer_load_dwordx4 v8, s[12:15], s31 offen lds
    s_add_u32 s31, s25, s37
    s_add_u32 m0, s28, 29696
    s_nop 0
    buffer_load_dwordx4 v8, s[12:15], s31 offen lds
    s_add_u32 s31, s26, s37
    s_add_u32 m0, s28, 30720
    s_nop 0
    buffer_load_dwordx4 v8, s[12:15], s31 offen lds
    s_add_u32 s31, s27, s37
    s_add_u32 m0, s28, 31744
    s_nop 0
    buffer_load_dwordx4 v8, s[12:15], s31 offen lds
    s_add_u32 s31, s44, s38
    s_add_u32 m0, s29, 28672
    s_nop 0
    buffer_load_dwordx4 v9, s[16:19], s31 offen lds
    s_add_u32 s31, s45, s38
    s_add_u32 m0, s29, 29696
    s_nop 0
    buffer_load_dwordx4 v9, s[16:19], s31 offen lds
    s_add_u32 s31, s46, s38
    s_add_u32 m0, s29, 30720
    s_nop 0
    buffer_load_dwordx4 v9, s[16:19], s31 offen lds
    s_add_u32 s36, s47, 2
    s_and_b32 s36, s36, 7
    s_lshl_b32 s37, s36, 7
    s_mul_i32 s38, s36, 196608
    s_add_u32 s31, s24, s37
    s_add_u32 m0, s28, 57344
    s_nop 0
    buffer_load_dwordx4 v8, s[12:15], s31 offen lds
    s_add_u32 s31, s25, s37
    s_add_u32 m0, s28, 58368
    s_nop 0
    buffer_load_dwordx4 v8, s[12:15], s31 offen lds
    s_add_u32 s31, s26, s37
    s_add_u32 m0, s28, 59392
    s_nop 0
    buffer_load_dwordx4 v8, s[12:15], s31 offen lds
    s_add_u32 s31, s27, s37
    s_add_u32 m0, s28, 60416
    s_nop 0
    buffer_load_dwordx4 v8, s[12:15], s31 offen lds
    s_add_u32 s31, s44, s38
    s_add_u32 m0, s29, 57344
    s_nop 0
    buffer_load_dwordx4 v9, s[16:19], s31 offen lds
    s_add_u32 s31, s45, s38
    s_add_u32 m0, s29, 58368
    s_nop 0
    buffer_load_dwordx4 v9, s[16:19], s31 offen lds
    s_add_u32 s31, s46, s38
    s_add_u32 m0, s29, 59392
    s_nop 0
    buffer_load_dwordx4 v9, s[16:19], s31 offen lds
    s_waitcnt vmcnt(14)
    s_barrier
    ds_read_b64_tr_b16 v[32:33], v10 offset:0
    ds_read_b64_tr_b16 v[34:35], v10 offset:256
    ds_read_b64_tr_b16 v[36:37], v11 offset:0
    ds_read_b64_tr_b16 v[38:39], v11 offset:256
    ds_read_b64_tr_b16 v[40:41], v12 offset:0
    ds_read_b64_tr_b16 v[42:43], v12 offset:256
    s_add_u32 s36, s47, 3
    s_and_b32 s36, s36, 7
    s_lshl_b32 s37, s36, 7
    s_mul_i32 s38, s36, 196608
    s_add_u32 s31, s24, s37
    s_add_u32 m0, s28, 86016
    s_nop 0
    buffer_load_dwordx4 v8, s[12:15], s31 offen lds
    s_add_u32 s31, s25, s37
    s_add_u32 m0, s28, 87040
    s_nop 0
    buffer_load_dwordx4 v8, s[12:15], s31 offen lds
    s_add_u32 s31, s26, s37
    s_add_u32 m0, s28, 88064
    s_nop 0
    buffer_load_dwordx4 v8, s[12:15], s31 offen lds
    s_add_u32 s31, s27, s37
    s_add_u32 m0, s28, 89088
    s_nop 0
    buffer_load_dwordx4 v8, s[12:15], s31 offen lds
    s_add_u32 s31, s44, s38
    s_add_u32 m0, s29, 86016
    s_nop 0
    buffer_load_dwordx4 v9, s[16:19], s31 offen lds
    s_add_u32 s31, s45, s38
    s_add_u32 m0, s29, 87040
    s_nop 0
    buffer_load_dwordx4 v9, s[16:19], s31 offen lds
    s_add_u32 s31, s46, s38
    s_add_u32 m0, s29, 88064
    s_nop 0
    buffer_load_dwordx4 v9, s[16:19], s31 offen lds
    s_waitcnt lgkmcnt(0)
    v_mfma_f32_16x16x32_bf16 v[44:47], v[22:25], v[32:35], 0
    v_mfma_f32_16x16x32_bf16 v[48:51], v[22:25], v[36:39], 0
    v_mfma_f32_16x16x32_bf16 v[52:55], v[22:25], v[40:43], 0
    s_waitcnt vmcnt(14)
    s_barrier
    ds_read_b64_tr_b16 v[32:33], v10 offset:28672
    ds_read_b64_tr_b16 v[34:35], v10 offset:28928
    ds_read_b64_tr_b16 v[36:37], v11 offset:28672
    ds_read_b64_tr_b16 v[38:39], v11 offset:28928
    ds_read_b64_tr_b16 v[40:41], v12 offset:28672
    ds_read_b64_tr_b16 v[42:43], v12 offset:28928
    s_add_u32 s36, s47, 4
    s_and_b32 s36, s36, 7
    s_lshl_b32 s37, s36, 7
    s_mul_i32 s38, s36, 196608
    s_add_u32 s31, s24, s37
    s_add_u32 m0, s28, 114688
    s_nop 0
    buffer_load_dwordx4 v8, s[12:15], s31 offen lds
    s_add_u32 s31, s25, s37
    s_add_u32 m0, s28, 115712
    s_nop 0
    buffer_load_dwordx4 v8, s[12:15], s31 offen lds
    s_add_u32 s31, s26, s37
    s_add_u32 m0, s28, 116736
    s_nop 0
    buffer_load_dwordx4 v8, s[12:15], s31 offen lds
    s_add_u32 s31, s27, s37
    s_add_u32 m0, s28, 117760
    s_nop 0
    buffer_load_dwordx4 v8, s[12:15], s31 offen lds
    s_add_u32 s31, s44, s38
    s_add_u32 m0, s29, 114688
    s_nop 0
    buffer_load_dwordx4 v9, s[16:19], s31 offen lds
    s_add_u32 s31, s45, s38
    s_add_u32 m0, s29, 115712
    s_nop 0
    buffer_load_dwordx4 v9, s[16:19], s31 offen lds
    s_add_u32 s31, s46, s38
    s_add_u32 m0, s29, 116736
    s_nop 0
    buffer_load_dwordx4 v9, s[16:19], s31 offen lds
    s_waitcnt lgkmcnt(0)
    v_mfma_f32_16x16x32_bf16 v[44:47], v[22:25], v[32:35], v[44:47]
    v_mfma_f32_16x16x32_bf16 v[48:51], v[22:25], v[36:39], v[48:51]
    v_mfma_f32_16x16x32_bf16 v[52:55], v[22:25], v[40:43], v[52:55]
    s_waitcnt vmcnt(14)
    s_barrier
    ds_read_b64_tr_b16 v[32:33], v13 offset:0
    ds_read_b64_tr_b16 v[34:35], v13 offset:256
    ds_read_b64_tr_b16 v[36:37], v14 offset:0
    ds_read_b64_tr_b16 v[38:39], v14 offset:256
    ds_read_b64_tr_b16 v[40:41], v15 offset:0
    ds_read_b64_tr_b16 v[42:43], v15 offset:256
    s_add_u32 s36, s47, 5
    s_and_b32 s36, s36, 7
    s_lshl_b32 s37, s36, 7
    s_mul_i32 s38, s36, 196608
    s_add_u32 s31, s24, s37
    s_add_u32 m0, s28, 0
    s_nop 0
    buffer_load_dwordx4 v8, s[12:15], s31 offen lds
    s_add_u32 s31, s25, s37
    s_add_u32 m0, s28, 1024
    s_nop 0
    buffer_load_dwordx4 v8, s[12:15], s31 offen lds
    s_add_u32 s31, s26, s37
    s_add_u32 m0, s28, 2048
    s_nop 0
    buffer_load_dwordx4 v8, s[12:15], s31 offen lds
    s_add_u32 s31, s27, s37
    s_add_u32 m0, s28, 3072
    s_nop 0
    buffer_load_dwordx4 v8, s[12:15], s31 offen lds
    s_add_u32 s31, s44, s38
    s_add_u32 m0, s29, 0
    s_nop 0
    buffer_load_dwordx4 v9, s[16:19], s31 offen lds
    s_add_u32 s31, s45, s38
    s_add_u32 m0, s29, 1024
    s_nop 0
    buffer_load_dwordx4 v9, s[16:19], s31 offen lds
    s_add_u32 s31, s46, s38
    s_add_u32 m0, s29, 2048
    s_nop 0
    buffer_load_dwordx4 v9, s[16:19], s31 offen lds
    s_waitcnt lgkmcnt(0)
    v_mfma_f32_16x16x32_bf16 v[44:47], v[22:25], v[32:35], v[44:47]
    v_mfma_f32_16x16x32_bf16 v[48:51], v[22:25], v[36:39], v[48:51]
    v_mfma_f32_16x16x32_bf16 v[52:55], v[22:25], v[40:43], v[52:55]
    s_waitcnt vmcnt(14)
    s_barrier
    ds_read_b64_tr_b16 v[32:33], v13 offset:28672
    ds_read_b64_tr_b16 v[34:35], v13 offset:28928
    ds_read_b64_tr_b16 v[36:37], v14 offset:28672
    ds_read_b64_tr_b16 v[38:39], v14 offset:28928
    ds_read_b64_tr_b16 v[40:41], v15 offset:28672
    ds_read_b64_tr_b16 v[42:43], v15 offset:28928
    s_add_u32 s36, s47, 6
    s_and_b32 s36, s36, 7
    s_lshl_b32 s37, s36, 7
    s_mul_i32 s38, s36, 196608
    s_add_u32 s31, s24, s37
    s_add_u32 m0, s28, 28672
    s_nop 0
    buffer_load_dwordx4 v8, s[12:15], s31 offen lds
    s_add_u32 s31, s25, s37
    s_add_u32 m0, s28, 29696
    s_nop 0
    buffer_load_dwordx4 v8, s[12:15], s31 offen lds
    s_add_u32 s31, s26, s37
    s_add_u32 m0, s28, 30720
    s_nop 0
    buffer_load_dwordx4 v8, s[12:15], s31 offen lds
    s_add_u32 s31, s27, s37
    s_add_u32 m0, s28, 31744
    s_nop 0
    buffer_load_dwordx4 v8, s[12:15], s31 offen lds
    s_add_u32 s31, s44, s38
    s_add_u32 m0, s29, 28672
    s_nop 0
    buffer_load_dwordx4 v9, s[16:19], s31 offen lds
    s_add_u32 s31, s45, s38
    s_add_u32 m0, s29, 29696
    s_nop 0
    buffer_load_dwordx4 v9, s[16:19], s31 offen lds
    s_add_u32 s31, s46, s38
    s_add_u32 m0, s29, 30720
    s_nop 0
    buffer_load_dwordx4 v9, s[16:19], s31 offen lds
    s_waitcnt lgkmcnt(0)
    v_mfma_f32_16x16x32_bf16 v[44:47], v[22:25], v[32:35], v[44:47]
    v_mfma_f32_16x16x32_bf16 v[48:51], v[22:25], v[36:39], v[48:51]
    v_mfma_f32_16x16x32_bf16 v[52:55], v[22:25], v[40:43], v[52:55]
    s_waitcnt vmcnt(14)
    s_barrier
    ds_read_b64_tr_b16 v[32:33], v16 offset:0
    ds_read_b64_tr_b16 v[34:35], v16 offset:256
    ds_read_b64_tr_b16 v[36:37], v17 offset:0
    ds_read_b64_tr_b16 v[38:39], v17 offset:256
    ds_read_b64_tr_b16 v[40:41], v18 offset:0
    ds_read_b64_tr_b16 v[42:43], v18 offset:256
    s_add_u32 s36, s47, 7
    s_and_b32 s36, s36, 7
    s_lshl_b32 s37, s36, 7
    s_mul_i32 s38, s36, 196608
    s_add_u32 s31, s24, s37
    s_add_u32 m0, s28, 57344
    s_nop 0
    buffer_load_dwordx4 v8, s[12:15], s31 offen lds
    s_add_u32 s31, s25, s37
    s_add_u32 m0, s28, 58368
    s_nop 0
    buffer_load_dwordx4 v8, s[12:15], s31 offen lds
    s_add_u32 s31, s26, s37
    s_add_u32 m0, s28, 59392
    s_nop 0
    buffer_load_dwordx4 v8, s[12:15], s31 offen lds
    s_add_u32 s31, s27, s37
    s_add_u32 m0, s28, 60416
    s_nop 0
    buffer_load_dwordx4 v8, s[12:15], s31 offen lds
    s_add_u32 s31, s44, s38
    s_add_u32 m0, s29, 57344
    s_nop 0
    buffer_load_dwordx4 v9, s[16:19], s31 offen lds
    s_add_u32 s31, s45, s38
    s_add_u32 m0, s29, 58368
    s_nop 0
    buffer_load_dwordx4 v9, s[16:19], s31 offen lds
    s_add_u32 s31, s46, s38
    s_add_u32 m0, s29, 59392
    s_nop 0
    buffer_load_dwordx4 v9, s[16:19], s31 offen lds
    buffer_load_dwordx4 v[64:67], v30, s[56:59], s60 offen
    s_add_u32 s60, s60, s62
    buffer_load_dwordx4 v[68:71], v30, s[56:59], s60 offen
    s_add_u32 s60, s60, s62
    buffer_load_dwordx4 v[72:75], v30, s[56:59], s60 offen
    s_add_u32 s60, s60, s62
    buffer_load_dwordx4 v[76:79], v30, s[56:59], s60 offen
    s_waitcnt lgkmcnt(0)
    v_mfma_f32_16x16x32_bf16 v[44:47], v[22:25], v[32:35], v[44:47]
    v_mfma_f32_16x16x32_bf16 v[48:51], v[22:25], v[36:39], v[48:51]
    v_mfma_f32_16x16x32_bf16 v[52:55], v[22:25], v[40:43], v[52:55]
    s_waitcnt vmcnt(18)
    s_barrier
    ds_read_b64_tr_b16 v[32:33], v10 offset:0
    ds_read_b64_tr_b16 v[34:35], v10 offset:256
    ds_read_b64_tr_b16 v[36:37], v11 offset:0
    ds_read_b64_tr_b16 v[38:39], v11 offset:256
    ds_read_b64_tr_b16 v[40:41], v12 offset:0
    ds_read_b64_tr_b16 v[42:43], v12 offset:256
    buffer_load_dword v95, v29, s[52:55], s63 offen
    s_waitcnt lgkmcnt(0)
    v_mfma_f32_16x16x32_bf16 v[44:47], v[22:25], v[32:35], v[44:47]
    v_mfma_f32_16x16x32_bf16 v[48:51], v[22:25], v[36:39], v[48:51]
    v_mfma_f32_16x16x32_bf16 v[52:55], v[22:25], v[40:43], v[52:55]
    s_waitcnt vmcnt(12)
    s_barrier
    ds_read_b64_tr_b16 v[32:33], v10 offset:28672
    ds_read_b64_tr_b16 v[34:35], v10 offset:28928
    ds_read_b64_tr_b16 v[36:37], v11 offset:28672
    ds_read_b64_tr_b16 v[38:39], v11 offset:28928
    ds_read_b64_tr_b16 v[40:41], v12 offset:28672
    ds_read_b64_tr_b16 v[42:43], v12 offset:28928
    s_waitcnt lgkmcnt(0)
    v_mfma_f32_16x16x32_bf16 v[44:47], v[22:25], v[32:35], v[44:47]
    v_mfma_f32_16x16x32_bf16 v[48:51], v[22:25], v[36:39], v[48:51]
    v_mfma_f32_16x16x32_bf16 v[52:55], v[22:25], v[40:43], v[52:55]
    s_waitcnt vmcnt(5)
    s_barrier
    ds_read_b64_tr_b16 v[32:33], v13 offset:0
    ds_read_b64_tr_b16 v[34:35], v13 offset:256
    ds_read_b64_tr_b16 v[36:37], v14 offset:0
    ds_read_b64_tr_b16 v[38:39], v14 offset:256
    ds_read_b64_tr_b16 v[40:41], v15 offset:0
    ds_read_b64_tr_b16 v[42:43], v15 offset:256
    s_waitcnt lgkmcnt(0)
    v_mfma_f32_16x16x32_bf16 v[44:47], v[22:25], v[32:35], v[44:47]
    v_mfma_f32_16x16x32_bf16 v[48:51], v[22:25], v[36:39], v[48:51]
    v_mfma_f32_16x16x32_bf16 v[52:55], v[22:25], v[40:43], v[52:55]
    s_nop 5
    ds_write_b32 v20, v44 offset:0
    ds_write_b32 v20, v48 offset:64
    ds_write_b32 v20, v52 offset:128
    s_waitcnt lgkmcnt(0)
    s_barrier
    s_cmp_ge_u32 s30, 896
    s_cbranch_scc1 K1_done
    s_mov_b32 s36, 0x00003f80
    s_mov_b32 s37, 0x3f800000
    s_waitcnt vmcnt(0)
    v_dot2_f32_bf16 v80, v64, s36, 0
    v_dot2_f32_bf16 v81, v64, s37, 0
    v_dot2_f32_bf16 v82, v65, s36, 0
    v_dot2_f32_bf16 v83, v65, s37, 0
    v_dot2_f32_bf16 v84, v66, s36, 0
    v_dot2_f32_bf16 v85, v66, s37, 0
    v_dot2_f32_bf16 v86, v67, s36, 0
    v_dot2_f32_bf16 v87, v67, s37, 0
    v_dot2_f32_bf16 v80, v68, s36, v80
    v_dot2_f32_bf16 v81, v68, s37, v81
    v_dot2_f32_bf16 v82, v69, s36, v82
    v_dot2_f32_bf16 v83, v69, s37, v83
    v_dot2_f32_bf16 v84, v70, s36, v84
    v_dot2_f32_bf16 v85, v70, s37, v85
    v_dot2_f32_bf16 v86, v71, s36, v86
    v_dot2_f32_bf16 v87, v71, s37, v87
    v_dot2_f32_bf16 v80, v72, s36, v80
    v_dot2_f32_bf16 v81, v72, s37, v81
    v_dot2_f32_bf16 v82, v73, s36, v82
    v_dot2_f32_bf16 v83, v73, s37, v83
    v_dot2_f32_bf16 v84, v74, s36, v84
    v_dot2_f32_bf16 v85, v74, s37, v85
    v_dot2_f32_bf16 v86, v75, s36, v86
    v_dot2_f32_bf16 v87, v75, s37, v87
    v_dot2_f32_bf16 v80, v76, s36, v80
    v_dot2_f32_bf16 v81, v76, s37, v81
    v_dot2_f32_bf16 v82, v77, s36, v82
    v_dot2_f32_bf16 v83, v77, s37, v83
    v_dot2_f32_bf16 v84, v78, s36, v84
    v_dot2_f32_bf16 v85, v78, s37, v85
    v_dot2_f32_bf16 v86, v79, s36, v86
    v_dot2_f32_bf16 v87, v79, s37, v87
    v_add_f32_dpp v80, v80, v80 row_ror:8 row_mask:0xf bank_mask:0xf
    v_add_f32_dpp v81, v81, v81 row_ror:8 row_mask:0xf bank_mask:0xf
    v_add_f32_dpp v82, v82, v82 row_ror:8 row_mask:0xf bank_mask:0xf
    v_add_f32_dpp v83, v83, v83 row_ror:8 row_mask:0xf bank_mask:0xf
    v_add_f32_dpp v84, v84, v84 row_ror:8 row_mask:0xf bank_mask:0xf
    v_add_f32_dpp v85, v85, v85 row_ror:8 row_mask:0xf bank_mask:0xf
    v_add_f32_dpp v86, v86, v86 row_ror:8 row_mask:0xf bank_mask:0xf
    v_add_f32_dpp v87, v87, v87 row_ror:8 row_mask:0xf bank_mask:0xf
    v_mov_b32 v88, v80
    v_mov_b32 v89, v81
    v_mov_b32 v90, v82
    v_mov_b32 v91, v83
    v_mov_b32 v92, v84
    v_mov_b32 v93, v85
    v_mov_b32 v94, v86
    v_mov_b32 v95, v87
    v_permlane16_swap_b32 v80, v88
    v_permlane16_swap_b32 v81, v89
    v_permlane16_swap_b32 v82, v90
    v_permlane16_swap_b32 v83, v91
    v_permlane16_swap_b32 v84, v92
    v_permlane16_swap_b32 v85, v93
    v_permlane16_swap_b32 v86, v94
    v_permlane16_swap_b32 v87, v95
    v_add_f32 v80, v80, v88
    v_add_f32 v81, v81, v89
    v_add_f32 v82, v82, v90
    v_add_f32 v83, v83, v91
    v_add_f32 v84, v84, v92
    v_add_f32 v85, v85, v93
    v_add_f32 v86, v86, v94
    v_add_f32 v87, v87, v95
    v_mov_b32 v88, v80
    v_mov_b32 v89, v81
    v_mov_b32 v90, v82
    v_mov_b32 v91, v83
    v_mov_b32 v92, v84
    v_mov_b32 v93, v85
    v_mov_b32 v94, v86
    v_mov_b32 v95, v87
    v_permlane32_swap_b32 v80, v88
    v_permlane32_swap_b32 v81, v89
    v_permlane32_swap_b32 v82, v90
    v_permlane32_swap_b32 v83, v91
    v_permlane32_swap_b32 v84, v92
    v_permlane32_swap_b32 v85, v93
    v_permlane32_swap_b32 v86, v94
    v_permlane32_swap_b32 v87, v95
    v_add_f32 v80, v80, v88
    v_add_f32 v81, v81, v89
    v_add_f32 v82, v82, v90
    v_add_f32 v83, v83, v91
    v_add_f32 v84, v84, v92
    v_add_f32 v85, v85, v93
    v_add_f32 v86, v86, v94
    v_add_f32 v87, v87, v95
    s_mov_b64 exec, 0xff
    buffer_store_dwordx4 v[80:83], v31, s[32:35], s61 offen offset:0
    buffer_store_dwordx4 v[84:87], v31, s[32:35], s61 offen offset:16
    s_endpgm
J_K1_comp:
    s_nop 7
    s_nop 7
    v_lshl_add_u32 v10, v6, 5, v7
    v_xor_b32 v5, 1, v6
    v_lshl_add_u32 v11, v5, 5, v7
    s_lshl_b32 s23, s22, 12
    s_add_u32 s23, s23, 12288
    v_and_b32 v4, 7, v2
    v_xor_b32 v4, v4, v3
    v_lshlrev_b32 v4, 4, v4
    v_lshl_add_u32 v4, v2, 7, v4
    v_add_u32 v16, s23, v4
    v_xor_b32 v4, 64, v4
    v_add_u32 v17, s23, v4
    v_add_u32 v12, 57344, v10
    v_add_u32 v18, 57344, v16
    v_add_u32 v13, 57344, v11
    v_add_u32 v19, 57344, v17
    v_add_u32 v14, 114688, v10
    v_add_u32 v20, 114688, v16
    v_add_u32 v15, 114688, v11
    v_add_u32 v21, 114688, v17
    s_lshl_b32 s25, s20, 12
    s_lshl_b32 s24, s22, 10
    s_add_u32 s25, s25, s24
    v_lshlrev_b32 v4, 5, v2
    v_add_u32 v4, s25, v4
    v_lshl_add_u32 v8, v3, 3, v4
    v_lshlrev_b32 v5, 1, v6
    v_lshrrev_b32 v6, 1, v3
    v_or_b32 v5, v5, v6
    v_lshl_add_u32 v9, v5, 3, v4
    s_mul_i32 s28, s21, 0x60000
    v_lshlrev_b32 v4, 4, v3
    v_lshlrev_b32 v5, 2, v2
    v_add_u32 v206, 143360, v4
    v_add_u32 v207, 143360, v5
    s_lshl_b32 s24, s22, 8
    s_add_u32 s24, s24, 144384
    v_add_u32 v208, s24, v5
    v_add_u32 v209, s24, v4
    s_lshl_b32 s24, s11, 2
    s_add_u32 s24, s24, s22
    s_and_b32 s25, s10, 3
    s_lshl_b32 s25, s25, 19
    s_and_b32 s26, s24, 15
    s_lshl_b32 s26, s26, 15
    s_add_u32 s25, s25, s26
    s_lshr_b32 s30, s24, 4
    s_add_u32 s27, s30, s47
    s_and_b32 s27, s27, 7
    s_lshl_b32 s26, s27, 7
    s_add_u32 s25, s25, s26
    s_lshl_b32 s27, s27, 4
    s_and_b32 s26, s24, 15
    s_add_u32 s26, s26, s27
    s_mul_i32 s26, s26, 12288
    s_lshr_b32 s27, s10, 2
    s_mul_i32 s27, s27, 1536
    s_add_u32 s26, s26, s27
    v_and_b32 v4, 31, v1
    v_lshlrev_b32 v4, 10, v4
    v_min_u32 v5, 11, v2
    v_lshlrev_b32 v5, 7, v5
    v_mul_u32_u24 v6, 0xc00, v3
    v_add_u32 v5, v5, v6
    s_waitcnt lgkmcnt(0)
    s_mov_b32 s12, s4
    s_mov_b32 s13, s5
    s_mov_b32 s14, 0x200000
    s_mov_b32 s15, 0x00020000
    s_mov_b32 s16, s6
    s_mov_b32 s17, s7
    s_mov_b32 s18, 0x180000
    s_mov_b32 s19, 0x00020000
    s_cmp_lt_u32 s30, 3
    s_cbranch_scc1 K1_nopf
K1_dl:
    s_cmp_le_u32 s30, 3
    s_cbranch_scc1 K1_dx
    s_sleep 6
    s_sub_u32 s30, s30, 1
    s_branch K1_dl
K1_dx:
    buffer_load_dword v210, v5, s[16:19], s26 offen
    buffer_load_dword v211, v4, s[12:15], s25 offen
K1_nopf:
    s_mov_b32 s32, s8
    s_mov_b32 s33, s9
    s_mov_b32 s34, 0x10000000
    s_mov_b32 s35, 0x00020000
    s_cmp_eq_u32 s21, 10
    s_cbranch_scc1 J_K1_mix
    s_cmp_gt_u32 s21, 10
    s_cbranch_scc1 J_K1_v
J_K1_qk:
    s_nop 7
    s_nop 7
    s_barrier
    ds_read_b128 v[54:57], v16 offset:0
    ds_read_b128 v[58:61], v16 offset:2048
    ds_read_b64_tr_b16 v[70:71], v10 offset:0
    ds_read_b64_tr_b16 v[72:73], v10 offset:256
    ds_read_b64_tr_b16 v[74:75], v11 offset:0
    ds_read_b64_tr_b16 v[76:77], v11 offset:256
    ds_read_b64_tr_b16 v[78:79], v10 offset:2048
    ds_read_b64_tr_b16 v[80:81], v10 offset:2304
    ds_read_b64_tr_b16 v[82:83], v11 offset:2048
    ds_read_b64_tr_b16 v[84:85], v11 offset:2304
    ds_read_b64_tr_b16 v[86:87], v10 offset:4096
    ds_read_b64_tr_b16 v[88:89], v10 offset:4352
    ds_read_b64_tr_b16 v[90:91], v11 offset:4096
    ds_read_b64_tr_b16 v[92:93], v11 offset:4352
    s_waitcnt lgkmcnt(0)
    v_mfma_f32_16x16x32_bf16 v[26:29], v[22:25], v[54:57], 0
    ds_read_b128 v[62:65], v17 offset:0
    ds_read_b128 v[66:69], v17 offset:2048
    v_mfma_f32_16x16x32_bf16 v[34:37], v[54:57], v[54:57], 0
    ds_read_b64_tr_b16 v[94:95], v10 offset:6144
    ds_read_b64_tr_b16 v[96:97], v10 offset:6400
    v_mfma_f32_16x16x32_bf16 v[30:33], v[22:25], v[58:61], 0
    ds_read_b64_tr_b16 v[98:99], v11 offset:6144
    ds_read_b64_tr_b16 v[100:101], v11 offset:6400
    v_mfma_f32_16x16x32_bf16 v[38:41], v[58:61], v[58:61], 0
    ds_read_b64_tr_b16 v[102:103], v10 offset:8192
    ds_read_b64_tr_b16 v[104:105], v10 offset:8448
    v_mfma_f32_16x16x32_bf16 v[118:121], v[70:73], v[54:57], 0
    ds_read_b64_tr_b16 v[106:107], v11 offset:8192
    ds_read_b64_tr_b16 v[108:109], v11 offset:8448
    v_mfma_f32_16x16x32_bf16 v[142:145], v[70:73], v[58:61], 0
    ds_read_b64_tr_b16 v[110:111], v10 offset:10240
    ds_read_b64_tr_b16 v[112:113], v10 offset:10496
    v_mfma_f32_16x16x32_bf16 v[122:125], v[74:77], v[54:57], 0
    ds_read_b64_tr_b16 v[114:115], v11 offset:10240
    ds_read_b64_tr_b16 v[116:117], v11 offset:10496
    v_mfma_f32_16x16x32_bf16 v[146:149], v[74:77], v[58:61], 0
    v_mfma_f32_16x16x32_bf16 v[126:129], v[78:81], v[54:57], 0
    v_mfma_f32_16x16x32_bf16 v[150:153], v[78:81], v[58:61], 0
    v_mfma_f32_16x16x32_bf16 v[130:133], v[82:85], v[54:57], 0
    v_mfma_f32_16x16x32_bf16 v[154:157], v[82:85], v[58:61], 0
    v_mfma_f32_16x16x32_bf16 v[134:137], v[86:89], v[54:57], 0
    v_mfma_f32_16x16x32_bf16 v[158:161], v[86:89], v[58:61], 0
    v_mfma_f32_16x16x32_bf16 v[138:141], v[90:93], v[54:57], 0
    v_mfma_f32_16x16x32_bf16 v[162:165], v[90:93], v[58:61], 0
    s_waitcnt lgkmcnt(0)
    s_barrier
    v_mfma_f32_16x16x32_bf16 v[26:29], v[22:25], v[62:65], v[26:29]
    ds_read_b128 v[54:57], v16 offset:28672
    ds_read_b128 v[58:61], v16 offset:30720
    v_mfma_f32_16x16x32_bf16 v[34:37], v[62:65], v[62:65], v[34:37]
    ds_read_b64_tr_b16 v[70:71], v10 offset:28672
    ds_read_b64_tr_b16 v[72:73], v10 offset:28928
    v_mfma_f32_16x16x32_bf16 v[30:33], v[22:25], v[66:69], v[30:33]
    ds_read_b64_tr_b16 v[74:75], v11 offset:28672
    ds_read_b64_tr_b16 v[76:77], v11 offset:28928
    v_mfma_f32_16x16x32_bf16 v[38:41], v[66:69], v[66:69], v[38:41]
    ds_read_b64_tr_b16 v[78:79], v10 offset:30720
    ds_read_b64_tr_b16 v[80:81], v10 offset:30976
    v_mfma_f32_16x16x32_bf16 v[118:121], v[94:97], v[62:65], v[118:121]
    ds_read_b64_tr_b16 v[82:83], v11 offset:30720
    ds_read_b64_tr_b16 v[84:85], v11 offset:30976
    v_mfma_f32_16x16x32_bf16 v[142:145], v[94:97], v[66:69], v[142:145]
    ds_read_b64_tr_b16 v[86:87], v10 offset:32768
    ds_read_b64_tr_b16 v[88:89], v10 offset:33024
    v_mfma_f32_16x16x32_bf16 v[122:125], v[98:101], v[62:65], v[122:125]
    ds_read_b64_tr_b16 v[90:91], v11 offset:32768
    ds_read_b64_tr_b16 v[92:93], v11 offset:33024
    v_mfma_f32_16x16x32_bf16 v[146:149], v[98:101], v[66:69], v[146:149]
    v_mfma_f32_16x16x32_bf16 v[126:129], v[102:105], v[62:65], v[126:129]
    v_mfma_f32_16x16x32_bf16 v[150:153], v[102:105], v[66:69], v[150:153]
    v_mfma_f32_16x16x32_bf16 v[130:133], v[106:109], v[62:65], v[130:133]
    v_mfma_f32_16x16x32_bf16 v[154:157], v[106:109], v[66:69], v[154:157]
    v_mfma_f32_16x16x32_bf16 v[134:137], v[110:113], v[62:65], v[134:137]
    v_mfma_f32_16x16x32_bf16 v[158:161], v[110:113], v[66:69], v[158:161]
    v_mfma_f32_16x16x32_bf16 v[138:141], v[114:117], v[62:65], v[138:141]
    v_mfma_f32_16x16x32_bf16 v[162:165], v[114:117], v[66:69], v[162:165]
    s_waitcnt lgkmcnt(0)
    v_mfma_f32_16x16x32_bf16 v[26:29], v[22:25], v[54:57], v[26:29]
    ds_read_b128 v[62:65], v17 offset:28672
    ds_read_b128 v[66:69], v17 offset:30720
    v_mfma_f32_16x16x32_bf16 v[34:37], v[54:57], v[54:57], v[34:37]
    ds_read_b64_tr_b16 v[94:95], v10 offset:34816
    ds_read_b64_tr_b16 v[96:97], v10 offset:35072
    v_mfma_f32_16x16x32_bf16 v[30:33], v[22:25], v[58:61], v[30:33]
    ds_read_b64_tr_b16 v[98:99], v11 offset:34816
    ds_read_b64_tr_b16 v[100:101], v11 offset:35072
    v_mfma_f32_16x16x32_bf16 v[38:41], v[58:61], v[58:61], v[38:41]
    ds_read_b64_tr_b16 v[102:103], v10 offset:36864
    ds_read_b64_tr_b16 v[104:105], v10 offset:37120
    v_mfma_f32_16x16x32_bf16 v[118:121], v[70:73], v[54:57], v[118:121]
    ds_read_b64_tr_b16 v[106:107], v11 offset:36864
    ds_read_b64_tr_b16 v[108:109], v11 offset:37120
    v_mfma_f32_16x16x32_bf16 v[142:145], v[70:73], v[58:61], v[142:145]
    ds_read_b64_tr_b16 v[110:111], v10 offset:38912
    ds_read_b64_tr_b16 v[112:113], v10 offset:39168
    v_mfma_f32_16x16x32_bf16 v[122:125], v[74:77], v[54:57], v[122:125]
    ds_read_b64_tr_b16 v[114:115], v11 offset:38912
    ds_read_b64_tr_b16 v[116:117], v11 offset:39168
    v_mfma_f32_16x16x32_bf16 v[146:149], v[74:77], v[58:61], v[146:149]
    v_mfma_f32_16x16x32_bf16 v[126:129], v[78:81], v[54:57], v[126:129]
    v_mfma_f32_16x16x32_bf16 v[150:153], v[78:81], v[58:61], v[150:153]
    v_mfma_f32_16x16x32_bf16 v[130:133], v[82:85], v[54:57], v[130:133]
    v_mfma_f32_16x16x32_bf16 v[154:157], v[82:85], v[58:61], v[154:157]
    v_mfma_f32_16x16x32_bf16 v[134:137], v[86:89], v[54:57], v[134:137]
    v_mfma_f32_16x16x32_bf16 v[158:161], v[86:89], v[58:61], v[158:161]
    v_mfma_f32_16x16x32_bf16 v[138:141], v[90:93], v[54:57], v[138:141]
    v_mfma_f32_16x16x32_bf16 v[162:165], v[90:93], v[58:61], v[162:165]
    s_waitcnt lgkmcnt(0)
    s_barrier
    v_mfma_f32_16x16x32_bf16 v[26:29], v[22:25], v[62:65], v[26:29]
    ds_read_b128 v[54:57], v18 offset:0
    ds_read_b128 v[58:61], v18 offset:2048
    v_mfma_f32_16x16x32_bf16 v[34:37], v[62:65], v[62:65], v[34:37]
    ds_read_b64_tr_b16 v[70:71], v12 offset:0
    ds_read_b64_tr_b16 v[72:73], v12 offset:256
    v_mfma_f32_16x16x32_bf16 v[30:33], v[22:25], v[66:69], v[30:33]
    ds_read_b64_tr_b16 v[74:75], v13 offset:0
    ds_read_b64_tr_b16 v[76:77], v13 offset:256
    v_mfma_f32_16x16x32_bf16 v[38:41], v[66:69], v[66:69], v[38:41]
    ds_read_b64_tr_b16 v[78:79], v12 offset:2048
    ds_read_b64_tr_b16 v[80:81], v12 offset:2304
    v_mfma_f32_16x16x32_bf16 v[118:121], v[94:97], v[62:65], v[118:121]
    ds_read_b64_tr_b16 v[82:83], v13 offset:2048
    ds_read_b64_tr_b16 v[84:85], v13 offset:2304
    v_mfma_f32_16x16x32_bf16 v[142:145], v[94:97], v[66:69], v[142:145]
    ds_read_b64_tr_b16 v[86:87], v12 offset:4096
    ds_read_b64_tr_b16 v[88:89], v12 offset:4352
    v_mfma_f32_16x16x32_bf16 v[122:125], v[98:101], v[62:65], v[122:125]
    ds_read_b64_tr_b16 v[90:91], v13 offset:4096
    ds_read_b64_tr_b16 v[92:93], v13 offset:4352
    v_mfma_f32_16x16x32_bf16 v[146:149], v[98:101], v[66:69], v[146:149]
    v_mfma_f32_16x16x32_bf16 v[126:129], v[102:105], v[62:65], v[126:129]
    v_mfma_f32_16x16x32_bf16 v[150:153], v[102:105], v[66:69], v[150:153]
    v_mfma_f32_16x16x32_bf16 v[130:133], v[106:109], v[62:65], v[130:133]
    v_mfma_f32_16x16x32_bf16 v[154:157], v[106:109], v[66:69], v[154:157]
    v_mfma_f32_16x16x32_bf16 v[134:137], v[110:113], v[62:65], v[134:137]
    v_mfma_f32_16x16x32_bf16 v[158:161], v[110:113], v[66:69], v[158:161]
    v_mfma_f32_16x16x32_bf16 v[138:141], v[114:117], v[62:65], v[138:141]
    v_mfma_f32_16x16x32_bf16 v[162:165], v[114:117], v[66:69], v[162:165]
    s_waitcnt lgkmcnt(0)
    v_mfma_f32_16x16x32_bf16 v[26:29], v[22:25], v[54:57], v[26:29]
    ds_read_b128 v[62:65], v19 offset:0
    ds_read_b128 v[66:69], v19 offset:2048
    v_mfma_f32_16x16x32_bf16 v[34:37], v[54:57], v[54:57], v[34:37]
    ds_read_b64_tr_b16 v[94:95], v12 offset:6144
    ds_read_b64_tr_b16 v[96:97], v12 offset:6400
    v_mfma_f32_16x16x32_bf16 v[30:33], v[22:25], v[58:61], v[30:33]
    ds_read_b64_tr_b16 v[98:99], v13 offset:6144
    ds_read_b64_tr_b16 v[100:101], v13 offset:6400
    v_mfma_f32_16x16x32_bf16 v[38:41], v[58:61], v[58:61], v[38:41]
    ds_read_b64_tr_b16 v[102:103], v12 offset:8192
    ds_read_b64_tr_b16 v[104:105], v12 offset:8448
    v_mfma_f32_16x16x32_bf16 v[118:121], v[70:73], v[54:57], v[118:121]
    ds_read_b64_tr_b16 v[106:107], v13 offset:8192
    ds_read_b64_tr_b16 v[108:109], v13 offset:8448
    v_mfma_f32_16x16x32_bf16 v[142:145], v[70:73], v[58:61], v[142:145]
    ds_read_b64_tr_b16 v[110:111], v12 offset:10240
    ds_read_b64_tr_b16 v[112:113], v12 offset:10496
    v_mfma_f32_16x16x32_bf16 v[122:125], v[74:77], v[54:57], v[122:125]
    ds_read_b64_tr_b16 v[114:115], v13 offset:10240
    ds_read_b64_tr_b16 v[116:117], v13 offset:10496
    v_mfma_f32_16x16x32_bf16 v[146:149], v[74:77], v[58:61], v[146:149]
    v_mfma_f32_16x16x32_bf16 v[126:129], v[78:81], v[54:57], v[126:129]
    v_mfma_f32_16x16x32_bf16 v[150:153], v[78:81], v[58:61], v[150:153]
    v_mfma_f32_16x16x32_bf16 v[130:133], v[82:85], v[54:57], v[130:133]
    v_mfma_f32_16x16x32_bf16 v[154:157], v[82:85], v[58:61], v[154:157]
    v_mfma_f32_16x16x32_bf16 v[134:137], v[86:89], v[54:57], v[134:137]
    v_mfma_f32_16x16x32_bf16 v[158:161], v[86:89], v[58:61], v[158:161]
    v_mfma_f32_16x16x32_bf16 v[138:141], v[90:93], v[54:57], v[138:141]
    v_mfma_f32_16x16x32_bf16 v[162:165], v[90:93], v[58:61], v[162:165]
    s_waitcnt lgkmcnt(0)
    s_barrier
    v_mfma_f32_16x16x32_bf16 v[26:29], v[22:25], v[62:65], v[26:29]
    ds_read_b128 v[54:57], v18 offset:28672
    ds_read_b128 v[58:61], v18 offset:30720
    v_mfma_f32_16x16x32_bf16 v[34:37], v[62:65], v[62:65], v[34:37]
    ds_read_b64_tr_b16 v[70:71], v12 offset:28672
    ds_read_b64_tr_b16 v[72:73], v12 offset:28928
    v_mfma_f32_16x16x32_bf16 v[30:33], v[22:25], v[66:69], v[30:33]
    ds_read_b64_tr_b16 v[74:75], v13 offset:28672
    ds_read_b64_tr_b16 v[76:77], v13 offset:28928
    v_mfma_f32_16x16x32_bf16 v[38:41], v[66:69], v[66:69], v[38:41]
    ds_read_b64_tr_b16 v[78:79], v12 offset:30720
    ds_read_b64_tr_b16 v[80:81], v12 offset:30976
    v_mfma_f32_16x16x32_bf16 v[118:121], v[94:97], v[62:65], v[118:121]
    ds_read_b64_tr_b16 v[82:83], v13 offset:30720
    ds_read_b64_tr_b16 v[84:85], v13 offset:30976
    v_mfma_f32_16x16x32_bf16 v[142:145], v[94:97], v[66:69], v[142:145]
    ds_read_b64_tr_b16 v[86:87], v12 offset:32768
    ds_read_b64_tr_b16 v[88:89], v12 offset:33024
    v_mfma_f32_16x16x32_bf16 v[122:125], v[98:101], v[62:65], v[122:125]
    ds_read_b64_tr_b16 v[90:91], v13 offset:32768
    ds_read_b64_tr_b16 v[92:93], v13 offset:33024
    v_mfma_f32_16x16x32_bf16 v[146:149], v[98:101], v[66:69], v[146:149]
    v_mfma_f32_16x16x32_bf16 v[126:129], v[102:105], v[62:65], v[126:129]
    v_mfma_f32_16x16x32_bf16 v[150:153], v[102:105], v[66:69], v[150:153]
    v_mfma_f32_16x16x32_bf16 v[130:133], v[106:109], v[62:65], v[130:133]
    v_mfma_f32_16x16x32_bf16 v[154:157], v[106:109], v[66:69], v[154:157]
    v_mfma_f32_16x16x32_bf16 v[134:137], v[110:113], v[62:65], v[134:137]
    v_mfma_f32_16x16x32_bf16 v[158:161], v[110:113], v[66:69], v[158:161]
    v_mfma_f32_16x16x32_bf16 v[138:141], v[114:117], v[62:65], v[138:141]
    v_mfma_f32_16x16x32_bf16 v[162:165], v[114:117], v[66:69], v[162:165]
    s_waitcnt lgkmcnt(0)
    v_mfma_f32_16x16x32_bf16 v[26:29], v[22:25], v[54:57], v[26:29]
    ds_read_b128 v[62:65], v19 offset:28672
    ds_read_b128 v[66:69], v19 offset:30720
    v_mfma_f32_16x16x32_bf16 v[34:37], v[54:57], v[54:57], v[34:37]
    ds_read_b64_tr_b16 v[94:95], v12 offset:34816
    ds_read_b64_tr_b16 v[96:97], v12 offset:35072
    v_mfma_f32_16x16x32_bf16 v[30:33], v[22:25], v[58:61], v[30:33]
    ds_read_b64_tr_b16 v[98:99], v13 offset:34816
    ds_read_b64_tr_b16 v[100:101], v13 offset:35072
    v_mfma_f32_16x16x32_bf16 v[38:41], v[58:61], v[58:61], v[38:41]
    ds_read_b64_tr_b16 v[102:103], v12 offset:36864
    ds_read_b64_tr_b16 v[104:105], v12 offset:37120
    v_mfma_f32_16x16x32_bf16 v[118:121], v[70:73], v[54:57], v[118:121]
    ds_read_b64_tr_b16 v[106:107], v13 offset:36864
    ds_read_b64_tr_b16 v[108:109], v13 offset:37120
    v_mfma_f32_16x16x32_bf16 v[142:145], v[70:73], v[58:61], v[142:145]
    ds_read_b64_tr_b16 v[110:111], v12 offset:38912
    ds_read_b64_tr_b16 v[112:113], v12 offset:39168
    v_mfma_f32_16x16x32_bf16 v[122:125], v[74:77], v[54:57], v[122:125]
    ds_read_b64_tr_b16 v[114:115], v13 offset:38912
    ds_read_b64_tr_b16 v[116:117], v13 offset:39168
    v_mfma_f32_16x16x32_bf16 v[146:149], v[74:77], v[58:61], v[146:149]
    v_mfma_f32_16x16x32_bf16 v[126:129], v[78:81], v[54:57], v[126:129]
    v_mfma_f32_16x16x32_bf16 v[150:153], v[78:81], v[58:61], v[150:153]
    v_mfma_f32_16x16x32_bf16 v[130:133], v[82:85], v[54:57], v[130:133]
    v_mfma_f32_16x16x32_bf16 v[154:157], v[82:85], v[58:61], v[154:157]
    v_mfma_f32_16x16x32_bf16 v[134:137], v[86:89], v[54:57], v[134:137]
    v_mfma_f32_16x16x32_bf16 v[158:161], v[86:89], v[58:61], v[158:161]
    v_mfma_f32_16x16x32_bf16 v[138:141], v[90:93], v[54:57], v[138:141]
    v_mfma_f32_16x16x32_bf16 v[162:165], v[90:93], v[58:61], v[162:165]
    s_waitcnt lgkmcnt(0)
    s_barrier
    v_mfma_f32_16x16x32_bf16 v[26:29], v[22:25], v[62:65], v[26:29]
    ds_read_b128 v[54:57], v20 offset:0
    ds_read_b128 v[58:61], v20 offset:2048
    v_mfma_f32_16x16x32_bf16 v[34:37], v[62:65], v[62:65], v[34:37]
    ds_read_b64_tr_b16 v[70:71], v14 offset:0
    ds_read_b64_tr_b16 v[72:73], v14 offset:256
    v_mfma_f32_16x16x32_bf16 v[30:33], v[22:25], v[66:69], v[30:33]
    ds_read_b64_tr_b16 v[74:75], v15 offset:0
    ds_read_b64_tr_b16 v[76:77], v15 offset:256
    v_mfma_f32_16x16x32_bf16 v[38:41], v[66:69], v[66:69], v[38:41]
    ds_read_b64_tr_b16 v[78:79], v14 offset:2048
    ds_read_b64_tr_b16 v[80:81], v14 offset:2304
    v_mfma_f32_16x16x32_bf16 v[118:121], v[94:97], v[62:65], v[118:121]
    ds_read_b64_tr_b16 v[82:83], v15 offset:2048
    ds_read_b64_tr_b16 v[84:85], v15 offset:2304
    v_mfma_f32_16x16x32_bf16 v[142:145], v[94:97], v[66:69], v[142:145]
    ds_read_b64_tr_b16 v[86:87], v14 offset:4096
    ds_read_b64_tr_b16 v[88:89], v14 offset:4352
    v_mfma_f32_16x16x32_bf16 v[122:125], v[98:101], v[62:65], v[122:125]
    ds_read_b64_tr_b16 v[90:91], v15 offset:4096
    ds_read_b64_tr_b16 v[92:93], v15 offset:4352
    v_mfma_f32_16x16x32_bf16 v[146:149], v[98:101], v[66:69], v[146:149]
    v_mfma_f32_16x16x32_bf16 v[126:129], v[102:105], v[62:65], v[126:129]
    v_mfma_f32_16x16x32_bf16 v[150:153], v[102:105], v[66:69], v[150:153]
    v_mfma_f32_16x16x32_bf16 v[130:133], v[106:109], v[62:65], v[130:133]
    v_mfma_f32_16x16x32_bf16 v[154:157], v[106:109], v[66:69], v[154:157]
    v_mfma_f32_16x16x32_bf16 v[134:137], v[110:113], v[62:65], v[134:137]
    v_mfma_f32_16x16x32_bf16 v[158:161], v[110:113], v[66:69], v[158:161]
    v_mfma_f32_16x16x32_bf16 v[138:141], v[114:117], v[62:65], v[138:141]
    v_mfma_f32_16x16x32_bf16 v[162:165], v[114:117], v[66:69], v[162:165]
    s_waitcnt lgkmcnt(0)
    v_mfma_f32_16x16x32_bf16 v[26:29], v[22:25], v[54:57], v[26:29]
    ds_read_b128 v[62:65], v21 offset:0
    ds_read_b128 v[66:69], v21 offset:2048
    v_mfma_f32_16x16x32_bf16 v[34:37], v[54:57], v[54:57], v[34:37]
    ds_read_b64_tr_b16 v[94:95], v14 offset:6144
    ds_read_b64_tr_b16 v[96:97], v14 offset:6400
    v_mfma_f32_16x16x32_bf16 v[30:33], v[22:25], v[58:61], v[30:33]
    ds_read_b64_tr_b16 v[98:99], v15 offset:6144
    ds_read_b64_tr_b16 v[100:101], v15 offset:6400
    v_mfma_f32_16x16x32_bf16 v[38:41], v[58:61], v[58:61], v[38:41]
    ds_read_b64_tr_b16 v[102:103], v14 offset:8192
    ds_read_b64_tr_b16 v[104:105], v14 offset:8448
    v_mfma_f32_16x16x32_bf16 v[118:121], v[70:73], v[54:57], v[118:121]
    ds_read_b64_tr_b16 v[106:107], v15 offset:8192
    ds_read_b64_tr_b16 v[108:109], v15 offset:8448
    v_mfma_f32_16x16x32_bf16 v[142:145], v[70:73], v[58:61], v[142:145]
    ds_read_b64_tr_b16 v[110:111], v14 offset:10240
    ds_read_b64_tr_b16 v[112:113], v14 offset:10496
    v_mfma_f32_16x16x32_bf16 v[122:125], v[74:77], v[54:57], v[122:125]
    ds_read_b64_tr_b16 v[114:115], v15 offset:10240
    ds_read_b64_tr_b16 v[116:117], v15 offset:10496
    v_mfma_f32_16x16x32_bf16 v[146:149], v[74:77], v[58:61], v[146:149]
    v_mfma_f32_16x16x32_bf16 v[126:129], v[78:81], v[54:57], v[126:129]
    v_mfma_f32_16x16x32_bf16 v[150:153], v[78:81], v[58:61], v[150:153]
    v_mfma_f32_16x16x32_bf16 v[130:133], v[82:85], v[54:57], v[130:133]
    v_mfma_f32_16x16x32_bf16 v[154:157], v[82:85], v[58:61], v[154:157]
    v_mfma_f32_16x16x32_bf16 v[134:137], v[86:89], v[54:57], v[134:137]
    v_mfma_f32_16x16x32_bf16 v[158:161], v[86:89], v[58:61], v[158:161]
    v_mfma_f32_16x16x32_bf16 v[138:141], v[90:93], v[54:57], v[138:141]
    v_mfma_f32_16x16x32_bf16 v[162:165], v[90:93], v[58:61], v[162:165]
    s_waitcnt lgkmcnt(0)
    s_barrier
    v_mfma_f32_16x16x32_bf16 v[26:29], v[22:25], v[62:65], v[26:29]
    ds_read_b128 v[54:57], v16 offset:0
    ds_read_b128 v[58:61], v16 offset:2048
    v_mfma_f32_16x16x32_bf16 v[34:37], v[62:65], v[62:65], v[34:37]
    ds_read_b64_tr_b16 v[70:71], v10 offset:0
    ds_read_b64_tr_b16 v[72:73], v10 offset:256
    v_mfma_f32_16x16x32_bf16 v[30:33], v[22:25], v[66:69], v[30:33]
    ds_read_b64_tr_b16 v[74:75], v11 offset:0
    ds_read_b64_tr_b16 v[76:77], v11 offset:256
    v_mfma_f32_16x16x32_bf16 v[38:41], v[66:69], v[66:69], v[38:41]
    ds_read_b64_tr_b16 v[78:79], v10 offset:2048
    ds_read_b64_tr_b16 v[80:81], v10 offset:2304
    v_mfma_f32_16x16x32_bf16 v[118:121], v[94:97], v[62:65], v[118:121]
    ds_read_b64_tr_b16 v[82:83], v11 offset:2048
    ds_read_b64_tr_b16 v[84:85], v11 offset:2304
    v_mfma_f32_16x16x32_bf16 v[142:145], v[94:97], v[66:69], v[142:145]
    ds_read_b64_tr_b16 v[86:87], v10 offset:4096
    ds_read_b64_tr_b16 v[88:89], v10 offset:4352
    v_mfma_f32_16x16x32_bf16 v[122:125], v[98:101], v[62:65], v[122:125]
    ds_read_b64_tr_b16 v[90:91], v11 offset:4096
    ds_read_b64_tr_b16 v[92:93], v11 offset:4352
    v_mfma_f32_16x16x32_bf16 v[146:149], v[98:101], v[66:69], v[146:149]
    v_mfma_f32_16x16x32_bf16 v[126:129], v[102:105], v[62:65], v[126:129]
    v_mfma_f32_16x16x32_bf16 v[150:153], v[102:105], v[66:69], v[150:153]
    v_mfma_f32_16x16x32_bf16 v[130:133], v[106:109], v[62:65], v[130:133]
    v_mfma_f32_16x16x32_bf16 v[154:157], v[106:109], v[66:69], v[154:157]
    v_mfma_f32_16x16x32_bf16 v[134:137], v[110:113], v[62:65], v[134:137]
    v_mfma_f32_16x16x32_bf16 v[158:161], v[110:113], v[66:69], v[158:161]
    v_mfma_f32_16x16x32_bf16 v[138:141], v[114:117], v[62:65], v[138:141]
    v_mfma_f32_16x16x32_bf16 v[162:165], v[114:117], v[66:69], v[162:165]
    s_waitcnt lgkmcnt(0)
    v_mfma_f32_16x16x32_bf16 v[26:29], v[22:25], v[54:57], v[26:29]
    ds_read_b128 v[62:65], v17 offset:0
    ds_read_b128 v[66:69], v17 offset:2048
    v_mfma_f32_16x16x32_bf16 v[34:37], v[54:57], v[54:57], v[34:37]
    ds_read_b64_tr_b16 v[94:95], v10 offset:6144
    ds_read_b64_tr_b16 v[96:97], v10 offset:6400
    v_mfma_f32_16x16x32_bf16 v[30:33], v[22:25], v[58:61], v[30:33]
    ds_read_b64_tr_b16 v[98:99], v11 offset:6144
    ds_read_b64_tr_b16 v[100:101], v11 offset:6400
    v_mfma_f32_16x16x32_bf16 v[38:41], v[58:61], v[58:61], v[38:41]
    ds_read_b64_tr_b16 v[102:103], v10 offset:8192
    ds_read_b64_tr_b16 v[104:105], v10 offset:8448
    v_mfma_f32_16x16x32_bf16 v[118:121], v[70:73], v[54:57], v[118:121]
    ds_read_b64_tr_b16 v[106:107], v11 offset:8192
    ds_read_b64_tr_b16 v[108:109], v11 offset:8448
    v_mfma_f32_16x16x32_bf16 v[142:145], v[70:73], v[58:61], v[142:145]
    ds_read_b64_tr_b16 v[110:111], v10 offset:10240
    ds_read_b64_tr_b16 v[112:113], v10 offset:10496
    v_mfma_f32_16x16x32_bf16 v[122:125], v[74:77], v[54:57], v[122:125]
    ds_read_b64_tr_b16 v[114:115], v11 offset:10240
    ds_read_b64_tr_b16 v[116:117], v11 offset:10496
    v_mfma_f32_16x16x32_bf16 v[146:149], v[74:77], v[58:61], v[146:149]
    v_mfma_f32_16x16x32_bf16 v[126:129], v[78:81], v[54:57], v[126:129]
    v_mfma_f32_16x16x32_bf16 v[150:153], v[78:81], v[58:61], v[150:153]
    v_mfma_f32_16x16x32_bf16 v[130:133], v[82:85], v[54:57], v[130:133]
    v_mfma_f32_16x16x32_bf16 v[154:157], v[82:85], v[58:61], v[154:157]
    v_mfma_f32_16x16x32_bf16 v[134:137], v[86:89], v[54:57], v[134:137]
    v_mfma_f32_16x16x32_bf16 v[158:161], v[86:89], v[58:61], v[158:161]
    v_mfma_f32_16x16x32_bf16 v[138:141], v[90:93], v[54:57], v[138:141]
    v_mfma_f32_16x16x32_bf16 v[162:165], v[90:93], v[58:61], v[162:165]
    s_waitcnt lgkmcnt(0)
    s_barrier
    v_mfma_f32_16x16x32_bf16 v[26:29], v[22:25], v[62:65], v[26:29]
    ds_read_b128 v[54:57], v16 offset:28672
    ds_read_b128 v[58:61], v16 offset:30720
    v_mfma_f32_16x16x32_bf16 v[34:37], v[62:65], v[62:65], v[34:37]
    ds_read_b64_tr_b16 v[70:71], v10 offset:28672
    ds_read_b64_tr_b16 v[72:73], v10 offset:28928
    v_mfma_f32_16x16x32_bf16 v[30:33], v[22:25], v[66:69], v[30:33]
    ds_read_b64_tr_b16 v[74:75], v11 offset:28672
    ds_read_b64_tr_b16 v[76:77], v11 offset:28928
    v_mfma_f32_16x16x32_bf16 v[38:41], v[66:69], v[66:69], v[38:41]
    ds_read_b64_tr_b16 v[78:79], v10 offset:30720
    ds_read_b64_tr_b16 v[80:81], v10 offset:30976
    v_mfma_f32_16x16x32_bf16 v[118:121], v[94:97], v[62:65], v[118:121]
    ds_read_b64_tr_b16 v[82:83], v11 offset:30720
    ds_read_b64_tr_b16 v[84:85], v11 offset:30976
    v_mfma_f32_16x16x32_bf16 v[142:145], v[94:97], v[66:69], v[142:145]
    ds_read_b64_tr_b16 v[86:87], v10 offset:32768
    ds_read_b64_tr_b16 v[88:89], v10 offset:33024
    v_mfma_f32_16x16x32_bf16 v[122:125], v[98:101], v[62:65], v[122:125]
    ds_read_b64_tr_b16 v[90:91], v11 offset:32768
    ds_read_b64_tr_b16 v[92:93], v11 offset:33024
    v_mfma_f32_16x16x32_bf16 v[146:149], v[98:101], v[66:69], v[146:149]
    v_mfma_f32_16x16x32_bf16 v[126:129], v[102:105], v[62:65], v[126:129]
    v_mfma_f32_16x16x32_bf16 v[150:153], v[102:105], v[66:69], v[150:153]
    v_mfma_f32_16x16x32_bf16 v[130:133], v[106:109], v[62:65], v[130:133]
    v_mfma_f32_16x16x32_bf16 v[154:157], v[106:109], v[66:69], v[154:157]
    v_mfma_f32_16x16x32_bf16 v[134:137], v[110:113], v[62:65], v[134:137]
    v_mfma_f32_16x16x32_bf16 v[158:161], v[110:113], v[66:69], v[158:161]
    v_mfma_f32_16x16x32_bf16 v[138:141], v[114:117], v[62:65], v[138:141]
    v_mfma_f32_16x16x32_bf16 v[162:165], v[114:117], v[66:69], v[162:165]
    s_waitcnt lgkmcnt(0)
    v_mfma_f32_16x16x32_bf16 v[26:29], v[22:25], v[54:57], v[26:29]
    ds_read_b128 v[62:65], v17 offset:28672
    ds_read_b128 v[66:69], v17 offset:30720
    v_mfma_f32_16x16x32_bf16 v[34:37], v[54:57], v[54:57], v[34:37]
    ds_read_b64_tr_b16 v[94:95], v10 offset:34816
    ds_read_b64_tr_b16 v[96:97], v10 offset:35072
    v_mfma_f32_16x16x32_bf16 v[30:33], v[22:25], v[58:61], v[30:33]
    ds_read_b64_tr_b16 v[98:99], v11 offset:34816
    ds_read_b64_tr_b16 v[100:101], v11 offset:35072
    v_mfma_f32_16x16x32_bf16 v[38:41], v[58:61], v[58:61], v[38:41]
    ds_read_b64_tr_b16 v[102:103], v10 offset:36864
    ds_read_b64_tr_b16 v[104:105], v10 offset:37120
    v_mfma_f32_16x16x32_bf16 v[118:121], v[70:73], v[54:57], v[118:121]
    ds_read_b64_tr_b16 v[106:107], v11 offset:36864
    ds_read_b64_tr_b16 v[108:109], v11 offset:37120
    v_mfma_f32_16x16x32_bf16 v[142:145], v[70:73], v[58:61], v[142:145]
    ds_read_b64_tr_b16 v[110:111], v10 offset:38912
    ds_read_b64_tr_b16 v[112:113], v10 offset:39168
    v_mfma_f32_16x16x32_bf16 v[122:125], v[74:77], v[54:57], v[122:125]
    ds_read_b64_tr_b16 v[114:115], v11 offset:38912
    ds_read_b64_tr_b16 v[116:117], v11 offset:39168
    v_mfma_f32_16x16x32_bf16 v[146:149], v[74:77], v[58:61], v[146:149]
    v_mfma_f32_16x16x32_bf16 v[126:129], v[78:81], v[54:57], v[126:129]
    v_mfma_f32_16x16x32_bf16 v[150:153], v[78:81], v[58:61], v[150:153]
    v_mfma_f32_16x16x32_bf16 v[130:133], v[82:85], v[54:57], v[130:133]
    v_mfma_f32_16x16x32_bf16 v[154:157], v[82:85], v[58:61], v[154:157]
    v_mfma_f32_16x16x32_bf16 v[134:137], v[86:89], v[54:57], v[134:137]
    v_mfma_f32_16x16x32_bf16 v[158:161], v[86:89], v[58:61], v[158:161]
    v_mfma_f32_16x16x32_bf16 v[138:141], v[90:93], v[54:57], v[138:141]
    v_mfma_f32_16x16x32_bf16 v[162:165], v[90:93], v[58:61], v[162:165]
    s_waitcnt lgkmcnt(0)
    s_barrier
    v_mfma_f32_16x16x32_bf16 v[26:29], v[22:25], v[62:65], v[26:29]
    ds_read_b128 v[54:57], v18 offset:0
    ds_read_b128 v[58:61], v18 offset:2048
    v_mfma_f32_16x16x32_bf16 v[34:37], v[62:65], v[62:65], v[34:37]
    ds_read_b64_tr_b16 v[70:71], v12 offset:0
    ds_read_b64_tr_b16 v[72:73], v12 offset:256
    v_mfma_f32_16x16x32_bf16 v[30:33], v[22:25], v[66:69], v[30:33]
    ds_read_b64_tr_b16 v[74:75], v13 offset:0
    ds_read_b64_tr_b16 v[76:77], v13 offset:256
    v_mfma_f32_16x16x32_bf16 v[38:41], v[66:69], v[66:69], v[38:41]
    ds_read_b64_tr_b16 v[78:79], v12 offset:2048
    ds_read_b64_tr_b16 v[80:81], v12 offset:2304
    v_mfma_f32_16x16x32_bf16 v[118:121], v[94:97], v[62:65], v[118:121]
    ds_read_b64_tr_b16 v[82:83], v13 offset:2048
    ds_read_b64_tr_b16 v[84:85], v13 offset:2304
    v_mfma_f32_16x16x32_bf16 v[142:145], v[94:97], v[66:69], v[142:145]
    ds_read_b64_tr_b16 v[86:87], v12 offset:4096
    ds_read_b64_tr_b16 v[88:89], v12 offset:4352
    v_mfma_f32_16x16x32_bf16 v[122:125], v[98:101], v[62:65], v[122:125]
    ds_read_b64_tr_b16 v[90:91], v13 offset:4096
    ds_read_b64_tr_b16 v[92:93], v13 offset:4352
    v_mfma_f32_16x16x32_bf16 v[146:149], v[98:101], v[66:69], v[146:149]
    v_mfma_f32_16x16x32_bf16 v[126:129], v[102:105], v[62:65], v[126:129]
    v_mfma_f32_16x16x32_bf16 v[150:153], v[102:105], v[66:69], v[150:153]
    v_mfma_f32_16x16x32_bf16 v[130:133], v[106:109], v[62:65], v[130:133]
    v_mfma_f32_16x16x32_bf16 v[154:157], v[106:109], v[66:69], v[154:157]
    v_mfma_f32_16x16x32_bf16 v[134:137], v[110:113], v[62:65], v[134:137]
    v_mfma_f32_16x16x32_bf16 v[158:161], v[110:113], v[66:69], v[158:161]
    v_mfma_f32_16x16x32_bf16 v[138:141], v[114:117], v[62:65], v[138:141]
    v_mfma_f32_16x16x32_bf16 v[162:165], v[114:117], v[66:69], v[162:165]
    s_waitcnt lgkmcnt(0)
    v_mfma_f32_16x16x32_bf16 v[26:29], v[22:25], v[54:57], v[26:29]
    ds_read_b128 v[62:65], v19 offset:0
    ds_read_b128 v[66:69], v19 offset:2048
    v_mfma_f32_16x16x32_bf16 v[34:37], v[54:57], v[54:57], v[34:37]
    ds_read_b64_tr_b16 v[94:95], v12 offset:6144
    ds_read_b64_tr_b16 v[96:97], v12 offset:6400
    v_mfma_f32_16x16x32_bf16 v[30:33], v[22:25], v[58:61], v[30:33]
    ds_read_b64_tr_b16 v[98:99], v13 offset:6144
    ds_read_b64_tr_b16 v[100:101], v13 offset:6400
    v_mfma_f32_16x16x32_bf16 v[38:41], v[58:61], v[58:61], v[38:41]
    ds_read_b64_tr_b16 v[102:103], v12 offset:8192
    ds_read_b64_tr_b16 v[104:105], v12 offset:8448
    v_mfma_f32_16x16x32_bf16 v[118:121], v[70:73], v[54:57], v[118:121]
    ds_read_b64_tr_b16 v[106:107], v13 offset:8192
    ds_read_b64_tr_b16 v[108:109], v13 offset:8448
    v_mfma_f32_16x16x32_bf16 v[142:145], v[70:73], v[58:61], v[142:145]
    ds_read_b64_tr_b16 v[110:111], v12 offset:10240
    ds_read_b64_tr_b16 v[112:113], v12 offset:10496
    v_mfma_f32_16x16x32_bf16 v[122:125], v[74:77], v[54:57], v[122:125]
    ds_read_b64_tr_b16 v[114:115], v13 offset:10240
    ds_read_b64_tr_b16 v[116:117], v13 offset:10496
    v_mfma_f32_16x16x32_bf16 v[146:149], v[74:77], v[58:61], v[146:149]
    v_mfma_f32_16x16x32_bf16 v[126:129], v[78:81], v[54:57], v[126:129]
    v_mfma_f32_16x16x32_bf16 v[150:153], v[78:81], v[58:61], v[150:153]
    v_mfma_f32_16x16x32_bf16 v[130:133], v[82:85], v[54:57], v[130:133]
    v_mfma_f32_16x16x32_bf16 v[154:157], v[82:85], v[58:61], v[154:157]
    v_mfma_f32_16x16x32_bf16 v[134:137], v[86:89], v[54:57], v[134:137]
    v_mfma_f32_16x16x32_bf16 v[158:161], v[86:89], v[58:61], v[158:161]
    v_mfma_f32_16x16x32_bf16 v[138:141], v[90:93], v[54:57], v[138:141]
    v_mfma_f32_16x16x32_bf16 v[162:165], v[90:93], v[58:61], v[162:165]
    s_waitcnt lgkmcnt(12)
    v_mfma_f32_16x16x32_bf16 v[26:29], v[22:25], v[62:65], v[26:29]
    v_mfma_f32_16x16x32_bf16 v[34:37], v[62:65], v[62:65], v[34:37]
    v_mfma_f32_16x16x32_bf16 v[30:33], v[22:25], v[66:69], v[30:33]
    v_mfma_f32_16x16x32_bf16 v[38:41], v[66:69], v[66:69], v[38:41]
    s_waitcnt lgkmcnt(0)
    s_barrier
    v_mfma_f32_16x16x32_bf16 v[118:121], v[94:97], v[62:65], v[118:121]
    s_mov_b32 s40, 0x100001
    s_mov_b32 s41, 0x10000100
    s_mov_b32 s42, 0x200002
    s_mov_b32 s43, 0x20000200
    s_mov_b32 s44, 0x400004
    s_mov_b32 s45, 0x40000400
    v_mfma_f32_16x16x32_bf16 v[142:145], v[94:97], v[66:69], v[142:145]
    s_mov_b32 s46, 0x800008
    s_mov_b32 s47, 0x80000800
    ds_read_b128 v[166:169], v206 offset:0
    ds_read_b128 v[70:73], v206 offset:384
    ds_read_b128 v[170:173], v206 offset:64
    ds_read_b128 v[74:77], v206 offset:448
    v_mfma_f32_16x16x32_bf16 v[122:125], v[98:101], v[62:65], v[122:125]
    v_mov_b32 v42, 0
    v_mov_b32 v44, 0
    v_cndmask_b32_e64 v42, v42, v34, s[40:41]
    v_cndmask_b32_e64 v44, v44, v38, s[40:41]
    v_cndmask_b32_e64 v42, v42, v35, s[42:43]
    v_cndmask_b32_e64 v44, v44, v39, s[42:43]
    v_mfma_f32_16x16x32_bf16 v[146:149], v[98:101], v[66:69], v[146:149]
    v_cndmask_b32_e64 v42, v42, v36, s[44:45]
    v_cndmask_b32_e64 v44, v44, v40, s[44:45]
    v_cndmask_b32_e64 v42, v42, v37, s[46:47]
    v_cndmask_b32_e64 v44, v44, v41, s[46:47]
    v_mov_b32 v43, v42
    v_mov_b32 v45, v44
    v_mfma_f32_16x16x32_bf16 v[126:129], v[102:105], v[62:65], v[126:129]
    ds_read_b128 v[174:177], v206 offset:128
    ds_read_b128 v[78:81], v206 offset:512
    ds_read_b128 v[178:181], v206 offset:192
    ds_read_b128 v[82:85], v206 offset:576
    v_permlane32_swap_b32 v42, v43
    v_permlane32_swap_b32 v44, v45
    v_mfma_f32_16x16x32_bf16 v[150:153], v[102:105], v[66:69], v[150:153]
    v_add_f32 v42, v42, v43
    v_add_f32 v44, v44, v45
    v_mov_b32 v43, v42
    v_mov_b32 v45, v44
    s_nop 0
    v_permlane16_swap_b32 v42, v43
    v_permlane16_swap_b32 v44, v45
    v_mfma_f32_16x16x32_bf16 v[130:133], v[106:109], v[62:65], v[130:133]
    v_add_f32 v42, v42, v43
    v_add_f32 v44, v44, v45
    v_mul_f32 v50, 0x3b000000, v26
    v_mul_f32 v51, 0x3b000000, v30
    ds_read_b128 v[182:185], v206 offset:256
    ds_read_b128 v[86:89], v206 offset:640
    v_mfma_f32_16x16x32_bf16 v[154:157], v[106:109], v[66:69], v[154:157]
    ds_read_b128 v[186:189], v206 offset:320
    ds_read_b128 v[90:93], v206 offset:704
    v_mul_f32 v52, 0x3b000000, v42
    v_mul_f32 v53, 0x3b000000, v44
    v_fma_f32 v52, -v50, v50, v52
    v_fma_f32 v53, -v51, v51, v53
    v_mfma_f32_16x16x32_bf16 v[134:137], v[110:113], v[62:65], v[134:137]
    v_max_f32 v52, 0, v52
    v_max_f32 v53, 0, v53
    v_cvt_pk_bf16_f32 v42, v50, v52
    v_cvt_pk_bf16_f32 v44, v51, v53
    v_lshlrev_b32 v50, 16, v42
    v_lshlrev_b32 v51, 16, v44
    v_mfma_f32_16x16x32_bf16 v[158:161], v[110:113], v[66:69], v[158:161]
    v_and_b32 v52, 0xffff0000, v42
    v_and_b32 v53, 0xffff0000, v44
    v_add_f32 v52, 0x3727c5ac, v52
    v_add_f32 v53, 0x3727c5ac, v53
    v_cvt_pk_bf16_f32 v42, v52, v52
    v_cvt_pk_bf16_f32 v44, v53, v53
    v_mfma_f32_16x16x32_bf16 v[138:141], v[114:117], v[62:65], v[138:141]
    v_lshlrev_b32 v52, 16, v42
    v_lshlrev_b32 v53, 16, v44
    v_sqrt_f32 v52, v52
    v_sqrt_f32 v53, v53
    v_cvt_pk_bf16_f32 v42, v52, v52
    v_cvt_pk_bf16_f32 v44, v53, v53
    v_mfma_f32_16x16x32_bf16 v[162:165], v[114:117], v[66:69], v[162:165]
    v_lshlrev_b32 v52, 16, v42
    v_lshlrev_b32 v53, 16, v44
    v_rcp_f32 v52, v52
    v_rcp_f32 v53, v53
    s_waitcnt lgkmcnt(0)
    v_pk_add_f32 v[166:167], v[166:167], v[70:71]
    v_pk_add_f32 v[168:169], v[168:169], v[72:73]
    v_pk_add_f32 v[170:171], v[170:171], v[74:75]
    v_pk_add_f32 v[172:173], v[172:173], v[76:77]
    v_pk_add_f32 v[174:175], v[174:175], v[78:79]
    v_pk_add_f32 v[176:177], v[176:177], v[80:81]
    v_pk_add_f32 v[178:179], v[178:179], v[82:83]
    v_pk_add_f32 v[180:181], v[180:181], v[84:85]
    v_pk_add_f32 v[182:183], v[182:183], v[86:87]
    v_pk_add_f32 v[184:185], v[184:185], v[88:89]
    v_pk_add_f32 v[186:187], v[186:187], v[90:91]
    v_pk_add_f32 v[188:189], v[188:189], v[92:93]
    s_add_u32 s29, s28, 0
    v_pk_fma_f32 v[118:119], v[166:167], v[50:51], v[118:119] op_sel:[0,0,0] op_sel_hi:[1,0,1] neg_lo:[0,1,0] neg_hi:[0,1,0]
    v_pk_fma_f32 v[120:121], v[168:169], v[50:51], v[120:121] op_sel:[0,0,0] op_sel_hi:[1,0,1] neg_lo:[0,1,0] neg_hi:[0,1,0]
    v_pk_mul_f32 v[118:119], v[118:119], v[52:53] op_sel:[0,0] op_sel_hi:[1,0]
    v_pk_mul_f32 v[120:121], v[120:121], v[52:53] op_sel:[0,0] op_sel_hi:[1,0]
    v_cvt_pk_bf16_f32 v118, v118, v119
    v_cvt_pk_bf16_f32 v119, v120, v121
    buffer_store_dwordx2 v[118:119], v8, s[32:35], s29 offen offset:0
    v_pk_fma_f32 v[142:143], v[166:167], v[50:51], v[142:143] op_sel:[0,1,0] op_sel_hi:[1,1,1] neg_lo:[0,1,0] neg_hi:[0,1,0]
    v_pk_fma_f32 v[144:145], v[168:169], v[50:51], v[144:145] op_sel:[0,1,0] op_sel_hi:[1,1,1] neg_lo:[0,1,0] neg_hi:[0,1,0]
    v_pk_mul_f32 v[142:143], v[142:143], v[52:53] op_sel:[0,1] op_sel_hi:[1,1]
    v_pk_mul_f32 v[144:145], v[144:145], v[52:53] op_sel:[0,1] op_sel_hi:[1,1]
    v_cvt_pk_bf16_f32 v142, v142, v143
    v_cvt_pk_bf16_f32 v143, v144, v145
    buffer_store_dwordx2 v[142:143], v8, s[32:35], s29 offen offset:512
    s_add_u32 s29, s28, 65536
    v_pk_fma_f32 v[122:123], v[170:171], v[50:51], v[122:123] op_sel:[0,0,0] op_sel_hi:[1,0,1] neg_lo:[0,1,0] neg_hi:[0,1,0]
    v_pk_fma_f32 v[124:125], v[172:173], v[50:51], v[124:125] op_sel:[0,0,0] op_sel_hi:[1,0,1] neg_lo:[0,1,0] neg_hi:[0,1,0]
    v_pk_mul_f32 v[122:123], v[122:123], v[52:53] op_sel:[0,0] op_sel_hi:[1,0]
    v_pk_mul_f32 v[124:125], v[124:125], v[52:53] op_sel:[0,0] op_sel_hi:[1,0]
    v_cvt_pk_bf16_f32 v122, v122, v123
    v_cvt_pk_bf16_f32 v123, v124, v125
    buffer_store_dwordx2 v[122:123], v8, s[32:35], s29 offen offset:0
    v_pk_fma_f32 v[146:147], v[170:171], v[50:51], v[146:147] op_sel:[0,1,0] op_sel_hi:[1,1,1] neg_lo:[0,1,0] neg_hi:[0,1,0]
    v_pk_fma_f32 v[148:149], v[172:173], v[50:51], v[148:149] op_sel:[0,1,0] op_sel_hi:[1,1,1] neg_lo:[0,1,0] neg_hi:[0,1,0]
    v_pk_mul_f32 v[146:147], v[146:147], v[52:53] op_sel:[0,1] op_sel_hi:[1,1]
    v_pk_mul_f32 v[148:149], v[148:149], v[52:53] op_sel:[0,1] op_sel_hi:[1,1]
    v_cvt_pk_bf16_f32 v146, v146, v147
    v_cvt_pk_bf16_f32 v147, v148, v149
    buffer_store_dwordx2 v[146:147], v8, s[32:35], s29 offen offset:512
    s_add_u32 s29, s28, 131072
    v_pk_fma_f32 v[126:127], v[174:175], v[50:51], v[126:127] op_sel:[0,0,0] op_sel_hi:[1,0,1] neg_lo:[0,1,0] neg_hi:[0,1,0]
    v_pk_fma_f32 v[128:129], v[176:177], v[50:51], v[128:129] op_sel:[0,0,0] op_sel_hi:[1,0,1] neg_lo:[0,1,0] neg_hi:[0,1,0]
    v_pk_mul_f32 v[126:127], v[126:127], v[52:53] op_sel:[0,0] op_sel_hi:[1,0]
    v_pk_mul_f32 v[128:129], v[128:129], v[52:53] op_sel:[0,0] op_sel_hi:[1,0]
    v_cvt_pk_bf16_f32 v126, v126, v127
    v_cvt_pk_bf16_f32 v127, v128, v129
    buffer_store_dwordx2 v[126:127], v8, s[32:35], s29 offen offset:0
    v_pk_fma_f32 v[150:151], v[174:175], v[50:51], v[150:151] op_sel:[0,1,0] op_sel_hi:[1,1,1] neg_lo:[0,1,0] neg_hi:[0,1,0]
    v_pk_fma_f32 v[152:153], v[176:177], v[50:51], v[152:153] op_sel:[0,1,0] op_sel_hi:[1,1,1] neg_lo:[0,1,0] neg_hi:[0,1,0]
    v_pk_mul_f32 v[150:151], v[150:151], v[52:53] op_sel:[0,1] op_sel_hi:[1,1]
    v_pk_mul_f32 v[152:153], v[152:153], v[52:53] op_sel:[0,1] op_sel_hi:[1,1]
    v_cvt_pk_bf16_f32 v150, v150, v151
    v_cvt_pk_bf16_f32 v151, v152, v153
    buffer_store_dwordx2 v[150:151], v8, s[32:35], s29 offen offset:512
    s_add_u32 s29, s28, 196608
    v_pk_fma_f32 v[130:131], v[178:179], v[50:51], v[130:131] op_sel:[0,0,0] op_sel_hi:[1,0,1] neg_lo:[0,1,0] neg_hi:[0,1,0]
    v_pk_fma_f32 v[132:133], v[180:181], v[50:51], v[132:133] op_sel:[0,0,0] op_sel_hi:[1,0,1] neg_lo:[0,1,0] neg_hi:[0,1,0]
    v_pk_mul_f32 v[130:131], v[130:131], v[52:53] op_sel:[0,0] op_sel_hi:[1,0]
    v_pk_mul_f32 v[132:133], v[132:133], v[52:53] op_sel:[0,0] op_sel_hi:[1,0]
    v_cvt_pk_bf16_f32 v130, v130, v131
    v_cvt_pk_bf16_f32 v131, v132, v133
    buffer_store_dwordx2 v[130:131], v8, s[32:35], s29 offen offset:0
    v_pk_fma_f32 v[154:155], v[178:179], v[50:51], v[154:155] op_sel:[0,1,0] op_sel_hi:[1,1,1] neg_lo:[0,1,0] neg_hi:[0,1,0]
    v_pk_fma_f32 v[156:157], v[180:181], v[50:51], v[156:157] op_sel:[0,1,0] op_sel_hi:[1,1,1] neg_lo:[0,1,0] neg_hi:[0,1,0]
    v_pk_mul_f32 v[154:155], v[154:155], v[52:53] op_sel:[0,1] op_sel_hi:[1,1]
    v_pk_mul_f32 v[156:157], v[156:157], v[52:53] op_sel:[0,1] op_sel_hi:[1,1]
    v_cvt_pk_bf16_f32 v154, v154, v155
    v_cvt_pk_bf16_f32 v155, v156, v157
    buffer_store_dwordx2 v[154:155], v8, s[32:35], s29 offen offset:512
    s_add_u32 s29, s28, 262144
    v_pk_fma_f32 v[134:135], v[182:183], v[50:51], v[134:135] op_sel:[0,0,0] op_sel_hi:[1,0,1] neg_lo:[0,1,0] neg_hi:[0,1,0]
    v_pk_fma_f32 v[136:137], v[184:185], v[50:51], v[136:137] op_sel:[0,0,0] op_sel_hi:[1,0,1] neg_lo:[0,1,0] neg_hi:[0,1,0]
    v_pk_mul_f32 v[134:135], v[134:135], v[52:53] op_sel:[0,0] op_sel_hi:[1,0]
    v_pk_mul_f32 v[136:137], v[136:137], v[52:53] op_sel:[0,0] op_sel_hi:[1,0]
    v_cvt_pk_bf16_f32 v134, v134, v135
    v_cvt_pk_bf16_f32 v135, v136, v137
    buffer_store_dwordx2 v[134:135], v8, s[32:35], s29 offen offset:0
    v_pk_fma_f32 v[158:159], v[182:183], v[50:51], v[158:159] op_sel:[0,1,0] op_sel_hi:[1,1,1] neg_lo:[0,1,0] neg_hi:[0,1,0]
    v_pk_fma_f32 v[160:161], v[184:185], v[50:51], v[160:161] op_sel:[0,1,0] op_sel_hi:[1,1,1] neg_lo:[0,1,0] neg_hi:[0,1,0]
    v_pk_mul_f32 v[158:159], v[158:159], v[52:53] op_sel:[0,1] op_sel_hi:[1,1]
    v_pk_mul_f32 v[160:161], v[160:161], v[52:53] op_sel:[0,1] op_sel_hi:[1,1]
    v_cvt_pk_bf16_f32 v158, v158, v159
    v_cvt_pk_bf16_f32 v159, v160, v161
    buffer_store_dwordx2 v[158:159], v8, s[32:35], s29 offen offset:512
    s_add_u32 s29, s28, 327680
    v_pk_fma_f32 v[138:139], v[186:187], v[50:51], v[138:139] op_sel:[0,0,0] op_sel_hi:[1,0,1] neg_lo:[0,1,0] neg_hi:[0,1,0]
    v_pk_fma_f32 v[140:141], v[188:189], v[50:51], v[140:141] op_sel:[0,0,0] op_sel_hi:[1,0,1] neg_lo:[0,1,0] neg_hi:[0,1,0]
    v_pk_mul_f32 v[138:139], v[138:139], v[52:53] op_sel:[0,0] op_sel_hi:[1,0]
    v_pk_mul_f32 v[140:141], v[140:141], v[52:53] op_sel:[0,0] op_sel_hi:[1,0]
    v_cvt_pk_bf16_f32 v138, v138, v139
    v_cvt_pk_bf16_f32 v139, v140, v141
    buffer_store_dwordx2 v[138:139], v8, s[32:35], s29 offen offset:0
    v_pk_fma_f32 v[162:163], v[186:187], v[50:51], v[162:163] op_sel:[0,1,0] op_sel_hi:[1,1,1] neg_lo:[0,1,0] neg_hi:[0,1,0]
    v_pk_fma_f32 v[164:165], v[188:189], v[50:51], v[164:165] op_sel:[0,1,0] op_sel_hi:[1,1,1] neg_lo:[0,1,0] neg_hi:[0,1,0]
    v_pk_mul_f32 v[162:163], v[162:163], v[52:53] op_sel:[0,1] op_sel_hi:[1,1]
    v_pk_mul_f32 v[164:165], v[164:165], v[52:53] op_sel:[0,1] op_sel_hi:[1,1]
    v_cvt_pk_bf16_f32 v162, v162, v163
    v_cvt_pk_bf16_f32 v163, v164, v165
    buffer_store_dwordx2 v[162:163], v8, s[32:35], s29 offen offset:512
    s_endpgm
J_K1_mix:
    s_nop 7
    s_nop 7
    s_barrier
    ds_read_b128 v[54:57], v16 offset:0
    ds_read_b128 v[58:61], v16 offset:2048
    ds_read_b64_tr_b16 v[70:71], v10 offset:0
    ds_read_b64_tr_b16 v[72:73], v10 offset:256
    ds_read_b64_tr_b16 v[74:75], v11 offset:0
    ds_read_b64_tr_b16 v[76:77], v11 offset:256
    ds_read_b64_tr_b16 v[78:79], v10 offset:2048
    ds_read_b64_tr_b16 v[80:81], v10 offset:2304
    ds_read_b64_tr_b16 v[82:83], v11 offset:2048
    ds_read_b64_tr_b16 v[84:85], v11 offset:2304
    ds_read_b64_tr_b16 v[86:87], v10 offset:4096
    ds_read_b64_tr_b16 v[88:89], v10 offset:4352
    ds_read_b64_tr_b16 v[90:91], v11 offset:4096
    ds_read_b64_tr_b16 v[92:93], v11 offset:4352
    s_waitcnt lgkmcnt(0)
    v_mfma_f32_16x16x32_bf16 v[26:29], v[22:25], v[54:57], 0
    ds_read_b128 v[62:65], v17 offset:0
    ds_read_b128 v[66:69], v17 offset:2048
    v_mfma_f32_16x16x32_bf16 v[34:37], v[54:57], v[54:57], 0
    ds_read_b64_tr_b16 v[94:95], v10 offset:6144
    ds_read_b64_tr_b16 v[96:97], v10 offset:6400
    v_mfma_f32_16x16x32_bf16 v[30:33], v[22:25], v[58:61], 0
    ds_read_b64_tr_b16 v[98:99], v11 offset:6144
    ds_read_b64_tr_b16 v[100:101], v11 offset:6400
    v_mfma_f32_16x16x32_bf16 v[38:41], v[58:61], v[58:61], 0
    ds_read_b64_tr_b16 v[102:103], v10 offset:8192
    ds_read_b64_tr_b16 v[104:105], v10 offset:8448
    v_mfma_f32_16x16x32_bf16 v[118:121], v[70:73], v[54:57], 0
    ds_read_b64_tr_b16 v[106:107], v11 offset:8192
    ds_read_b64_tr_b16 v[108:109], v11 offset:8448
    v_mfma_f32_16x16x32_bf16 v[142:145], v[70:73], v[58:61], 0
    ds_read_b64_tr_b16 v[110:111], v10 offset:10240
    ds_read_b64_tr_b16 v[112:113], v10 offset:10496
    v_mfma_f32_16x16x32_bf16 v[122:125], v[74:77], v[54:57], 0
    ds_read_b64_tr_b16 v[114:115], v11 offset:10240
    ds_read_b64_tr_b16 v[116:117], v11 offset:10496
    v_mfma_f32_16x16x32_bf16 v[146:149], v[74:77], v[58:61], 0
    v_mfma_f32_16x16x32_bf16 v[126:129], v[78:81], v[54:57], 0
    v_mfma_f32_16x16x32_bf16 v[150:153], v[78:81], v[58:61], 0
    v_mfma_f32_16x16x32_bf16 v[130:133], v[82:85], v[54:57], 0
    v_mfma_f32_16x16x32_bf16 v[154:157], v[82:85], v[58:61], 0
    v_mfma_f32_16x16x32_bf16 v[134:137], v[54:57], v[86:89], 0
    v_mfma_f32_16x16x32_bf16 v[158:161], v[58:61], v[86:89], 0
    v_mfma_f32_16x16x32_bf16 v[138:141], v[54:57], v[90:93], 0
    v_mfma_f32_16x16x32_bf16 v[162:165], v[58:61], v[90:93], 0
    s_waitcnt lgkmcnt(0)
    s_barrier
    v_mfma_f32_16x16x32_bf16 v[26:29], v[22:25], v[62:65], v[26:29]
    ds_read_b128 v[54:57], v16 offset:28672
    ds_read_b128 v[58:61], v16 offset:30720
    v_mfma_f32_16x16x32_bf16 v[34:37], v[62:65], v[62:65], v[34:37]
    ds_read_b64_tr_b16 v[70:71], v10 offset:28672
    ds_read_b64_tr_b16 v[72:73], v10 offset:28928
    v_mfma_f32_16x16x32_bf16 v[30:33], v[22:25], v[66:69], v[30:33]
    ds_read_b64_tr_b16 v[74:75], v11 offset:28672
    ds_read_b64_tr_b16 v[76:77], v11 offset:28928
    v_mfma_f32_16x16x32_bf16 v[38:41], v[66:69], v[66:69], v[38:41]
    ds_read_b64_tr_b16 v[78:79], v10 offset:30720
    ds_read_b64_tr_b16 v[80:81], v10 offset:30976
    v_mfma_f32_16x16x32_bf16 v[118:121], v[94:97], v[62:65], v[118:121]
    ds_read_b64_tr_b16 v[82:83], v11 offset:30720
    ds_read_b64_tr_b16 v[84:85], v11 offset:30976
    v_mfma_f32_16x16x32_bf16 v[142:145], v[94:97], v[66:69], v[142:145]
    ds_read_b64_tr_b16 v[86:87], v10 offset:32768
    ds_read_b64_tr_b16 v[88:89], v10 offset:33024
    v_mfma_f32_16x16x32_bf16 v[122:125], v[98:101], v[62:65], v[122:125]
    ds_read_b64_tr_b16 v[90:91], v11 offset:32768
    ds_read_b64_tr_b16 v[92:93], v11 offset:33024
    v_mfma_f32_16x16x32_bf16 v[146:149], v[98:101], v[66:69], v[146:149]
    v_mfma_f32_16x16x32_bf16 v[126:129], v[102:105], v[62:65], v[126:129]
    v_mfma_f32_16x16x32_bf16 v[150:153], v[102:105], v[66:69], v[150:153]
    v_mfma_f32_16x16x32_bf16 v[130:133], v[106:109], v[62:65], v[130:133]
    v_mfma_f32_16x16x32_bf16 v[154:157], v[106:109], v[66:69], v[154:157]
    v_mfma_f32_16x16x32_bf16 v[134:137], v[62:65], v[110:113], v[134:137]
    v_mfma_f32_16x16x32_bf16 v[158:161], v[66:69], v[110:113], v[158:161]
    v_mfma_f32_16x16x32_bf16 v[138:141], v[62:65], v[114:117], v[138:141]
    v_mfma_f32_16x16x32_bf16 v[162:165], v[66:69], v[114:117], v[162:165]
    s_waitcnt lgkmcnt(0)
    v_mfma_f32_16x16x32_bf16 v[26:29], v[22:25], v[54:57], v[26:29]
    ds_read_b128 v[62:65], v17 offset:28672
    ds_read_b128 v[66:69], v17 offset:30720
    v_mfma_f32_16x16x32_bf16 v[34:37], v[54:57], v[54:57], v[34:37]
    ds_read_b64_tr_b16 v[94:95], v10 offset:34816
    ds_read_b64_tr_b16 v[96:97], v10 offset:35072
    v_mfma_f32_16x16x32_bf16 v[30:33], v[22:25], v[58:61], v[30:33]
    ds_read_b64_tr_b16 v[98:99], v11 offset:34816
    ds_read_b64_tr_b16 v[100:101], v11 offset:35072
    v_mfma_f32_16x16x32_bf16 v[38:41], v[58:61], v[58:61], v[38:41]
    ds_read_b64_tr_b16 v[102:103], v10 offset:36864
    ds_read_b64_tr_b16 v[104:105], v10 offset:37120
    v_mfma_f32_16x16x32_bf16 v[118:121], v[70:73], v[54:57], v[118:121]
    ds_read_b64_tr_b16 v[106:107], v11 offset:36864
    ds_read_b64_tr_b16 v[108:109], v11 offset:37120
    v_mfma_f32_16x16x32_bf16 v[142:145], v[70:73], v[58:61], v[142:145]
    ds_read_b64_tr_b16 v[110:111], v10 offset:38912
    ds_read_b64_tr_b16 v[112:113], v10 offset:39168
    v_mfma_f32_16x16x32_bf16 v[122:125], v[74:77], v[54:57], v[122:125]
    ds_read_b64_tr_b16 v[114:115], v11 offset:38912
    ds_read_b64_tr_b16 v[116:117], v11 offset:39168
    v_mfma_f32_16x16x32_bf16 v[146:149], v[74:77], v[58:61], v[146:149]
    v_mfma_f32_16x16x32_bf16 v[126:129], v[78:81], v[54:57], v[126:129]
    v_mfma_f32_16x16x32_bf16 v[150:153], v[78:81], v[58:61], v[150:153]
    v_mfma_f32_16x16x32_bf16 v[130:133], v[82:85], v[54:57], v[130:133]
    v_mfma_f32_16x16x32_bf16 v[154:157], v[82:85], v[58:61], v[154:157]
    v_mfma_f32_16x16x32_bf16 v[134:137], v[54:57], v[86:89], v[134:137]
    v_mfma_f32_16x16x32_bf16 v[158:161], v[58:61], v[86:89], v[158:161]
    v_mfma_f32_16x16x32_bf16 v[138:141], v[54:57], v[90:93], v[138:141]
    v_mfma_f32_16x16x32_bf16 v[162:165], v[58:61], v[90:93], v[162:165]
    s_waitcnt lgkmcnt(0)
    s_barrier
    v_mfma_f32_16x16x32_bf16 v[26:29], v[22:25], v[62:65], v[26:29]
    ds_read_b128 v[54:57], v18 offset:0
    ds_read_b128 v[58:61], v18 offset:2048
    v_mfma_f32_16x16x32_bf16 v[34:37], v[62:65], v[62:65], v[34:37]
    ds_read_b64_tr_b16 v[70:71], v12 offset:0
    ds_read_b64_tr_b16 v[72:73], v12 offset:256
    v_mfma_f32_16x16x32_bf16 v[30:33], v[22:25], v[66:69], v[30:33]
    ds_read_b64_tr_b16 v[74:75], v13 offset:0
    ds_read_b64_tr_b16 v[76:77], v13 offset:256
    v_mfma_f32_16x16x32_bf16 v[38:41], v[66:69], v[66:69], v[38:41]
    ds_read_b64_tr_b16 v[78:79], v12 offset:2048
    ds_read_b64_tr_b16 v[80:81], v12 offset:2304
    v_mfma_f32_16x16x32_bf16 v[118:121], v[94:97], v[62:65], v[118:121]
    ds_read_b64_tr_b16 v[82:83], v13 offset:2048
    ds_read_b64_tr_b16 v[84:85], v13 offset:2304
    v_mfma_f32_16x16x32_bf16 v[142:145], v[94:97], v[66:69], v[142:145]
    ds_read_b64_tr_b16 v[86:87], v12 offset:4096
    ds_read_b64_tr_b16 v[88:89], v12 offset:4352
    v_mfma_f32_16x16x32_bf16 v[122:125], v[98:101], v[62:65], v[122:125]
    ds_read_b64_tr_b16 v[90:91], v13 offset:4096
    ds_read_b64_tr_b16 v[92:93], v13 offset:4352
    v_mfma_f32_16x16x32_bf16 v[146:149], v[98:101], v[66:69], v[146:149]
    v_mfma_f32_16x16x32_bf16 v[126:129], v[102:105], v[62:65], v[126:129]
    v_mfma_f32_16x16x32_bf16 v[150:153], v[102:105], v[66:69], v[150:153]
    v_mfma_f32_16x16x32_bf16 v[130:133], v[106:109], v[62:65], v[130:133]
    v_mfma_f32_16x16x32_bf16 v[154:157], v[106:109], v[66:69], v[154:157]
    v_mfma_f32_16x16x32_bf16 v[134:137], v[62:65], v[110:113], v[134:137]
    v_mfma_f32_16x16x32_bf16 v[158:161], v[66:69], v[110:113], v[158:161]
    v_mfma_f32_16x16x32_bf16 v[138:141], v[62:65], v[114:117], v[138:141]
    v_mfma_f32_16x16x32_bf16 v[162:165], v[66:69], v[114:117], v[162:165]
    s_waitcnt lgkmcnt(0)
    v_mfma_f32_16x16x32_bf16 v[26:29], v[22:25], v[54:57], v[26:29]
    ds_read_b128 v[62:65], v19 offset:0
    ds_read_b128 v[66:69], v19 offset:2048
    v_mfma_f32_16x16x32_bf16 v[34:37], v[54:57], v[54:57], v[34:37]
    ds_read_b64_tr_b16 v[94:95], v12 offset:6144
    ds_read_b64_tr_b16 v[96:97], v12 offset:6400
    v_mfma_f32_16x16x32_bf16 v[30:33], v[22:25], v[58:61], v[30:33]
    ds_read_b64_tr_b16 v[98:99], v13 offset:6144
    ds_read_b64_tr_b16 v[100:101], v13 offset:6400
    v_mfma_f32_16x16x32_bf16 v[38:41], v[58:61], v[58:61], v[38:41]
    ds_read_b64_tr_b16 v[102:103], v12 offset:8192
    ds_read_b64_tr_b16 v[104:105], v12 offset:8448
    v_mfma_f32_16x16x32_bf16 v[118:121], v[70:73], v[54:57], v[118:121]
    ds_read_b64_tr_b16 v[106:107], v13 offset:8192
    ds_read_b64_tr_b16 v[108:109], v13 offset:8448
    v_mfma_f32_16x16x32_bf16 v[142:145], v[70:73], v[58:61], v[142:145]
    ds_read_b64_tr_b16 v[110:111], v12 offset:10240
    ds_read_b64_tr_b16 v[112:113], v12 offset:10496
    v_mfma_f32_16x16x32_bf16 v[122:125], v[74:77], v[54:57], v[122:125]
    ds_read_b64_tr_b16 v[114:115], v13 offset:10240
    ds_read_b64_tr_b16 v[116:117], v13 offset:10496
    v_mfma_f32_16x16x32_bf16 v[146:149], v[74:77], v[58:61], v[146:149]
    v_mfma_f32_16x16x32_bf16 v[126:129], v[78:81], v[54:57], v[126:129]
    v_mfma_f32_16x16x32_bf16 v[150:153], v[78:81], v[58:61], v[150:153]
    v_mfma_f32_16x16x32_bf16 v[130:133], v[82:85], v[54:57], v[130:133]
    v_mfma_f32_16x16x32_bf16 v[154:157], v[82:85], v[58:61], v[154:157]
    v_mfma_f32_16x16x32_bf16 v[134:137], v[54:57], v[86:89], v[134:137]
    v_mfma_f32_16x16x32_bf16 v[158:161], v[58:61], v[86:89], v[158:161]
    v_mfma_f32_16x16x32_bf16 v[138:141], v[54:57], v[90:93], v[138:141]
    v_mfma_f32_16x16x32_bf16 v[162:165], v[58:61], v[90:93], v[162:165]
    s_waitcnt lgkmcnt(0)
    s_barrier
    v_mfma_f32_16x16x32_bf16 v[26:29], v[22:25], v[62:65], v[26:29]
    ds_read_b128 v[54:57], v18 offset:28672
    ds_read_b128 v[58:61], v18 offset:30720
    v_mfma_f32_16x16x32_bf16 v[34:37], v[62:65], v[62:65], v[34:37]
    ds_read_b64_tr_b16 v[70:71], v12 offset:28672
    ds_read_b64_tr_b16 v[72:73], v12 offset:28928
    v_mfma_f32_16x16x32_bf16 v[30:33], v[22:25], v[66:69], v[30:33]
    ds_read_b64_tr_b16 v[74:75], v13 offset:28672
    ds_read_b64_tr_b16 v[76:77], v13 offset:28928
    v_mfma_f32_16x16x32_bf16 v[38:41], v[66:69], v[66:69], v[38:41]
    ds_read_b64_tr_b16 v[78:79], v12 offset:30720
    ds_read_b64_tr_b16 v[80:81], v12 offset:30976
    v_mfma_f32_16x16x32_bf16 v[118:121], v[94:97], v[62:65], v[118:121]
    ds_read_b64_tr_b16 v[82:83], v13 offset:30720
    ds_read_b64_tr_b16 v[84:85], v13 offset:30976
    v_mfma_f32_16x16x32_bf16 v[142:145], v[94:97], v[66:69], v[142:145]
    ds_read_b64_tr_b16 v[86:87], v12 offset:32768
    ds_read_b64_tr_b16 v[88:89], v12 offset:33024
    v_mfma_f32_16x16x32_bf16 v[122:125], v[98:101], v[62:65], v[122:125]
    ds_read_b64_tr_b16 v[90:91], v13 offset:32768
    ds_read_b64_tr_b16 v[92:93], v13 offset:33024
    v_mfma_f32_16x16x32_bf16 v[146:149], v[98:101], v[66:69], v[146:149]
    v_mfma_f32_16x16x32_bf16 v[126:129], v[102:105], v[62:65], v[126:129]
    v_mfma_f32_16x16x32_bf16 v[150:153], v[102:105], v[66:69], v[150:153]
    v_mfma_f32_16x16x32_bf16 v[130:133], v[106:109], v[62:65], v[130:133]
    v_mfma_f32_16x16x32_bf16 v[154:157], v[106:109], v[66:69], v[154:157]
    v_mfma_f32_16x16x32_bf16 v[134:137], v[62:65], v[110:113], v[134:137]
    v_mfma_f32_16x16x32_bf16 v[158:161], v[66:69], v[110:113], v[158:161]
    v_mfma_f32_16x16x32_bf16 v[138:141], v[62:65], v[114:117], v[138:141]
    v_mfma_f32_16x16x32_bf16 v[162:165], v[66:69], v[114:117], v[162:165]
    s_waitcnt lgkmcnt(0)
    v_mfma_f32_16x16x32_bf16 v[26:29], v[22:25], v[54:57], v[26:29]
    ds_read_b128 v[62:65], v19 offset:28672
    ds_read_b128 v[66:69], v19 offset:30720
    v_mfma_f32_16x16x32_bf16 v[34:37], v[54:57], v[54:57], v[34:37]
    ds_read_b64_tr_b16 v[94:95], v12 offset:34816
    ds_read_b64_tr_b16 v[96:97], v12 offset:35072
    v_mfma_f32_16x16x32_bf16 v[30:33], v[22:25], v[58:61], v[30:33]
    ds_read_b64_tr_b16 v[98:99], v13 offset:34816
    ds_read_b64_tr_b16 v[100:101], v13 offset:35072
    v_mfma_f32_16x16x32_bf16 v[38:41], v[58:61], v[58:61], v[38:41]
    ds_read_b64_tr_b16 v[102:103], v12 offset:36864
    ds_read_b64_tr_b16 v[104:105], v12 offset:37120
    v_mfma_f32_16x16x32_bf16 v[118:121], v[70:73], v[54:57], v[118:121]
    ds_read_b64_tr_b16 v[106:107], v13 offset:36864
    ds_read_b64_tr_b16 v[108:109], v13 offset:37120
    v_mfma_f32_16x16x32_bf16 v[142:145], v[70:73], v[58:61], v[142:145]
    ds_read_b64_tr_b16 v[110:111], v12 offset:38912
    ds_read_b64_tr_b16 v[112:113], v12 offset:39168
    v_mfma_f32_16x16x32_bf16 v[122:125], v[74:77], v[54:57], v[122:125]
    ds_read_b64_tr_b16 v[114:115], v13 offset:38912
    ds_read_b64_tr_b16 v[116:117], v13 offset:39168
    v_mfma_f32_16x16x32_bf16 v[146:149], v[74:77], v[58:61], v[146:149]
    v_mfma_f32_16x16x32_bf16 v[126:129], v[78:81], v[54:57], v[126:129]
    v_mfma_f32_16x16x32_bf16 v[150:153], v[78:81], v[58:61], v[150:153]
    v_mfma_f32_16x16x32_bf16 v[130:133], v[82:85], v[54:57], v[130:133]
    v_mfma_f32_16x16x32_bf16 v[154:157], v[82:85], v[58:61], v[154:157]
    v_mfma_f32_16x16x32_bf16 v[134:137], v[54:57], v[86:89], v[134:137]
    v_mfma_f32_16x16x32_bf16 v[158:161], v[58:61], v[86:89], v[158:161]
    v_mfma_f32_16x16x32_bf16 v[138:141], v[54:57], v[90:93], v[138:141]
    v_mfma_f32_16x16x32_bf16 v[162:165], v[58:61], v[90:93], v[162:165]
    s_waitcnt lgkmcnt(0)
    s_barrier
    v_mfma_f32_16x16x32_bf16 v[26:29], v[22:25], v[62:65], v[26:29]
    ds_read_b128 v[54:57], v20 offset:0
    ds_read_b128 v[58:61], v20 offset:2048
    v_mfma_f32_16x16x32_bf16 v[34:37], v[62:65], v[62:65], v[34:37]
    ds_read_b64_tr_b16 v[70:71], v14 offset:0
    ds_read_b64_tr_b16 v[72:73], v14 offset:256
    v_mfma_f32_16x16x32_bf16 v[30:33], v[22:25], v[66:69], v[30:33]
    ds_read_b64_tr_b16 v[74:75], v15 offset:0
    ds_read_b64_tr_b16 v[76:77], v15 offset:256
    v_mfma_f32_16x16x32_bf16 v[38:41], v[66:69], v[66:69], v[38:41]
    ds_read_b64_tr_b16 v[78:79], v14 offset:2048
    ds_read_b64_tr_b16 v[80:81], v14 offset:2304
    v_mfma_f32_16x16x32_bf16 v[118:121], v[94:97], v[62:65], v[118:121]
    ds_read_b64_tr_b16 v[82:83], v15 offset:2048
    ds_read_b64_tr_b16 v[84:85], v15 offset:2304
    v_mfma_f32_16x16x32_bf16 v[142:145], v[94:97], v[66:69], v[142:145]
    ds_read_b64_tr_b16 v[86:87], v14 offset:4096
    ds_read_b64_tr_b16 v[88:89], v14 offset:4352
    v_mfma_f32_16x16x32_bf16 v[122:125], v[98:101], v[62:65], v[122:125]
    ds_read_b64_tr_b16 v[90:91], v15 offset:4096
    ds_read_b64_tr_b16 v[92:93], v15 offset:4352
    v_mfma_f32_16x16x32_bf16 v[146:149], v[98:101], v[66:69], v[146:149]
    v_mfma_f32_16x16x32_bf16 v[126:129], v[102:105], v[62:65], v[126:129]
    v_mfma_f32_16x16x32_bf16 v[150:153], v[102:105], v[66:69], v[150:153]
    v_mfma_f32_16x16x32_bf16 v[130:133], v[106:109], v[62:65], v[130:133]
    v_mfma_f32_16x16x32_bf16 v[154:157], v[106:109], v[66:69], v[154:157]
    v_mfma_f32_16x16x32_bf16 v[134:137], v[62:65], v[110:113], v[134:137]
    v_mfma_f32_16x16x32_bf16 v[158:161], v[66:69], v[110:113], v[158:161]
    v_mfma_f32_16x16x32_bf16 v[138:141], v[62:65], v[114:117], v[138:141]
    v_mfma_f32_16x16x32_bf16 v[162:165], v[66:69], v[114:117], v[162:165]
    s_waitcnt lgkmcnt(0)
    v_mfma_f32_16x16x32_bf16 v[26:29], v[22:25], v[54:57], v[26:29]
    ds_read_b128 v[62:65], v21 offset:0
    ds_read_b128 v[66:69], v21 offset:2048
    v_mfma_f32_16x16x32_bf16 v[34:37], v[54:57], v[54:57], v[34:37]
    ds_read_b64_tr_b16 v[94:95], v14 offset:6144
    ds_read_b64_tr_b16 v[96:97], v14 offset:6400
    v_mfma_f32_16x16x32_bf16 v[30:33], v[22:25], v[58:61], v[30:33]
    ds_read_b64_tr_b16 v[98:99], v15 offset:6144
    ds_read_b64_tr_b16 v[100:101], v15 offset:6400
    v_mfma_f32_16x16x32_bf16 v[38:41], v[58:61], v[58:61], v[38:41]
    ds_read_b64_tr_b16 v[102:103], v14 offset:8192
    ds_read_b64_tr_b16 v[104:105], v14 offset:8448
    v_mfma_f32_16x16x32_bf16 v[118:121], v[70:73], v[54:57], v[118:121]
    ds_read_b64_tr_b16 v[106:107], v15 offset:8192
    ds_read_b64_tr_b16 v[108:109], v15 offset:8448
    v_mfma_f32_16x16x32_bf16 v[142:145], v[70:73], v[58:61], v[142:145]
    ds_read_b64_tr_b16 v[110:111], v14 offset:10240
    ds_read_b64_tr_b16 v[112:113], v14 offset:10496
    v_mfma_f32_16x16x32_bf16 v[122:125], v[74:77], v[54:57], v[122:125]
    ds_read_b64_tr_b16 v[114:115], v15 offset:10240
    ds_read_b64_tr_b16 v[116:117], v15 offset:10496
    v_mfma_f32_16x16x32_bf16 v[146:149], v[74:77], v[58:61], v[146:149]
    v_mfma_f32_16x16x32_bf16 v[126:129], v[78:81], v[54:57], v[126:129]
    v_mfma_f32_16x16x32_bf16 v[150:153], v[78:81], v[58:61], v[150:153]
    v_mfma_f32_16x16x32_bf16 v[130:133], v[82:85], v[54:57], v[130:133]
    v_mfma_f32_16x16x32_bf16 v[154:157], v[82:85], v[58:61], v[154:157]
    v_mfma_f32_16x16x32_bf16 v[134:137], v[54:57], v[86:89], v[134:137]
    v_mfma_f32_16x16x32_bf16 v[158:161], v[58:61], v[86:89], v[158:161]
    v_mfma_f32_16x16x32_bf16 v[138:141], v[54:57], v[90:93], v[138:141]
    v_mfma_f32_16x16x32_bf16 v[162:165], v[58:61], v[90:93], v[162:165]
    s_waitcnt lgkmcnt(0)
    s_barrier
    v_mfma_f32_16x16x32_bf16 v[26:29], v[22:25], v[62:65], v[26:29]
    ds_read_b128 v[54:57], v16 offset:0
    ds_read_b128 v[58:61], v16 offset:2048
    v_mfma_f32_16x16x32_bf16 v[34:37], v[62:65], v[62:65], v[34:37]
    ds_read_b64_tr_b16 v[70:71], v10 offset:0
    ds_read_b64_tr_b16 v[72:73], v10 offset:256
    v_mfma_f32_16x16x32_bf16 v[30:33], v[22:25], v[66:69], v[30:33]
    ds_read_b64_tr_b16 v[74:75], v11 offset:0
    ds_read_b64_tr_b16 v[76:77], v11 offset:256
    v_mfma_f32_16x16x32_bf16 v[38:41], v[66:69], v[66:69], v[38:41]
    ds_read_b64_tr_b16 v[78:79], v10 offset:2048
    ds_read_b64_tr_b16 v[80:81], v10 offset:2304
    v_mfma_f32_16x16x32_bf16 v[118:121], v[94:97], v[62:65], v[118:121]
    ds_read_b64_tr_b16 v[82:83], v11 offset:2048
    ds_read_b64_tr_b16 v[84:85], v11 offset:2304
    v_mfma_f32_16x16x32_bf16 v[142:145], v[94:97], v[66:69], v[142:145]
    ds_read_b64_tr_b16 v[86:87], v10 offset:4096
    ds_read_b64_tr_b16 v[88:89], v10 offset:4352
    v_mfma_f32_16x16x32_bf16 v[122:125], v[98:101], v[62:65], v[122:125]
    ds_read_b64_tr_b16 v[90:91], v11 offset:4096
    ds_read_b64_tr_b16 v[92:93], v11 offset:4352
    v_mfma_f32_16x16x32_bf16 v[146:149], v[98:101], v[66:69], v[146:149]
    v_mfma_f32_16x16x32_bf16 v[126:129], v[102:105], v[62:65], v[126:129]
    v_mfma_f32_16x16x32_bf16 v[150:153], v[102:105], v[66:69], v[150:153]
    v_mfma_f32_16x16x32_bf16 v[130:133], v[106:109], v[62:65], v[130:133]
    v_mfma_f32_16x16x32_bf16 v[154:157], v[106:109], v[66:69], v[154:157]
    v_mfma_f32_16x16x32_bf16 v[134:137], v[62:65], v[110:113], v[134:137]
    v_mfma_f32_16x16x32_bf16 v[158:161], v[66:69], v[110:113], v[158:161]
    v_mfma_f32_16x16x32_bf16 v[138:141], v[62:65], v[114:117], v[138:141]
    v_mfma_f32_16x16x32_bf16 v[162:165], v[66:69], v[114:117], v[162:165]
    s_waitcnt lgkmcnt(0)
    v_mfma_f32_16x16x32_bf16 v[26:29], v[22:25], v[54:57], v[26:29]
    ds_read_b128 v[62:65], v17 offset:0
    ds_read_b128 v[66:69], v17 offset:2048
    v_mfma_f32_16x16x32_bf16 v[34:37], v[54:57], v[54:57], v[34:37]
    ds_read_b64_tr_b16 v[94:95], v10 offset:6144
    ds_read_b64_tr_b16 v[96:97], v10 offset:6400
    v_mfma_f32_16x16x32_bf16 v[30:33], v[22:25], v[58:61], v[30:33]
    ds_read_b64_tr_b16 v[98:99], v11 offset:6144
    ds_read_b64_tr_b16 v[100:101], v11 offset:6400
    v_mfma_f32_16x16x32_bf16 v[38:41], v[58:61], v[58:61], v[38:41]
    ds_read_b64_tr_b16 v[102:103], v10 offset:8192
    ds_read_b64_tr_b16 v[104:105], v10 offset:8448
    v_mfma_f32_16x16x32_bf16 v[118:121], v[70:73], v[54:57], v[118:121]
    ds_read_b64_tr_b16 v[106:107], v11 offset:8192
    ds_read_b64_tr_b16 v[108:109], v11 offset:8448
    v_mfma_f32_16x16x32_bf16 v[142:145], v[70:73], v[58:61], v[142:145]
    ds_read_b64_tr_b16 v[110:111], v10 offset:10240
    ds_read_b64_tr_b16 v[112:113], v10 offset:10496
    v_mfma_f32_16x16x32_bf16 v[122:125], v[74:77], v[54:57], v[122:125]
    ds_read_b64_tr_b16 v[114:115], v11 offset:10240
    ds_read_b64_tr_b16 v[116:117], v11 offset:10496
    v_mfma_f32_16x16x32_bf16 v[146:149], v[74:77], v[58:61], v[146:149]
    v_mfma_f32_16x16x32_bf16 v[126:129], v[78:81], v[54:57], v[126:129]
    v_mfma_f32_16x16x32_bf16 v[150:153], v[78:81], v[58:61], v[150:153]
    v_mfma_f32_16x16x32_bf16 v[130:133], v[82:85], v[54:57], v[130:133]
    v_mfma_f32_16x16x32_bf16 v[154:157], v[82:85], v[58:61], v[154:157]
    v_mfma_f32_16x16x32_bf16 v[134:137], v[54:57], v[86:89], v[134:137]
    v_mfma_f32_16x16x32_bf16 v[158:161], v[58:61], v[86:89], v[158:161]
    v_mfma_f32_16x16x32_bf16 v[138:141], v[54:57], v[90:93], v[138:141]
    v_mfma_f32_16x16x32_bf16 v[162:165], v[58:61], v[90:93], v[162:165]
    s_waitcnt lgkmcnt(0)
    s_barrier
    v_mfma_f32_16x16x32_bf16 v[26:29], v[22:25], v[62:65], v[26:29]
    ds_read_b128 v[54:57], v16 offset:28672
    ds_read_b128 v[58:61], v16 offset:30720
    v_mfma_f32_16x16x32_bf16 v[34:37], v[62:65], v[62:65], v[34:37]
    ds_read_b64_tr_b16 v[70:71], v10 offset:28672
    ds_read_b64_tr_b16 v[72:73], v10 offset:28928
    v_mfma_f32_16x16x32_bf16 v[30:33], v[22:25], v[66:69], v[30:33]
    ds_read_b64_tr_b16 v[74:75], v11 offset:28672
    ds_read_b64_tr_b16 v[76:77], v11 offset:28928
    v_mfma_f32_16x16x32_bf16 v[38:41], v[66:69], v[66:69], v[38:41]
    ds_read_b64_tr_b16 v[78:79], v10 offset:30720
    ds_read_b64_tr_b16 v[80:81], v10 offset:30976
    v_mfma_f32_16x16x32_bf16 v[118:121], v[94:97], v[62:65], v[118:121]
    ds_read_b64_tr_b16 v[82:83], v11 offset:30720
    ds_read_b64_tr_b16 v[84:85], v11 offset:30976
    v_mfma_f32_16x16x32_bf16 v[142:145], v[94:97], v[66:69], v[142:145]
    ds_read_b64_tr_b16 v[86:87], v10 offset:32768
    ds_read_b64_tr_b16 v[88:89], v10 offset:33024
    v_mfma_f32_16x16x32_bf16 v[122:125], v[98:101], v[62:65], v[122:125]
    ds_read_b64_tr_b16 v[90:91], v11 offset:32768
    ds_read_b64_tr_b16 v[92:93], v11 offset:33024
    v_mfma_f32_16x16x32_bf16 v[146:149], v[98:101], v[66:69], v[146:149]
    v_mfma_f32_16x16x32_bf16 v[126:129], v[102:105], v[62:65], v[126:129]
    v_mfma_f32_16x16x32_bf16 v[150:153], v[102:105], v[66:69], v[150:153]
    v_mfma_f32_16x16x32_bf16 v[130:133], v[106:109], v[62:65], v[130:133]
    v_mfma_f32_16x16x32_bf16 v[154:157], v[106:109], v[66:69], v[154:157]
    v_mfma_f32_16x16x32_bf16 v[134:137], v[62:65], v[110:113], v[134:137]
    v_mfma_f32_16x16x32_bf16 v[158:161], v[66:69], v[110:113], v[158:161]
    v_mfma_f32_16x16x32_bf16 v[138:141], v[62:65], v[114:117], v[138:141]
    v_mfma_f32_16x16x32_bf16 v[162:165], v[66:69], v[114:117], v[162:165]
    s_waitcnt lgkmcnt(0)
    v_mfma_f32_16x16x32_bf16 v[26:29], v[22:25], v[54:57], v[26:29]
    ds_read_b128 v[62:65], v17 offset:28672
    ds_read_b128 v[66:69], v17 offset:30720
    v_mfma_f32_16x16x32_bf16 v[34:37], v[54:57], v[54:57], v[34:37]
    ds_read_b64_tr_b16 v[94:95], v10 offset:34816
    ds_read_b64_tr_b16 v[96:97], v10 offset:35072
    v_mfma_f32_16x16x32_bf16 v[30:33], v[22:25], v[58:61], v[30:33]
    ds_read_b64_tr_b16 v[98:99], v11 offset:34816
    ds_read_b64_tr_b16 v[100:101], v11 offset:35072
    v_mfma_f32_16x16x32_bf16 v[38:41], v[58:61], v[58:61], v[38:41]
    ds_read_b64_tr_b16 v[102:103], v10 offset:36864
    ds_read_b64_tr_b16 v[104:105], v10 offset:37120
    v_mfma_f32_16x16x32_bf16 v[118:121], v[70:73], v[54:57], v[118:121]
    ds_read_b64_tr_b16 v[106:107], v11 offset:36864
    ds_read_b64_tr_b16 v[108:109], v11 offset:37120
    v_mfma_f32_16x16x32_bf16 v[142:145], v[70:73], v[58:61], v[142:145]
    ds_read_b64_tr_b16 v[110:111], v10 offset:38912
    ds_read_b64_tr_b16 v[112:113], v10 offset:39168
    v_mfma_f32_16x16x32_bf16 v[122:125], v[74:77], v[54:57], v[122:125]
    ds_read_b64_tr_b16 v[114:115], v11 offset:38912
    ds_read_b64_tr_b16 v[116:117], v11 offset:39168
    v_mfma_f32_16x16x32_bf16 v[146:149], v[74:77], v[58:61], v[146:149]
    v_mfma_f32_16x16x32_bf16 v[126:129], v[78:81], v[54:57], v[126:129]
    v_mfma_f32_16x16x32_bf16 v[150:153], v[78:81], v[58:61], v[150:153]
    v_mfma_f32_16x16x32_bf16 v[130:133], v[82:85], v[54:57], v[130:133]
    v_mfma_f32_16x16x32_bf16 v[154:157], v[82:85], v[58:61], v[154:157]
    v_mfma_f32_16x16x32_bf16 v[134:137], v[54:57], v[86:89], v[134:137]
    v_mfma_f32_16x16x32_bf16 v[158:161], v[58:61], v[86:89], v[158:161]
    v_mfma_f32_16x16x32_bf16 v[138:141], v[54:57], v[90:93], v[138:141]
    v_mfma_f32_16x16x32_bf16 v[162:165], v[58:61], v[90:93], v[162:165]
    s_waitcnt lgkmcnt(0)
    s_barrier
    v_mfma_f32_16x16x32_bf16 v[26:29], v[22:25], v[62:65], v[26:29]
    ds_read_b128 v[54:57], v18 offset:0
    ds_read_b128 v[58:61], v18 offset:2048
    v_mfma_f32_16x16x32_bf16 v[34:37], v[62:65], v[62:65], v[34:37]
    ds_read_b64_tr_b16 v[70:71], v12 offset:0
    ds_read_b64_tr_b16 v[72:73], v12 offset:256
    v_mfma_f32_16x16x32_bf16 v[30:33], v[22:25], v[66:69], v[30:33]
    ds_read_b64_tr_b16 v[74:75], v13 offset:0
    ds_read_b64_tr_b16 v[76:77], v13 offset:256
    v_mfma_f32_16x16x32_bf16 v[38:41], v[66:69], v[66:69], v[38:41]
    ds_read_b64_tr_b16 v[78:79], v12 offset:2048
    ds_read_b64_tr_b16 v[80:81], v12 offset:2304
    v_mfma_f32_16x16x32_bf16 v[118:121], v[94:97], v[62:65], v[118:121]
    ds_read_b64_tr_b16 v[82:83], v13 offset:2048
    ds_read_b64_tr_b16 v[84:85], v13 offset:2304
    v_mfma_f32_16x16x32_bf16 v[142:145], v[94:97], v[66:69], v[142:145]
    ds_read_b64_tr_b16 v[86:87], v12 offset:4096
    ds_read_b64_tr_b16 v[88:89], v12 offset:4352
    v_mfma_f32_16x16x32_bf16 v[122:125], v[98:101], v[62:65], v[122:125]
    ds_read_b64_tr_b16 v[90:91], v13 offset:4096
    ds_read_b64_tr_b16 v[92:93], v13 offset:4352
    v_mfma_f32_16x16x32_bf16 v[146:149], v[98:101], v[66:69], v[146:149]
    v_mfma_f32_16x16x32_bf16 v[126:129], v[102:105], v[62:65], v[126:129]
    v_mfma_f32_16x16x32_bf16 v[150:153], v[102:105], v[66:69], v[150:153]
    v_mfma_f32_16x16x32_bf16 v[130:133], v[106:109], v[62:65], v[130:133]
    v_mfma_f32_16x16x32_bf16 v[154:157], v[106:109], v[66:69], v[154:157]
    v_mfma_f32_16x16x32_bf16 v[134:137], v[62:65], v[110:113], v[134:137]
    v_mfma_f32_16x16x32_bf16 v[158:161], v[66:69], v[110:113], v[158:161]
    v_mfma_f32_16x16x32_bf16 v[138:141], v[62:65], v[114:117], v[138:141]
    v_mfma_f32_16x16x32_bf16 v[162:165], v[66:69], v[114:117], v[162:165]
    s_waitcnt lgkmcnt(0)
    v_mfma_f32_16x16x32_bf16 v[26:29], v[22:25], v[54:57], v[26:29]
    ds_read_b128 v[62:65], v19 offset:0
    ds_read_b128 v[66:69], v19 offset:2048
    v_mfma_f32_16x16x32_bf16 v[34:37], v[54:57], v[54:57], v[34:37]
    ds_read_b64_tr_b16 v[94:95], v12 offset:6144
    ds_read_b64_tr_b16 v[96:97], v12 offset:6400
    v_mfma_f32_16x16x32_bf16 v[30:33], v[22:25], v[58:61], v[30:33]
    ds_read_b64_tr_b16 v[98:99], v13 offset:6144
    ds_read_b64_tr_b16 v[100:101], v13 offset:6400
    v_mfma_f32_16x16x32_bf16 v[38:41], v[58:61], v[58:61], v[38:41]
    ds_read_b64_tr_b16 v[102:103], v12 offset:8192
    ds_read_b64_tr_b16 v[104:105], v12 offset:8448
    v_mfma_f32_16x16x32_bf16 v[118:121], v[70:73], v[54:57], v[118:121]
    ds_read_b64_tr_b16 v[106:107], v13 offset:8192
    ds_read_b64_tr_b16 v[108:109], v13 offset:8448
    v_mfma_f32_16x16x32_bf16 v[142:145], v[70:73], v[58:61], v[142:145]
    ds_read_b64_tr_b16 v[110:111], v12 offset:10240
    ds_read_b64_tr_b16 v[112:113], v12 offset:10496
    v_mfma_f32_16x16x32_bf16 v[122:125], v[74:77], v[54:57], v[122:125]
    ds_read_b64_tr_b16 v[114:115], v13 offset:10240
    ds_read_b64_tr_b16 v[116:117], v13 offset:10496
    v_mfma_f32_16x16x32_bf16 v[146:149], v[74:77], v[58:61], v[146:149]
    v_mfma_f32_16x16x32_bf16 v[126:129], v[78:81], v[54:57], v[126:129]
    v_mfma_f32_16x16x32_bf16 v[150:153], v[78:81], v[58:61], v[150:153]
    v_mfma_f32_16x16x32_bf16 v[130:133], v[82:85], v[54:57], v[130:133]
    v_mfma_f32_16x16x32_bf16 v[154:157], v[82:85], v[58:61], v[154:157]
    v_mfma_f32_16x16x32_bf16 v[134:137], v[54:57], v[86:89], v[134:137]
    v_mfma_f32_16x16x32_bf16 v[158:161], v[58:61], v[86:89], v[158:161]
    v_mfma_f32_16x16x32_bf16 v[138:141], v[54:57], v[90:93], v[138:141]
    v_mfma_f32_16x16x32_bf16 v[162:165], v[58:61], v[90:93], v[162:165]
    s_waitcnt lgkmcnt(12)
    v_mfma_f32_16x16x32_bf16 v[26:29], v[22:25], v[62:65], v[26:29]
    v_mfma_f32_16x16x32_bf16 v[34:37], v[62:65], v[62:65], v[34:37]
    v_mfma_f32_16x16x32_bf16 v[30:33], v[22:25], v[66:69], v[30:33]
    v_mfma_f32_16x16x32_bf16 v[38:41], v[66:69], v[66:69], v[38:41]
    s_waitcnt lgkmcnt(0)
    s_barrier
    v_mfma_f32_16x16x32_bf16 v[118:121], v[94:97], v[62:65], v[118:121]
    s_mov_b32 s40, 0x100001
    s_mov_b32 s41, 0x10000100
    s_mov_b32 s42, 0x200002
    s_mov_b32 s43, 0x20000200
    s_mov_b32 s44, 0x400004
    s_mov_b32 s45, 0x40000400
    v_mfma_f32_16x16x32_bf16 v[142:145], v[94:97], v[66:69], v[142:145]
    s_mov_b32 s46, 0x800008
    s_mov_b32 s47, 0x80000800
    ds_read_b128 v[166:169], v206 offset:0
    ds_read_b128 v[70:73], v206 offset:384
    ds_read_b128 v[170:173], v206 offset:64
    ds_read_b128 v[74:77], v206 offset:448
    v_mfma_f32_16x16x32_bf16 v[122:125], v[98:101], v[62:65], v[122:125]
    v_mov_b32 v42, 0
    v_mov_b32 v44, 0
    v_cndmask_b32_e64 v42, v42, v34, s[40:41]
    v_cndmask_b32_e64 v44, v44, v38, s[40:41]
    v_cndmask_b32_e64 v42, v42, v35, s[42:43]
    v_cndmask_b32_e64 v44, v44, v39, s[42:43]
    v_mfma_f32_16x16x32_bf16 v[146:149], v[98:101], v[66:69], v[146:149]
    v_cndmask_b32_e64 v42, v42, v36, s[44:45]
    v_cndmask_b32_e64 v44, v44, v40, s[44:45]
    v_cndmask_b32_e64 v42, v42, v37, s[46:47]
    v_cndmask_b32_e64 v44, v44, v41, s[46:47]
    v_mov_b32 v43, v42
    v_mov_b32 v45, v44
    v_mfma_f32_16x16x32_bf16 v[126:129], v[102:105], v[62:65], v[126:129]
    ds_read_b128 v[174:177], v206 offset:128
    ds_read_b128 v[78:81], v206 offset:512
    ds_read_b128 v[178:181], v206 offset:192
    ds_read_b128 v[82:85], v206 offset:576
    v_permlane32_swap_b32 v42, v43
    v_permlane32_swap_b32 v44, v45
    v_mfma_f32_16x16x32_bf16 v[150:153], v[102:105], v[66:69], v[150:153]
    v_add_f32 v42, v42, v43
    v_add_f32 v44, v44, v45
    v_mov_b32 v43, v42
    v_mov_b32 v45, v44
    s_nop 0
    v_permlane16_swap_b32 v42, v43
    v_permlane16_swap_b32 v44, v45
    v_mfma_f32_16x16x32_bf16 v[130:133], v[106:109], v[62:65], v[130:133]
    v_add_f32 v42, v42, v43
    v_add_f32 v44, v44, v45
    v_mul_f32 v50, 0x3b000000, v26
    v_mul_f32 v51, 0x3b000000, v30
    ds_read_b32 v182, v207 offset:256
    ds_read_b32 v86, v207 offset:640
    v_mfma_f32_16x16x32_bf16 v[154:157], v[106:109], v[66:69], v[154:157]
    ds_read_b32 v186, v207 offset:320
    ds_read_b32 v90, v207 offset:704
    v_mul_f32 v52, 0x3b000000, v42
    v_mul_f32 v53, 0x3b000000, v44
    v_fma_f32 v52, -v50, v50, v52
    v_fma_f32 v53, -v51, v51, v53
    v_mfma_f32_16x16x32_bf16 v[134:137], v[62:65], v[110:113], v[134:137]
    v_max_f32 v52, 0, v52
    v_max_f32 v53, 0, v53
    v_cvt_pk_bf16_f32 v42, v50, v52
    v_cvt_pk_bf16_f32 v44, v51, v53
    v_lshlrev_b32 v50, 16, v42
    v_lshlrev_b32 v51, 16, v44
    v_mfma_f32_16x16x32_bf16 v[158:161], v[66:69], v[110:113], v[158:161]
    v_and_b32 v52, 0xffff0000, v42
    v_and_b32 v53, 0xffff0000, v44
    v_add_f32 v52, 0x3727c5ac, v52
    v_add_f32 v53, 0x3727c5ac, v53
    v_cvt_pk_bf16_f32 v42, v52, v52
    v_cvt_pk_bf16_f32 v44, v53, v53
    v_mfma_f32_16x16x32_bf16 v[138:141], v[62:65], v[114:117], v[138:141]
    v_lshlrev_b32 v52, 16, v42
    v_lshlrev_b32 v53, 16, v44
    v_sqrt_f32 v52, v52
    v_sqrt_f32 v53, v53
    v_cvt_pk_bf16_f32 v42, v52, v52
    v_cvt_pk_bf16_f32 v44, v53, v53
    v_mfma_f32_16x16x32_bf16 v[162:165], v[66:69], v[114:117], v[162:165]
    v_lshlrev_b32 v52, 16, v42
    v_lshlrev_b32 v53, 16, v44
    v_rcp_f32 v52, v52
    v_rcp_f32 v53, v53
    ds_write_b32 v208, v50 offset:0
    ds_write_b32 v208, v52 offset:64
    ds_write_b32 v208, v51 offset:128
    ds_write_b32 v208, v53 offset:192
    s_waitcnt lgkmcnt(0)
    ds_read_b128 v[190:193], v209 offset:0
    ds_read_b128 v[194:197], v209 offset:64
    ds_read_b128 v[198:201], v209 offset:128
    ds_read_b128 v[202:205], v209 offset:192
    s_waitcnt lgkmcnt(0)
    v_pk_add_f32 v[166:167], v[166:167], v[70:71]
    v_pk_add_f32 v[168:169], v[168:169], v[72:73]
    v_pk_add_f32 v[170:171], v[170:171], v[74:75]
    v_pk_add_f32 v[172:173], v[172:173], v[76:77]
    v_pk_add_f32 v[174:175], v[174:175], v[78:79]
    v_pk_add_f32 v[176:177], v[176:177], v[80:81]
    v_pk_add_f32 v[178:179], v[178:179], v[82:83]
    v_pk_add_f32 v[180:181], v[180:181], v[84:85]
    v_add_f32 v182, v182, v86
    v_add_f32 v186, v186, v90
    s_add_u32 s29, s28, 0
    v_pk_fma_f32 v[118:119], v[166:167], v[50:51], v[118:119] op_sel:[0,0,0] op_sel_hi:[1,0,1] neg_lo:[0,1,0] neg_hi:[0,1,0]
    v_pk_fma_f32 v[120:121], v[168:169], v[50:51], v[120:121] op_sel:[0,0,0] op_sel_hi:[1,0,1] neg_lo:[0,1,0] neg_hi:[0,1,0]
    v_pk_mul_f32 v[118:119], v[118:119], v[52:53] op_sel:[0,0] op_sel_hi:[1,0]
    v_pk_mul_f32 v[120:121], v[120:121], v[52:53] op_sel:[0,0] op_sel_hi:[1,0]
    v_cvt_pk_bf16_f32 v118, v118, v119
    v_cvt_pk_bf16_f32 v119, v120, v121
    buffer_store_dwordx2 v[118:119], v8, s[32:35], s29 offen offset:0
    v_pk_fma_f32 v[142:143], v[166:167], v[50:51], v[142:143] op_sel:[0,1,0] op_sel_hi:[1,1,1] neg_lo:[0,1,0] neg_hi:[0,1,0]
    v_pk_fma_f32 v[144:145], v[168:169], v[50:51], v[144:145] op_sel:[0,1,0] op_sel_hi:[1,1,1] neg_lo:[0,1,0] neg_hi:[0,1,0]
    v_pk_mul_f32 v[142:143], v[142:143], v[52:53] op_sel:[0,1] op_sel_hi:[1,1]
    v_pk_mul_f32 v[144:145], v[144:145], v[52:53] op_sel:[0,1] op_sel_hi:[1,1]
    v_cvt_pk_bf16_f32 v142, v142, v143
    v_cvt_pk_bf16_f32 v143, v144, v145
    buffer_store_dwordx2 v[142:143], v8, s[32:35], s29 offen offset:512
    s_add_u32 s29, s28, 65536
    v_pk_fma_f32 v[122:123], v[170:171], v[50:51], v[122:123] op_sel:[0,0,0] op_sel_hi:[1,0,1] neg_lo:[0,1,0] neg_hi:[0,1,0]
    v_pk_fma_f32 v[124:125], v[172:173], v[50:51], v[124:125] op_sel:[0,0,0] op_sel_hi:[1,0,1] neg_lo:[0,1,0] neg_hi:[0,1,0]
    v_pk_mul_f32 v[122:123], v[122:123], v[52:53] op_sel:[0,0] op_sel_hi:[1,0]
    v_pk_mul_f32 v[124:125], v[124:125], v[52:53] op_sel:[0,0] op_sel_hi:[1,0]
    v_cvt_pk_bf16_f32 v122, v122, v123
    v_cvt_pk_bf16_f32 v123, v124, v125
    buffer_store_dwordx2 v[122:123], v8, s[32:35], s29 offen offset:0
    v_pk_fma_f32 v[146:147], v[170:171], v[50:51], v[146:147] op_sel:[0,1,0] op_sel_hi:[1,1,1] neg_lo:[0,1,0] neg_hi:[0,1,0]
    v_pk_fma_f32 v[148:149], v[172:173], v[50:51], v[148:149] op_sel:[0,1,0] op_sel_hi:[1,1,1] neg_lo:[0,1,0] neg_hi:[0,1,0]
    v_pk_mul_f32 v[146:147], v[146:147], v[52:53] op_sel:[0,1] op_sel_hi:[1,1]
    v_pk_mul_f32 v[148:149], v[148:149], v[52:53] op_sel:[0,1] op_sel_hi:[1,1]
    v_cvt_pk_bf16_f32 v146, v146, v147
    v_cvt_pk_bf16_f32 v147, v148, v149
    buffer_store_dwordx2 v[146:147], v8, s[32:35], s29 offen offset:512
    s_add_u32 s29, s28, 131072
    v_pk_fma_f32 v[126:127], v[174:175], v[50:51], v[126:127] op_sel:[0,0,0] op_sel_hi:[1,0,1] neg_lo:[0,1,0] neg_hi:[0,1,0]
    v_pk_fma_f32 v[128:129], v[176:177], v[50:51], v[128:129] op_sel:[0,0,0] op_sel_hi:[1,0,1] neg_lo:[0,1,0] neg_hi:[0,1,0]
    v_pk_mul_f32 v[126:127], v[126:127], v[52:53] op_sel:[0,0] op_sel_hi:[1,0]
    v_pk_mul_f32 v[128:129], v[128:129], v[52:53] op_sel:[0,0] op_sel_hi:[1,0]
    v_cvt_pk_bf16_f32 v126, v126, v127
    v_cvt_pk_bf16_f32 v127, v128, v129
    buffer_store_dwordx2 v[126:127], v8, s[32:35], s29 offen offset:0
    v_pk_fma_f32 v[150:151], v[174:175], v[50:51], v[150:151] op_sel:[0,1,0] op_sel_hi:[1,1,1] neg_lo:[0,1,0] neg_hi:[0,1,0]
    v_pk_fma_f32 v[152:153], v[176:177], v[50:51], v[152:153] op_sel:[0,1,0] op_sel_hi:[1,1,1] neg_lo:[0,1,0] neg_hi:[0,1,0]
    v_pk_mul_f32 v[150:151], v[150:151], v[52:53] op_sel:[0,1] op_sel_hi:[1,1]
    v_pk_mul_f32 v[152:153], v[152:153], v[52:53] op_sel:[0,1] op_sel_hi:[1,1]
    v_cvt_pk_bf16_f32 v150, v150, v151
    v_cvt_pk_bf16_f32 v151, v152, v153
    buffer_store_dwordx2 v[150:151], v8, s[32:35], s29 offen offset:512
    s_add_u32 s29, s28, 196608
    v_pk_fma_f32 v[130:131], v[178:179], v[50:51], v[130:131] op_sel:[0,0,0] op_sel_hi:[1,0,1] neg_lo:[0,1,0] neg_hi:[0,1,0]
    v_pk_fma_f32 v[132:133], v[180:181], v[50:51], v[132:133] op_sel:[0,0,0] op_sel_hi:[1,0,1] neg_lo:[0,1,0] neg_hi:[0,1,0]
    v_pk_mul_f32 v[130:131], v[130:131], v[52:53] op_sel:[0,0] op_sel_hi:[1,0]
    v_pk_mul_f32 v[132:133], v[132:133], v[52:53] op_sel:[0,0] op_sel_hi:[1,0]
    v_cvt_pk_bf16_f32 v130, v130, v131
    v_cvt_pk_bf16_f32 v131, v132, v133
    buffer_store_dwordx2 v[130:131], v8, s[32:35], s29 offen offset:0
    v_pk_fma_f32 v[154:155], v[178:179], v[50:51], v[154:155] op_sel:[0,1,0] op_sel_hi:[1,1,1] neg_lo:[0,1,0] neg_hi:[0,1,0]
    v_pk_fma_f32 v[156:157], v[180:181], v[50:51], v[156:157] op_sel:[0,1,0] op_sel_hi:[1,1,1] neg_lo:[0,1,0] neg_hi:[0,1,0]
    v_pk_mul_f32 v[154:155], v[154:155], v[52:53] op_sel:[0,1] op_sel_hi:[1,1]
    v_pk_mul_f32 v[156:157], v[156:157], v[52:53] op_sel:[0,1] op_sel_hi:[1,1]
    v_cvt_pk_bf16_f32 v154, v154, v155
    v_cvt_pk_bf16_f32 v155, v156, v157
    buffer_store_dwordx2 v[154:155], v8, s[32:35], s29 offen offset:512
    s_add_u32 s29, s28, 262144
    v_pk_fma_f32 v[134:135], v[190:191], v[182:183], v[134:135] op_sel:[0,0,0] op_sel_hi:[1,0,1] neg_lo:[0,1,0] neg_hi:[0,1,0]
    v_pk_fma_f32 v[136:137], v[192:193], v[182:183], v[136:137] op_sel:[0,0,0] op_sel_hi:[1,0,1] neg_lo:[0,1,0] neg_hi:[0,1,0]
    v_pk_mul_f32 v[134:135], v[134:135], v[194:195]
    v_pk_mul_f32 v[136:137], v[136:137], v[196:197]
    v_cvt_pk_bf16_f32 v134, v134, v135
    v_cvt_pk_bf16_f32 v135, v136, v137
    buffer_store_dwordx2 v[134:135], v9, s[32:35], s29 offen offset:0
    v_pk_fma_f32 v[158:159], v[198:199], v[182:183], v[158:159] op_sel:[0,0,0] op_sel_hi:[1,0,1] neg_lo:[0,1,0] neg_hi:[0,1,0]
    v_pk_fma_f32 v[160:161], v[200:201], v[182:183], v[160:161] op_sel:[0,0,0] op_sel_hi:[1,0,1] neg_lo:[0,1,0] neg_hi:[0,1,0]
    v_pk_mul_f32 v[158:159], v[158:159], v[202:203]
    v_pk_mul_f32 v[160:161], v[160:161], v[204:205]
    v_cvt_pk_bf16_f32 v158, v158, v159
    v_cvt_pk_bf16_f32 v159, v160, v161
    buffer_store_dwordx2 v[158:159], v9, s[32:35], s29 offen offset:512
    s_add_u32 s29, s28, 327680
    v_pk_fma_f32 v[138:139], v[190:191], v[186:187], v[138:139] op_sel:[0,0,0] op_sel_hi:[1,0,1] neg_lo:[0,1,0] neg_hi:[0,1,0]
    v_pk_fma_f32 v[140:141], v[192:193], v[186:187], v[140:141] op_sel:[0,0,0] op_sel_hi:[1,0,1] neg_lo:[0,1,0] neg_hi:[0,1,0]
    v_pk_mul_f32 v[138:139], v[138:139], v[194:195]
    v_pk_mul_f32 v[140:141], v[140:141], v[196:197]
    v_cvt_pk_bf16_f32 v138, v138, v139
    v_cvt_pk_bf16_f32 v139, v140, v141
    buffer_store_dwordx2 v[138:139], v9, s[32:35], s29 offen offset:0
    v_pk_fma_f32 v[162:163], v[198:199], v[186:187], v[162:163] op_sel:[0,0,0] op_sel_hi:[1,0,1] neg_lo:[0,1,0] neg_hi:[0,1,0]
    v_pk_fma_f32 v[164:165], v[200:201], v[186:187], v[164:165] op_sel:[0,0,0] op_sel_hi:[1,0,1] neg_lo:[0,1,0] neg_hi:[0,1,0]
    v_pk_mul_f32 v[162:163], v[162:163], v[202:203]
    v_pk_mul_f32 v[164:165], v[164:165], v[204:205]
    v_cvt_pk_bf16_f32 v162, v162, v163
    v_cvt_pk_bf16_f32 v163, v164, v165
    buffer_store_dwordx2 v[162:163], v9, s[32:35], s29 offen offset:512
    s_endpgm
J_K1_v:
    s_nop 7
    s_nop 7
    s_barrier
    ds_read_b128 v[54:57], v16 offset:0
    ds_read_b128 v[58:61], v16 offset:2048
    ds_read_b64_tr_b16 v[70:71], v10 offset:0
    ds_read_b64_tr_b16 v[72:73], v10 offset:256
    ds_read_b64_tr_b16 v[74:75], v11 offset:0
    ds_read_b64_tr_b16 v[76:77], v11 offset:256
    ds_read_b64_tr_b16 v[78:79], v10 offset:2048
    ds_read_b64_tr_b16 v[80:81], v10 offset:2304
    ds_read_b64_tr_b16 v[82:83], v11 offset:2048
    ds_read_b64_tr_b16 v[84:85], v11 offset:2304
    ds_read_b64_tr_b16 v[86:87], v10 offset:4096
    ds_read_b64_tr_b16 v[88:89], v10 offset:4352
    ds_read_b64_tr_b16 v[90:91], v11 offset:4096
    ds_read_b64_tr_b16 v[92:93], v11 offset:4352
    s_waitcnt lgkmcnt(0)
    v_mfma_f32_16x16x32_bf16 v[26:29], v[22:25], v[54:57], 0
    ds_read_b128 v[62:65], v17 offset:0
    ds_read_b128 v[66:69], v17 offset:2048
    v_mfma_f32_16x16x32_bf16 v[34:37], v[54:57], v[54:57], 0
    ds_read_b64_tr_b16 v[94:95], v10 offset:6144
    ds_read_b64_tr_b16 v[96:97], v10 offset:6400
    v_mfma_f32_16x16x32_bf16 v[30:33], v[22:25], v[58:61], 0
    ds_read_b64_tr_b16 v[98:99], v11 offset:6144
    ds_read_b64_tr_b16 v[100:101], v11 offset:6400
    v_mfma_f32_16x16x32_bf16 v[38:41], v[58:61], v[58:61], 0
    ds_read_b64_tr_b16 v[102:103], v10 offset:8192
    ds_read_b64_tr_b16 v[104:105], v10 offset:8448
    v_mfma_f32_16x16x32_bf16 v[118:121], v[54:57], v[70:73], 0
    ds_read_b64_tr_b16 v[106:107], v11 offset:8192
    ds_read_b64_tr_b16 v[108:109], v11 offset:8448
    v_mfma_f32_16x16x32_bf16 v[142:145], v[58:61], v[70:73], 0
    ds_read_b64_tr_b16 v[110:111], v10 offset:10240
    ds_read_b64_tr_b16 v[112:113], v10 offset:10496
    v_mfma_f32_16x16x32_bf16 v[122:125], v[54:57], v[74:77], 0
    ds_read_b64_tr_b16 v[114:115], v11 offset:10240
    ds_read_b64_tr_b16 v[116:117], v11 offset:10496
    v_mfma_f32_16x16x32_bf16 v[146:149], v[58:61], v[74:77], 0
    v_mfma_f32_16x16x32_bf16 v[126:129], v[54:57], v[78:81], 0
    v_mfma_f32_16x16x32_bf16 v[150:153], v[58:61], v[78:81], 0
    v_mfma_f32_16x16x32_bf16 v[130:133], v[54:57], v[82:85], 0
    v_mfma_f32_16x16x32_bf16 v[154:157], v[58:61], v[82:85], 0
    v_mfma_f32_16x16x32_bf16 v[134:137], v[54:57], v[86:89], 0
    v_mfma_f32_16x16x32_bf16 v[158:161], v[58:61], v[86:89], 0
    v_mfma_f32_16x16x32_bf16 v[138:141], v[54:57], v[90:93], 0
    v_mfma_f32_16x16x32_bf16 v[162:165], v[58:61], v[90:93], 0
    s_waitcnt lgkmcnt(0)
    s_barrier
    v_mfma_f32_16x16x32_bf16 v[26:29], v[22:25], v[62:65], v[26:29]
    ds_read_b128 v[54:57], v16 offset:28672
    ds_read_b128 v[58:61], v16 offset:30720
    v_mfma_f32_16x16x32_bf16 v[34:37], v[62:65], v[62:65], v[34:37]
    ds_read_b64_tr_b16 v[70:71], v10 offset:28672
    ds_read_b64_tr_b16 v[72:73], v10 offset:28928
    v_mfma_f32_16x16x32_bf16 v[30:33], v[22:25], v[66:69], v[30:33]
    ds_read_b64_tr_b16 v[74:75], v11 offset:28672
    ds_read_b64_tr_b16 v[76:77], v11 offset:28928
    v_mfma_f32_16x16x32_bf16 v[38:41], v[66:69], v[66:69], v[38:41]
    ds_read_b64_tr_b16 v[78:79], v10 offset:30720
    ds_read_b64_tr_b16 v[80:81], v10 offset:30976
    v_mfma_f32_16x16x32_bf16 v[118:121], v[62:65], v[94:97], v[118:121]
    ds_read_b64_tr_b16 v[82:83], v11 offset:30720
    ds_read_b64_tr_b16 v[84:85], v11 offset:30976
    v_mfma_f32_16x16x32_bf16 v[142:145], v[66:69], v[94:97], v[142:145]
    ds_read_b64_tr_b16 v[86:87], v10 offset:32768
    ds_read_b64_tr_b16 v[88:89], v10 offset:33024
    v_mfma_f32_16x16x32_bf16 v[122:125], v[62:65], v[98:101], v[122:125]
    ds_read_b64_tr_b16 v[90:91], v11 offset:32768
    ds_read_b64_tr_b16 v[92:93], v11 offset:33024
    v_mfma_f32_16x16x32_bf16 v[146:149], v[66:69], v[98:101], v[146:149]
    v_mfma_f32_16x16x32_bf16 v[126:129], v[62:65], v[102:105], v[126:129]
    v_mfma_f32_16x16x32_bf16 v[150:153], v[66:69], v[102:105], v[150:153]
    v_mfma_f32_16x16x32_bf16 v[130:133], v[62:65], v[106:109], v[130:133]
    v_mfma_f32_16x16x32_bf16 v[154:157], v[66:69], v[106:109], v[154:157]
    v_mfma_f32_16x16x32_bf16 v[134:137], v[62:65], v[110:113], v[134:137]
    v_mfma_f32_16x16x32_bf16 v[158:161], v[66:69], v[110:113], v[158:161]
    v_mfma_f32_16x16x32_bf16 v[138:141], v[62:65], v[114:117], v[138:141]
    v_mfma_f32_16x16x32_bf16 v[162:165], v[66:69], v[114:117], v[162:165]
    s_waitcnt lgkmcnt(0)
    v_mfma_f32_16x16x32_bf16 v[26:29], v[22:25], v[54:57], v[26:29]
    ds_read_b128 v[62:65], v17 offset:28672
    ds_read_b128 v[66:69], v17 offset:30720
    v_mfma_f32_16x16x32_bf16 v[34:37], v[54:57], v[54:57], v[34:37]
    ds_read_b64_tr_b16 v[94:95], v10 offset:34816
    ds_read_b64_tr_b16 v[96:97], v10 offset:35072
    v_mfma_f32_16x16x32_bf16 v[30:33], v[22:25], v[58:61], v[30:33]
    ds_read_b64_tr_b16 v[98:99], v11 offset:34816
    ds_read_b64_tr_b16 v[100:101], v11 offset:35072
    v_mfma_f32_16x16x32_bf16 v[38:41], v[58:61], v[58:61], v[38:41]
    ds_read_b64_tr_b16 v[102:103], v10 offset:36864
    ds_read_b64_tr_b16 v[104:105], v10 offset:37120
    v_mfma_f32_16x16x32_bf16 v[118:121], v[54:57], v[70:73], v[118:121]
    ds_read_b64_tr_b16 v[106:107], v11 offset:36864
    ds_read_b64_tr_b16 v[108:109], v11 offset:37120
    v_mfma_f32_16x16x32_bf16 v[142:145], v[58:61], v[70:73], v[142:145]
    ds_read_b64_tr_b16 v[110:111], v10 offset:38912
    ds_read_b64_tr_b16 v[112:113], v10 offset:39168
    v_mfma_f32_16x16x32_bf16 v[122:125], v[54:57], v[74:77], v[122:125]
    ds_read_b64_tr_b16 v[114:115], v11 offset:38912
    ds_read_b64_tr_b16 v[116:117], v11 offset:39168
    v_mfma_f32_16x16x32_bf16 v[146:149], v[58:61], v[74:77], v[146:149]
    v_mfma_f32_16x16x32_bf16 v[126:129], v[54:57], v[78:81], v[126:129]
    v_mfma_f32_16x16x32_bf16 v[150:153], v[58:61], v[78:81], v[150:153]
    v_mfma_f32_16x16x32_bf16 v[130:133], v[54:57], v[82:85], v[130:133]
    v_mfma_f32_16x16x32_bf16 v[154:157], v[58:61], v[82:85], v[154:157]
    v_mfma_f32_16x16x32_bf16 v[134:137], v[54:57], v[86:89], v[134:137]
    v_mfma_f32_16x16x32_bf16 v[158:161], v[58:61], v[86:89], v[158:161]
    v_mfma_f32_16x16x32_bf16 v[138:141], v[54:57], v[90:93], v[138:141]
    v_mfma_f32_16x16x32_bf16 v[162:165], v[58:61], v[90:93], v[162:165]
    s_waitcnt lgkmcnt(0)
    s_barrier
    v_mfma_f32_16x16x32_bf16 v[26:29], v[22:25], v[62:65], v[26:29]
    ds_read_b128 v[54:57], v18 offset:0
    ds_read_b128 v[58:61], v18 offset:2048
    v_mfma_f32_16x16x32_bf16 v[34:37], v[62:65], v[62:65], v[34:37]
    ds_read_b64_tr_b16 v[70:71], v12 offset:0
    ds_read_b64_tr_b16 v[72:73], v12 offset:256
    v_mfma_f32_16x16x32_bf16 v[30:33], v[22:25], v[66:69], v[30:33]
    ds_read_b64_tr_b16 v[74:75], v13 offset:0
    ds_read_b64_tr_b16 v[76:77], v13 offset:256
    v_mfma_f32_16x16x32_bf16 v[38:41], v[66:69], v[66:69], v[38:41]
    ds_read_b64_tr_b16 v[78:79], v12 offset:2048
    ds_read_b64_tr_b16 v[80:81], v12 offset:2304
    v_mfma_f32_16x16x32_bf16 v[118:121], v[62:65], v[94:97], v[118:121]
    ds_read_b64_tr_b16 v[82:83], v13 offset:2048
    ds_read_b64_tr_b16 v[84:85], v13 offset:2304
    v_mfma_f32_16x16x32_bf16 v[142:145], v[66:69], v[94:97], v[142:145]
    ds_read_b64_tr_b16 v[86:87], v12 offset:4096
    ds_read_b64_tr_b16 v[88:89], v12 offset:4352
    v_mfma_f32_16x16x32_bf16 v[122:125], v[62:65], v[98:101], v[122:125]
    ds_read_b64_tr_b16 v[90:91], v13 offset:4096
    ds_read_b64_tr_b16 v[92:93], v13 offset:4352
    v_mfma_f32_16x16x32_bf16 v[146:149], v[66:69], v[98:101], v[146:149]
    v_mfma_f32_16x16x32_bf16 v[126:129], v[62:65], v[102:105], v[126:129]
    v_mfma_f32_16x16x32_bf16 v[150:153], v[66:69], v[102:105], v[150:153]
    v_mfma_f32_16x16x32_bf16 v[130:133], v[62:65], v[106:109], v[130:133]
    v_mfma_f32_16x16x32_bf16 v[154:157], v[66:69], v[106:109], v[154:157]
    v_mfma_f32_16x16x32_bf16 v[134:137], v[62:65], v[110:113], v[134:137]
    v_mfma_f32_16x16x32_bf16 v[158:161], v[66:69], v[110:113], v[158:161]
    v_mfma_f32_16x16x32_bf16 v[138:141], v[62:65], v[114:117], v[138:141]
    v_mfma_f32_16x16x32_bf16 v[162:165], v[66:69], v[114:117], v[162:165]
    s_waitcnt lgkmcnt(0)
    v_mfma_f32_16x16x32_bf16 v[26:29], v[22:25], v[54:57], v[26:29]
    ds_read_b128 v[62:65], v19 offset:0
    ds_read_b128 v[66:69], v19 offset:2048
    v_mfma_f32_16x16x32_bf16 v[34:37], v[54:57], v[54:57], v[34:37]
    ds_read_b64_tr_b16 v[94:95], v12 offset:6144
    ds_read_b64_tr_b16 v[96:97], v12 offset:6400
    v_mfma_f32_16x16x32_bf16 v[30:33], v[22:25], v[58:61], v[30:33]
    ds_read_b64_tr_b16 v[98:99], v13 offset:6144
    ds_read_b64_tr_b16 v[100:101], v13 offset:6400
    v_mfma_f32_16x16x32_bf16 v[38:41], v[58:61], v[58:61], v[38:41]
    ds_read_b64_tr_b16 v[102:103], v12 offset:8192
    ds_read_b64_tr_b16 v[104:105], v12 offset:8448
    v_mfma_f32_16x16x32_bf16 v[118:121], v[54:57], v[70:73], v[118:121]
    ds_read_b64_tr_b16 v[106:107], v13 offset:8192
    ds_read_b64_tr_b16 v[108:109], v13 offset:8448
    v_mfma_f32_16x16x32_bf16 v[142:145], v[58:61], v[70:73], v[142:145]
    ds_read_b64_tr_b16 v[110:111], v12 offset:10240
    ds_read_b64_tr_b16 v[112:113], v12 offset:10496
    v_mfma_f32_16x16x32_bf16 v[122:125], v[54:57], v[74:77], v[122:125]
    ds_read_b64_tr_b16 v[114:115], v13 offset:10240
    ds_read_b64_tr_b16 v[116:117], v13 offset:10496
    v_mfma_f32_16x16x32_bf16 v[146:149], v[58:61], v[74:77], v[146:149]
    v_mfma_f32_16x16x32_bf16 v[126:129], v[54:57], v[78:81], v[126:129]
    v_mfma_f32_16x16x32_bf16 v[150:153], v[58:61], v[78:81], v[150:153]
    v_mfma_f32_16x16x32_bf16 v[130:133], v[54:57], v[82:85], v[130:133]
    v_mfma_f32_16x16x32_bf16 v[154:157], v[58:61], v[82:85], v[154:157]
    v_mfma_f32_16x16x32_bf16 v[134:137], v[54:57], v[86:89], v[134:137]
    v_mfma_f32_16x16x32_bf16 v[158:161], v[58:61], v[86:89], v[158:161]
    v_mfma_f32_16x16x32_bf16 v[138:141], v[54:57], v[90:93], v[138:141]
    v_mfma_f32_16x16x32_bf16 v[162:165], v[58:61], v[90:93], v[162:165]
    s_waitcnt lgkmcnt(0)
    s_barrier
    v_mfma_f32_16x16x32_bf16 v[26:29], v[22:25], v[62:65], v[26:29]
    ds_read_b128 v[54:57], v18 offset:28672
    ds_read_b128 v[58:61], v18 offset:30720
    v_mfma_f32_16x16x32_bf16 v[34:37], v[62:65], v[62:65], v[34:37]
    ds_read_b64_tr_b16 v[70:71], v12 offset:28672
    ds_read_b64_tr_b16 v[72:73], v12 offset:28928
    v_mfma_f32_16x16x32_bf16 v[30:33], v[22:25], v[66:69], v[30:33]
    ds_read_b64_tr_b16 v[74:75], v13 offset:28672
    ds_read_b64_tr_b16 v[76:77], v13 offset:28928
    v_mfma_f32_16x16x32_bf16 v[38:41], v[66:69], v[66:69], v[38:41]
    ds_read_b64_tr_b16 v[78:79], v12 offset:30720
    ds_read_b64_tr_b16 v[80:81], v12 offset:30976
    v_mfma_f32_16x16x32_bf16 v[118:121], v[62:65], v[94:97], v[118:121]
    ds_read_b64_tr_b16 v[82:83], v13 offset:30720
    ds_read_b64_tr_b16 v[84:85], v13 offset:30976
    v_mfma_f32_16x16x32_bf16 v[142:145], v[66:69], v[94:97], v[142:145]
    ds_read_b64_tr_b16 v[86:87], v12 offset:32768
    ds_read_b64_tr_b16 v[88:89], v12 offset:33024
    v_mfma_f32_16x16x32_bf16 v[122:125], v[62:65], v[98:101], v[122:125]
    ds_read_b64_tr_b16 v[90:91], v13 offset:32768
    ds_read_b64_tr_b16 v[92:93], v13 offset:33024
    v_mfma_f32_16x16x32_bf16 v[146:149], v[66:69], v[98:101], v[146:149]
    v_mfma_f32_16x16x32_bf16 v[126:129], v[62:65], v[102:105], v[126:129]
    v_mfma_f32_16x16x32_bf16 v[150:153], v[66:69], v[102:105], v[150:153]
    v_mfma_f32_16x16x32_bf16 v[130:133], v[62:65], v[106:109], v[130:133]
    v_mfma_f32_16x16x32_bf16 v[154:157], v[66:69], v[106:109], v[154:157]
    v_mfma_f32_16x16x32_bf16 v[134:137], v[62:65], v[110:113], v[134:137]
    v_mfma_f32_16x16x32_bf16 v[158:161], v[66:69], v[110:113], v[158:161]
    v_mfma_f32_16x16x32_bf16 v[138:141], v[62:65], v[114:117], v[138:141]
    v_mfma_f32_16x16x32_bf16 v[162:165], v[66:69], v[114:117], v[162:165]
    s_waitcnt lgkmcnt(0)
    v_mfma_f32_16x16x32_bf16 v[26:29], v[22:25], v[54:57], v[26:29]
    ds_read_b128 v[62:65], v19 offset:28672
    ds_read_b128 v[66:69], v19 offset:30720
    v_mfma_f32_16x16x32_bf16 v[34:37], v[54:57], v[54:57], v[34:37]
    ds_read_b64_tr_b16 v[94:95], v12 offset:34816
    ds_read_b64_tr_b16 v[96:97], v12 offset:35072
    v_mfma_f32_16x16x32_bf16 v[30:33], v[22:25], v[58:61], v[30:33]
    ds_read_b64_tr_b16 v[98:99], v13 offset:34816
    ds_read_b64_tr_b16 v[100:101], v13 offset:35072
    v_mfma_f32_16x16x32_bf16 v[38:41], v[58:61], v[58:61], v[38:41]
    ds_read_b64_tr_b16 v[102:103], v12 offset:36864
    ds_read_b64_tr_b16 v[104:105], v12 offset:37120
    v_mfma_f32_16x16x32_bf16 v[118:121], v[54:57], v[70:73], v[118:121]
    ds_read_b64_tr_b16 v[106:107], v13 offset:36864
    ds_read_b64_tr_b16 v[108:109], v13 offset:37120
    v_mfma_f32_16x16x32_bf16 v[142:145], v[58:61], v[70:73], v[142:145]
    ds_read_b64_tr_b16 v[110:111], v12 offset:38912
    ds_read_b64_tr_b16 v[112:113], v12 offset:39168
    v_mfma_f32_16x16x32_bf16 v[122:125], v[54:57], v[74:77], v[122:125]
    ds_read_b64_tr_b16 v[114:115], v13 offset:38912
    ds_read_b64_tr_b16 v[116:117], v13 offset:39168
    v_mfma_f32_16x16x32_bf16 v[146:149], v[58:61], v[74:77], v[146:149]
    v_mfma_f32_16x16x32_bf16 v[126:129], v[54:57], v[78:81], v[126:129]
    v_mfma_f32_16x16x32_bf16 v[150:153], v[58:61], v[78:81], v[150:153]
    v_mfma_f32_16x16x32_bf16 v[130:133], v[54:57], v[82:85], v[130:133]
    v_mfma_f32_16x16x32_bf16 v[154:157], v[58:61], v[82:85], v[154:157]
    v_mfma_f32_16x16x32_bf16 v[134:137], v[54:57], v[86:89], v[134:137]
    v_mfma_f32_16x16x32_bf16 v[158:161], v[58:61], v[86:89], v[158:161]
    v_mfma_f32_16x16x32_bf16 v[138:141], v[54:57], v[90:93], v[138:141]
    v_mfma_f32_16x16x32_bf16 v[162:165], v[58:61], v[90:93], v[162:165]
    s_waitcnt lgkmcnt(0)
    s_barrier
    v_mfma_f32_16x16x32_bf16 v[26:29], v[22:25], v[62:65], v[26:29]
    ds_read_b128 v[54:57], v20 offset:0
    ds_read_b128 v[58:61], v20 offset:2048
    v_mfma_f32_16x16x32_bf16 v[34:37], v[62:65], v[62:65], v[34:37]
    ds_read_b64_tr_b16 v[70:71], v14 offset:0
    ds_read_b64_tr_b16 v[72:73], v14 offset:256
    v_mfma_f32_16x16x32_bf16 v[30:33], v[22:25], v[66:69], v[30:33]
    ds_read_b64_tr_b16 v[74:75], v15 offset:0
    ds_read_b64_tr_b16 v[76:77], v15 offset:256
    v_mfma_f32_16x16x32_bf16 v[38:41], v[66:69], v[66:69], v[38:41]
    ds_read_b64_tr_b16 v[78:79], v14 offset:2048
    ds_read_b64_tr_b16 v[80:81], v14 offset:2304
    v_mfma_f32_16x16x32_bf16 v[118:121], v[62:65], v[94:97], v[118:121]
    ds_read_b64_tr_b16 v[82:83], v15 offset:2048
    ds_read_b64_tr_b16 v[84:85], v15 offset:2304
    v_mfma_f32_16x16x32_bf16 v[142:145], v[66:69], v[94:97], v[142:145]
    ds_read_b64_tr_b16 v[86:87], v14 offset:4096
    ds_read_b64_tr_b16 v[88:89], v14 offset:4352
    v_mfma_f32_16x16x32_bf16 v[122:125], v[62:65], v[98:101], v[122:125]
    ds_read_b64_tr_b16 v[90:91], v15 offset:4096
    ds_read_b64_tr_b16 v[92:93], v15 offset:4352
    v_mfma_f32_16x16x32_bf16 v[146:149], v[66:69], v[98:101], v[146:149]
    v_mfma_f32_16x16x32_bf16 v[126:129], v[62:65], v[102:105], v[126:129]
    v_mfma_f32_16x16x32_bf16 v[150:153], v[66:69], v[102:105], v[150:153]
    v_mfma_f32_16x16x32_bf16 v[130:133], v[62:65], v[106:109], v[130:133]
    v_mfma_f32_16x16x32_bf16 v[154:157], v[66:69], v[106:109], v[154:157]
    v_mfma_f32_16x16x32_bf16 v[134:137], v[62:65], v[110:113], v[134:137]
    v_mfma_f32_16x16x32_bf16 v[158:161], v[66:69], v[110:113], v[158:161]
    v_mfma_f32_16x16x32_bf16 v[138:141], v[62:65], v[114:117], v[138:141]
    v_mfma_f32_16x16x32_bf16 v[162:165], v[66:69], v[114:117], v[162:165]
    s_waitcnt lgkmcnt(0)
    v_mfma_f32_16x16x32_bf16 v[26:29], v[22:25], v[54:57], v[26:29]
    ds_read_b128 v[62:65], v21 offset:0
    ds_read_b128 v[66:69], v21 offset:2048
    v_mfma_f32_16x16x32_bf16 v[34:37], v[54:57], v[54:57], v[34:37]
    ds_read_b64_tr_b16 v[94:95], v14 offset:6144
    ds_read_b64_tr_b16 v[96:97], v14 offset:6400
    v_mfma_f32_16x16x32_bf16 v[30:33], v[22:25], v[58:61], v[30:33]
    ds_read_b64_tr_b16 v[98:99], v15 offset:6144
    ds_read_b64_tr_b16 v[100:101], v15 offset:6400
    v_mfma_f32_16x16x32_bf16 v[38:41], v[58:61], v[58:61], v[38:41]
    ds_read_b64_tr_b16 v[102:103], v14 offset:8192
    ds_read_b64_tr_b16 v[104:105], v14 offset:8448
    v_mfma_f32_16x16x32_bf16 v[118:121], v[54:57], v[70:73], v[118:121]
    ds_read_b64_tr_b16 v[106:107], v15 offset:8192
    ds_read_b64_tr_b16 v[108:109], v15 offset:8448
    v_mfma_f32_16x16x32_bf16 v[142:145], v[58:61], v[70:73], v[142:145]
    ds_read_b64_tr_b16 v[110:111], v14 offset:10240
    ds_read_b64_tr_b16 v[112:113], v14 offset:10496
    v_mfma_f32_16x16x32_bf16 v[122:125], v[54:57], v[74:77], v[122:125]
    ds_read_b64_tr_b16 v[114:115], v15 offset:10240
    ds_read_b64_tr_b16 v[116:117], v15 offset:10496
    v_mfma_f32_16x16x32_bf16 v[146:149], v[58:61], v[74:77], v[146:149]
    v_mfma_f32_16x16x32_bf16 v[126:129], v[54:57], v[78:81], v[126:129]
    v_mfma_f32_16x16x32_bf16 v[150:153], v[58:61], v[78:81], v[150:153]
    v_mfma_f32_16x16x32_bf16 v[130:133], v[54:57], v[82:85], v[130:133]
    v_mfma_f32_16x16x32_bf16 v[154:157], v[58:61], v[82:85], v[154:157]
    v_mfma_f32_16x16x32_bf16 v[134:137], v[54:57], v[86:89], v[134:137]
    v_mfma_f32_16x16x32_bf16 v[158:161], v[58:61], v[86:89], v[158:161]
    v_mfma_f32_16x16x32_bf16 v[138:141], v[54:57], v[90:93], v[138:141]
    v_mfma_f32_16x16x32_bf16 v[162:165], v[58:61], v[90:93], v[162:165]
    s_waitcnt lgkmcnt(0)
    s_barrier
    v_mfma_f32_16x16x32_bf16 v[26:29], v[22:25], v[62:65], v[26:29]
    ds_read_b128 v[54:57], v16 offset:0
    ds_read_b128 v[58:61], v16 offset:2048
    v_mfma_f32_16x16x32_bf16 v[34:37], v[62:65], v[62:65], v[34:37]
    ds_read_b64_tr_b16 v[70:71], v10 offset:0
    ds_read_b64_tr_b16 v[72:73], v10 offset:256
    v_mfma_f32_16x16x32_bf16 v[30:33], v[22:25], v[66:69], v[30:33]
    ds_read_b64_tr_b16 v[74:75], v11 offset:0
    ds_read_b64_tr_b16 v[76:77], v11 offset:256
    v_mfma_f32_16x16x32_bf16 v[38:41], v[66:69], v[66:69], v[38:41]
    ds_read_b64_tr_b16 v[78:79], v10 offset:2048
    ds_read_b64_tr_b16 v[80:81], v10 offset:2304
    v_mfma_f32_16x16x32_bf16 v[118:121], v[62:65], v[94:97], v[118:121]
    ds_read_b64_tr_b16 v[82:83], v11 offset:2048
    ds_read_b64_tr_b16 v[84:85], v11 offset:2304
    v_mfma_f32_16x16x32_bf16 v[142:145], v[66:69], v[94:97], v[142:145]
    ds_read_b64_tr_b16 v[86:87], v10 offset:4096
    ds_read_b64_tr_b16 v[88:89], v10 offset:4352
    v_mfma_f32_16x16x32_bf16 v[122:125], v[62:65], v[98:101], v[122:125]
    ds_read_b64_tr_b16 v[90:91], v11 offset:4096
    ds_read_b64_tr_b16 v[92:93], v11 offset:4352
    v_mfma_f32_16x16x32_bf16 v[146:149], v[66:69], v[98:101], v[146:149]
    v_mfma_f32_16x16x32_bf16 v[126:129], v[62:65], v[102:105], v[126:129]
    v_mfma_f32_16x16x32_bf16 v[150:153], v[66:69], v[102:105], v[150:153]
    v_mfma_f32_16x16x32_bf16 v[130:133], v[62:65], v[106:109], v[130:133]
    v_mfma_f32_16x16x32_bf16 v[154:157], v[66:69], v[106:109], v[154:157]
    v_mfma_f32_16x16x32_bf16 v[134:137], v[62:65], v[110:113], v[134:137]
    v_mfma_f32_16x16x32_bf16 v[158:161], v[66:69], v[110:113], v[158:161]
    v_mfma_f32_16x16x32_bf16 v[138:141], v[62:65], v[114:117], v[138:141]
    v_mfma_f32_16x16x32_bf16 v[162:165], v[66:69], v[114:117], v[162:165]
    s_waitcnt lgkmcnt(0)
    v_mfma_f32_16x16x32_bf16 v[26:29], v[22:25], v[54:57], v[26:29]
    ds_read_b128 v[62:65], v17 offset:0
    ds_read_b128 v[66:69], v17 offset:2048
    v_mfma_f32_16x16x32_bf16 v[34:37], v[54:57], v[54:57], v[34:37]
    ds_read_b64_tr_b16 v[94:95], v10 offset:6144
    ds_read_b64_tr_b16 v[96:97], v10 offset:6400
    v_mfma_f32_16x16x32_bf16 v[30:33], v[22:25], v[58:61], v[30:33]
    ds_read_b64_tr_b16 v[98:99], v11 offset:6144
    ds_read_b64_tr_b16 v[100:101], v11 offset:6400
    v_mfma_f32_16x16x32_bf16 v[38:41], v[58:61], v[58:61], v[38:41]
    ds_read_b64_tr_b16 v[102:103], v10 offset:8192
    ds_read_b64_tr_b16 v[104:105], v10 offset:8448
    v_mfma_f32_16x16x32_bf16 v[118:121], v[54:57], v[70:73], v[118:121]
    ds_read_b64_tr_b16 v[106:107], v11 offset:8192
    ds_read_b64_tr_b16 v[108:109], v11 offset:8448
    v_mfma_f32_16x16x32_bf16 v[142:145], v[58:61], v[70:73], v[142:145]
    ds_read_b64_tr_b16 v[110:111], v10 offset:10240
    ds_read_b64_tr_b16 v[112:113], v10 offset:10496
    v_mfma_f32_16x16x32_bf16 v[122:125], v[54:57], v[74:77], v[122:125]
    ds_read_b64_tr_b16 v[114:115], v11 offset:10240
    ds_read_b64_tr_b16 v[116:117], v11 offset:10496
    v_mfma_f32_16x16x32_bf16 v[146:149], v[58:61], v[74:77], v[146:149]
    v_mfma_f32_16x16x32_bf16 v[126:129], v[54:57], v[78:81], v[126:129]
    v_mfma_f32_16x16x32_bf16 v[150:153], v[58:61], v[78:81], v[150:153]
    v_mfma_f32_16x16x32_bf16 v[130:133], v[54:57], v[82:85], v[130:133]
    v_mfma_f32_16x16x32_bf16 v[154:157], v[58:61], v[82:85], v[154:157]
    v_mfma_f32_16x16x32_bf16 v[134:137], v[54:57], v[86:89], v[134:137]
    v_mfma_f32_16x16x32_bf16 v[158:161], v[58:61], v[86:89], v[158:161]
    v_mfma_f32_16x16x32_bf16 v[138:141], v[54:57], v[90:93], v[138:141]
    v_mfma_f32_16x16x32_bf16 v[162:165], v[58:61], v[90:93], v[162:165]
    s_waitcnt lgkmcnt(0)
    s_barrier
    v_mfma_f32_16x16x32_bf16 v[26:29], v[22:25], v[62:65], v[26:29]
    ds_read_b128 v[54:57], v16 offset:28672
    ds_read_b128 v[58:61], v16 offset:30720
    v_mfma_f32_16x16x32_bf16 v[34:37], v[62:65], v[62:65], v[34:37]
    ds_read_b64_tr_b16 v[70:71], v10 offset:28672
    ds_read_b64_tr_b16 v[72:73], v10 offset:28928
    v_mfma_f32_16x16x32_bf16 v[30:33], v[22:25], v[66:69], v[30:33]
    ds_read_b64_tr_b16 v[74:75], v11 offset:28672
    ds_read_b64_tr_b16 v[76:77], v11 offset:28928
    v_mfma_f32_16x16x32_bf16 v[38:41], v[66:69], v[66:69], v[38:41]
    ds_read_b64_tr_b16 v[78:79], v10 offset:30720
    ds_read_b64_tr_b16 v[80:81], v10 offset:30976
    v_mfma_f32_16x16x32_bf16 v[118:121], v[62:65], v[94:97], v[118:121]
    ds_read_b64_tr_b16 v[82:83], v11 offset:30720
    ds_read_b64_tr_b16 v[84:85], v11 offset:30976
    v_mfma_f32_16x16x32_bf16 v[142:145], v[66:69], v[94:97], v[142:145]
    ds_read_b64_tr_b16 v[86:87], v10 offset:32768
    ds_read_b64_tr_b16 v[88:89], v10 offset:33024
    v_mfma_f32_16x16x32_bf16 v[122:125], v[62:65], v[98:101], v[122:125]
    ds_read_b64_tr_b16 v[90:91], v11 offset:32768
    ds_read_b64_tr_b16 v[92:93], v11 offset:33024
    v_mfma_f32_16x16x32_bf16 v[146:149], v[66:69], v[98:101], v[146:149]
    v_mfma_f32_16x16x32_bf16 v[126:129], v[62:65], v[102:105], v[126:129]
    v_mfma_f32_16x16x32_bf16 v[150:153], v[66:69], v[102:105], v[150:153]
    v_mfma_f32_16x16x32_bf16 v[130:133], v[62:65], v[106:109], v[130:133]
    v_mfma_f32_16x16x32_bf16 v[154:157], v[66:69], v[106:109], v[154:157]
    v_mfma_f32_16x16x32_bf16 v[134:137], v[62:65], v[110:113], v[134:137]
    v_mfma_f32_16x16x32_bf16 v[158:161], v[66:69], v[110:113], v[158:161]
    v_mfma_f32_16x16x32_bf16 v[138:141], v[62:65], v[114:117], v[138:141]
    v_mfma_f32_16x16x32_bf16 v[162:165], v[66:69], v[114:117], v[162:165]
    s_waitcnt lgkmcnt(0)
    v_mfma_f32_16x16x32_bf16 v[26:29], v[22:25], v[54:57], v[26:29]
    ds_read_b128 v[62:65], v17 offset:28672
    ds_read_b128 v[66:69], v17 offset:30720
    v_mfma_f32_16x16x32_bf16 v[34:37], v[54:57], v[54:57], v[34:37]
    ds_read_b64_tr_b16 v[94:95], v10 offset:34816
    ds_read_b64_tr_b16 v[96:97], v10 offset:35072
    v_mfma_f32_16x16x32_bf16 v[30:33], v[22:25], v[58:61], v[30:33]
    ds_read_b64_tr_b16 v[98:99], v11 offset:34816
    ds_read_b64_tr_b16 v[100:101], v11 offset:35072
    v_mfma_f32_16x16x32_bf16 v[38:41], v[58:61], v[58:61], v[38:41]
    ds_read_b64_tr_b16 v[102:103], v10 offset:36864
    ds_read_b64_tr_b16 v[104:105], v10 offset:37120
    v_mfma_f32_16x16x32_bf16 v[118:121], v[54:57], v[70:73], v[118:121]
    ds_read_b64_tr_b16 v[106:107], v11 offset:36864
    ds_read_b64_tr_b16 v[108:109], v11 offset:37120
    v_mfma_f32_16x16x32_bf16 v[142:145], v[58:61], v[70:73], v[142:145]
    ds_read_b64_tr_b16 v[110:111], v10 offset:38912
    ds_read_b64_tr_b16 v[112:113], v10 offset:39168
    v_mfma_f32_16x16x32_bf16 v[122:125], v[54:57], v[74:77], v[122:125]
    ds_read_b64_tr_b16 v[114:115], v11 offset:38912
    ds_read_b64_tr_b16 v[116:117], v11 offset:39168
    v_mfma_f32_16x16x32_bf16 v[146:149], v[58:61], v[74:77], v[146:149]
    v_mfma_f32_16x16x32_bf16 v[126:129], v[54:57], v[78:81], v[126:129]
    v_mfma_f32_16x16x32_bf16 v[150:153], v[58:61], v[78:81], v[150:153]
    v_mfma_f32_16x16x32_bf16 v[130:133], v[54:57], v[82:85], v[130:133]
    v_mfma_f32_16x16x32_bf16 v[154:157], v[58:61], v[82:85], v[154:157]
    v_mfma_f32_16x16x32_bf16 v[134:137], v[54:57], v[86:89], v[134:137]
    v_mfma_f32_16x16x32_bf16 v[158:161], v[58:61], v[86:89], v[158:161]
    v_mfma_f32_16x16x32_bf16 v[138:141], v[54:57], v[90:93], v[138:141]
    v_mfma_f32_16x16x32_bf16 v[162:165], v[58:61], v[90:93], v[162:165]
    s_waitcnt lgkmcnt(0)
    s_barrier
    v_mfma_f32_16x16x32_bf16 v[26:29], v[22:25], v[62:65], v[26:29]
    ds_read_b128 v[54:57], v18 offset:0
    ds_read_b128 v[58:61], v18 offset:2048
    v_mfma_f32_16x16x32_bf16 v[34:37], v[62:65], v[62:65], v[34:37]
    ds_read_b64_tr_b16 v[70:71], v12 offset:0
    ds_read_b64_tr_b16 v[72:73], v12 offset:256
    v_mfma_f32_16x16x32_bf16 v[30:33], v[22:25], v[66:69], v[30:33]
    ds_read_b64_tr_b16 v[74:75], v13 offset:0
    ds_read_b64_tr_b16 v[76:77], v13 offset:256
    v_mfma_f32_16x16x32_bf16 v[38:41], v[66:69], v[66:69], v[38:41]
    ds_read_b64_tr_b16 v[78:79], v12 offset:2048
    ds_read_b64_tr_b16 v[80:81], v12 offset:2304
    v_mfma_f32_16x16x32_bf16 v[118:121], v[62:65], v[94:97], v[118:121]
    ds_read_b64_tr_b16 v[82:83], v13 offset:2048
    ds_read_b64_tr_b16 v[84:85], v13 offset:2304
    v_mfma_f32_16x16x32_bf16 v[142:145], v[66:69], v[94:97], v[142:145]
    ds_read_b64_tr_b16 v[86:87], v12 offset:4096
    ds_read_b64_tr_b16 v[88:89], v12 offset:4352
    v_mfma_f32_16x16x32_bf16 v[122:125], v[62:65], v[98:101], v[122:125]
    ds_read_b64_tr_b16 v[90:91], v13 offset:4096
    ds_read_b64_tr_b16 v[92:93], v13 offset:4352
    v_mfma_f32_16x16x32_bf16 v[146:149], v[66:69], v[98:101], v[146:149]
    v_mfma_f32_16x16x32_bf16 v[126:129], v[62:65], v[102:105], v[126:129]
    v_mfma_f32_16x16x32_bf16 v[150:153], v[66:69], v[102:105], v[150:153]
    v_mfma_f32_16x16x32_bf16 v[130:133], v[62:65], v[106:109], v[130:133]
    v_mfma_f32_16x16x32_bf16 v[154:157], v[66:69], v[106:109], v[154:157]
    v_mfma_f32_16x16x32_bf16 v[134:137], v[62:65], v[110:113], v[134:137]
    v_mfma_f32_16x16x32_bf16 v[158:161], v[66:69], v[110:113], v[158:161]
    v_mfma_f32_16x16x32_bf16 v[138:141], v[62:65], v[114:117], v[138:141]
    v_mfma_f32_16x16x32_bf16 v[162:165], v[66:69], v[114:117], v[162:165]
    s_waitcnt lgkmcnt(0)
    v_mfma_f32_16x16x32_bf16 v[26:29], v[22:25], v[54:57], v[26:29]
    ds_read_b128 v[62:65], v19 offset:0
    ds_read_b128 v[66:69], v19 offset:2048
    v_mfma_f32_16x16x32_bf16 v[34:37], v[54:57], v[54:57], v[34:37]
    ds_read_b64_tr_b16 v[94:95], v12 offset:6144
    ds_read_b64_tr_b16 v[96:97], v12 offset:6400
    v_mfma_f32_16x16x32_bf16 v[30:33], v[22:25], v[58:61], v[30:33]
    ds_read_b64_tr_b16 v[98:99], v13 offset:6144
    ds_read_b64_tr_b16 v[100:101], v13 offset:6400
    v_mfma_f32_16x16x32_bf16 v[38:41], v[58:61], v[58:61], v[38:41]
    ds_read_b64_tr_b16 v[102:103], v12 offset:8192
    ds_read_b64_tr_b16 v[104:105], v12 offset:8448
    v_mfma_f32_16x16x32_bf16 v[118:121], v[54:57], v[70:73], v[118:121]
    ds_read_b64_tr_b16 v[106:107], v13 offset:8192
    ds_read_b64_tr_b16 v[108:109], v13 offset:8448
    v_mfma_f32_16x16x32_bf16 v[142:145], v[58:61], v[70:73], v[142:145]
    ds_read_b64_tr_b16 v[110:111], v12 offset:10240
    ds_read_b64_tr_b16 v[112:113], v12 offset:10496
    v_mfma_f32_16x16x32_bf16 v[122:125], v[54:57], v[74:77], v[122:125]
    ds_read_b64_tr_b16 v[114:115], v13 offset:10240
    ds_read_b64_tr_b16 v[116:117], v13 offset:10496
    v_mfma_f32_16x16x32_bf16 v[146:149], v[58:61], v[74:77], v[146:149]
    v_mfma_f32_16x16x32_bf16 v[126:129], v[54:57], v[78:81], v[126:129]
    v_mfma_f32_16x16x32_bf16 v[150:153], v[58:61], v[78:81], v[150:153]
    v_mfma_f32_16x16x32_bf16 v[130:133], v[54:57], v[82:85], v[130:133]
    v_mfma_f32_16x16x32_bf16 v[154:157], v[58:61], v[82:85], v[154:157]
    v_mfma_f32_16x16x32_bf16 v[134:137], v[54:57], v[86:89], v[134:137]
    v_mfma_f32_16x16x32_bf16 v[158:161], v[58:61], v[86:89], v[158:161]
    v_mfma_f32_16x16x32_bf16 v[138:141], v[54:57], v[90:93], v[138:141]
    v_mfma_f32_16x16x32_bf16 v[162:165], v[58:61], v[90:93], v[162:165]
    s_waitcnt lgkmcnt(12)
    v_mfma_f32_16x16x32_bf16 v[26:29], v[22:25], v[62:65], v[26:29]
    v_mfma_f32_16x16x32_bf16 v[34:37], v[62:65], v[62:65], v[34:37]
    v_mfma_f32_16x16x32_bf16 v[30:33], v[22:25], v[66:69], v[30:33]
    v_mfma_f32_16x16x32_bf16 v[38:41], v[66:69], v[66:69], v[38:41]
    s_waitcnt lgkmcnt(0)
    s_barrier
    v_mfma_f32_16x16x32_bf16 v[118:121], v[62:65], v[94:97], v[118:121]
    s_mov_b32 s40, 0x100001
    s_mov_b32 s41, 0x10000100
    s_mov_b32 s42, 0x200002
    s_mov_b32 s43, 0x20000200
    s_mov_b32 s44, 0x400004
    s_mov_b32 s45, 0x40000400
    v_mfma_f32_16x16x32_bf16 v[142:145], v[66:69], v[94:97], v[142:145]
    s_mov_b32 s46, 0x800008
    s_mov_b32 s47, 0x80000800
    ds_read_b32 v166, v207 offset:0
    ds_read_b32 v70, v207 offset:384
    ds_read_b32 v170, v207 offset:64
    ds_read_b32 v74, v207 offset:448
    v_mfma_f32_16x16x32_bf16 v[122:125], v[62:65], v[98:101], v[122:125]
    v_mov_b32 v42, 0
    v_mov_b32 v44, 0
    v_cndmask_b32_e64 v42, v42, v34, s[40:41]
    v_cndmask_b32_e64 v44, v44, v38, s[40:41]
    v_cndmask_b32_e64 v42, v42, v35, s[42:43]
    v_cndmask_b32_e64 v44, v44, v39, s[42:43]
    v_mfma_f32_16x16x32_bf16 v[146:149], v[66:69], v[98:101], v[146:149]
    v_cndmask_b32_e64 v42, v42, v36, s[44:45]
    v_cndmask_b32_e64 v44, v44, v40, s[44:45]
    v_cndmask_b32_e64 v42, v42, v37, s[46:47]
    v_cndmask_b32_e64 v44, v44, v41, s[46:47]
    v_mov_b32 v43, v42
    v_mov_b32 v45, v44
    v_mfma_f32_16x16x32_bf16 v[126:129], v[62:65], v[102:105], v[126:129]
    ds_read_b32 v174, v207 offset:128
    ds_read_b32 v78, v207 offset:512
    ds_read_b32 v178, v207 offset:192
    ds_read_b32 v82, v207 offset:576
    v_permlane32_swap_b32 v42, v43
    v_permlane32_swap_b32 v44, v45
    v_mfma_f32_16x16x32_bf16 v[150:153], v[66:69], v[102:105], v[150:153]
    v_add_f32 v42, v42, v43
    v_add_f32 v44, v44, v45
    v_mov_b32 v43, v42
    v_mov_b32 v45, v44
    s_nop 0
    v_permlane16_swap_b32 v42, v43
    v_permlane16_swap_b32 v44, v45
    v_mfma_f32_16x16x32_bf16 v[130:133], v[62:65], v[106:109], v[130:133]
    v_add_f32 v42, v42, v43
    v_add_f32 v44, v44, v45
    v_mul_f32 v50, 0x3b000000, v26
    v_mul_f32 v51, 0x3b000000, v30
    ds_read_b32 v182, v207 offset:256
    ds_read_b32 v86, v207 offset:640
    v_mfma_f32_16x16x32_bf16 v[154:157], v[66:69], v[106:109], v[154:157]
    ds_read_b32 v186, v207 offset:320
    ds_read_b32 v90, v207 offset:704
    v_mul_f32 v52, 0x3b000000, v42
    v_mul_f32 v53, 0x3b000000, v44
    v_fma_f32 v52, -v50, v50, v52
    v_fma_f32 v53, -v51, v51, v53
    v_mfma_f32_16x16x32_bf16 v[134:137], v[62:65], v[110:113], v[134:137]
    v_max_f32 v52, 0, v52
    v_max_f32 v53, 0, v53
    v_cvt_pk_bf16_f32 v42, v50, v52
    v_cvt_pk_bf16_f32 v44, v51, v53
    v_lshlrev_b32 v50, 16, v42
    v_lshlrev_b32 v51, 16, v44
    v_mfma_f32_16x16x32_bf16 v[158:161], v[66:69], v[110:113], v[158:161]
    v_and_b32 v52, 0xffff0000, v42
    v_and_b32 v53, 0xffff0000, v44
    v_add_f32 v52, 0x3727c5ac, v52
    v_add_f32 v53, 0x3727c5ac, v53
    v_cvt_pk_bf16_f32 v42, v52, v52
    v_cvt_pk_bf16_f32 v44, v53, v53
    v_mfma_f32_16x16x32_bf16 v[138:141], v[62:65], v[114:117], v[138:141]
    v_lshlrev_b32 v52, 16, v42
    v_lshlrev_b32 v53, 16, v44
    v_sqrt_f32 v52, v52
    v_sqrt_f32 v53, v53
    v_cvt_pk_bf16_f32 v42, v52, v52
    v_cvt_pk_bf16_f32 v44, v53, v53
    v_mfma_f32_16x16x32_bf16 v[162:165], v[66:69], v[114:117], v[162:165]
    v_lshlrev_b32 v52, 16, v42
    v_lshlrev_b32 v53, 16, v44
    v_rcp_f32 v52, v52
    v_rcp_f32 v53, v53
    ds_write_b32 v208, v50 offset:0
    ds_write_b32 v208, v52 offset:64
    ds_write_b32 v208, v51 offset:128
    ds_write_b32 v208, v53 offset:192
    s_waitcnt lgkmcnt(0)
    ds_read_b128 v[190:193], v209 offset:0
    ds_read_b128 v[194:197], v209 offset:64
    ds_read_b128 v[198:201], v209 offset:128
    ds_read_b128 v[202:205], v209 offset:192
    s_waitcnt lgkmcnt(0)
    v_add_f32 v166, v166, v70
    v_add_f32 v170, v170, v74
    v_add_f32 v174, v174, v78
    v_add_f32 v178, v178, v82
    v_add_f32 v182, v182, v86
    v_add_f32 v186, v186, v90
    s_add_u32 s29, s28, 0
    v_pk_fma_f32 v[118:119], v[190:191], v[166:167], v[118:119] op_sel:[0,0,0] op_sel_hi:[1,0,1] neg_lo:[0,1,0] neg_hi:[0,1,0]
    v_pk_fma_f32 v[120:121], v[192:193], v[166:167], v[120:121] op_sel:[0,0,0] op_sel_hi:[1,0,1] neg_lo:[0,1,0] neg_hi:[0,1,0]
    v_pk_mul_f32 v[118:119], v[118:119], v[194:195]
    v_pk_mul_f32 v[120:121], v[120:121], v[196:197]
    v_cvt_pk_bf16_f32 v118, v118, v119
    v_cvt_pk_bf16_f32 v119, v120, v121
    buffer_store_dwordx2 v[118:119], v9, s[32:35], s29 offen offset:0
    v_pk_fma_f32 v[142:143], v[198:199], v[166:167], v[142:143] op_sel:[0,0,0] op_sel_hi:[1,0,1] neg_lo:[0,1,0] neg_hi:[0,1,0]
    v_pk_fma_f32 v[144:145], v[200:201], v[166:167], v[144:145] op_sel:[0,0,0] op_sel_hi:[1,0,1] neg_lo:[0,1,0] neg_hi:[0,1,0]
    v_pk_mul_f32 v[142:143], v[142:143], v[202:203]
    v_pk_mul_f32 v[144:145], v[144:145], v[204:205]
    v_cvt_pk_bf16_f32 v142, v142, v143
    v_cvt_pk_bf16_f32 v143, v144, v145
    buffer_store_dwordx2 v[142:143], v9, s[32:35], s29 offen offset:512
    s_add_u32 s29, s28, 65536
    v_pk_fma_f32 v[122:123], v[190:191], v[170:171], v[122:123] op_sel:[0,0,0] op_sel_hi:[1,0,1] neg_lo:[0,1,0] neg_hi:[0,1,0]
    v_pk_fma_f32 v[124:125], v[192:193], v[170:171], v[124:125] op_sel:[0,0,0] op_sel_hi:[1,0,1] neg_lo:[0,1,0] neg_hi:[0,1,0]
    v_pk_mul_f32 v[122:123], v[122:123], v[194:195]
    v_pk_mul_f32 v[124:125], v[124:125], v[196:197]
    v_cvt_pk_bf16_f32 v122, v122, v123
    v_cvt_pk_bf16_f32 v123, v124, v125
    buffer_store_dwordx2 v[122:123], v9, s[32:35], s29 offen offset:0
    v_pk_fma_f32 v[146:147], v[198:199], v[170:171], v[146:147] op_sel:[0,0,0] op_sel_hi:[1,0,1] neg_lo:[0,1,0] neg_hi:[0,1,0]
    v_pk_fma_f32 v[148:149], v[200:201], v[170:171], v[148:149] op_sel:[0,0,0] op_sel_hi:[1,0,1] neg_lo:[0,1,0] neg_hi:[0,1,0]
    v_pk_mul_f32 v[146:147], v[146:147], v[202:203]
    v_pk_mul_f32 v[148:149], v[148:149], v[204:205]
    v_cvt_pk_bf16_f32 v146, v146, v147
    v_cvt_pk_bf16_f32 v147, v148, v149
    buffer_store_dwordx2 v[146:147], v9, s[32:35], s29 offen offset:512
    s_add_u32 s29, s28, 131072
    v_pk_fma_f32 v[126:127], v[190:191], v[174:175], v[126:127] op_sel:[0,0,0] op_sel_hi:[1,0,1] neg_lo:[0,1,0] neg_hi:[0,1,0]
    v_pk_fma_f32 v[128:129], v[192:193], v[174:175], v[128:129] op_sel:[0,0,0] op_sel_hi:[1,0,1] neg_lo:[0,1,0] neg_hi:[0,1,0]
    v_pk_mul_f32 v[126:127], v[126:127], v[194:195]
    v_pk_mul_f32 v[128:129], v[128:129], v[196:197]
    v_cvt_pk_bf16_f32 v126, v126, v127
    v_cvt_pk_bf16_f32 v127, v128, v129
    buffer_store_dwordx2 v[126:127], v9, s[32:35], s29 offen offset:0
    v_pk_fma_f32 v[150:151], v[198:199], v[174:175], v[150:151] op_sel:[0,0,0] op_sel_hi:[1,0,1] neg_lo:[0,1,0] neg_hi:[0,1,0]
    v_pk_fma_f32 v[152:153], v[200:201], v[174:175], v[152:153] op_sel:[0,0,0] op_sel_hi:[1,0,1] neg_lo:[0,1,0] neg_hi:[0,1,0]
    v_pk_mul_f32 v[150:151], v[150:151], v[202:203]
    v_pk_mul_f32 v[152:153], v[152:153], v[204:205]
    v_cvt_pk_bf16_f32 v150, v150, v151
    v_cvt_pk_bf16_f32 v151, v152, v153
    buffer_store_dwordx2 v[150:151], v9, s[32:35], s29 offen offset:512
    s_add_u32 s29, s28, 196608
    v_pk_fma_f32 v[130:131], v[190:191], v[178:179], v[130:131] op_sel:[0,0,0] op_sel_hi:[1,0,1] neg_lo:[0,1,0] neg_hi:[0,1,0]
    v_pk_fma_f32 v[132:133], v[192:193], v[178:179], v[132:133] op_sel:[0,0,0] op_sel_hi:[1,0,1] neg_lo:[0,1,0] neg_hi:[0,1,0]
    v_pk_mul_f32 v[130:131], v[130:131], v[194:195]
    v_pk_mul_f32 v[132:133], v[132:133], v[196:197]
    v_cvt_pk_bf16_f32 v130, v130, v131
    v_cvt_pk_bf16_f32 v131, v132, v133
    buffer_store_dwordx2 v[130:131], v9, s[32:35], s29 offen offset:0
    v_pk_fma_f32 v[154:155], v[198:199], v[178:179], v[154:155] op_sel:[0,0,0] op_sel_hi:[1,0,1] neg_lo:[0,1,0] neg_hi:[0,1,0]
    v_pk_fma_f32 v[156:157], v[200:201], v[178:179], v[156:157] op_sel:[0,0,0] op_sel_hi:[1,0,1] neg_lo:[0,1,0] neg_hi:[0,1,0]
    v_pk_mul_f32 v[154:155], v[154:155], v[202:203]
    v_pk_mul_f32 v[156:157], v[156:157], v[204:205]
    v_cvt_pk_bf16_f32 v154, v154, v155
    v_cvt_pk_bf16_f32 v155, v156, v157
    buffer_store_dwordx2 v[154:155], v9, s[32:35], s29 offen offset:512
    s_add_u32 s29, s28, 262144
    v_pk_fma_f32 v[134:135], v[190:191], v[182:183], v[134:135] op_sel:[0,0,0] op_sel_hi:[1,0,1] neg_lo:[0,1,0] neg_hi:[0,1,0]
    v_pk_fma_f32 v[136:137], v[192:193], v[182:183], v[136:137] op_sel:[0,0,0] op_sel_hi:[1,0,1] neg_lo:[0,1,0] neg_hi:[0,1,0]
    v_pk_mul_f32 v[134:135], v[134:135], v[194:195]
    v_pk_mul_f32 v[136:137], v[136:137], v[196:197]
    v_cvt_pk_bf16_f32 v134, v134, v135
    v_cvt_pk_bf16_f32 v135, v136, v137
    buffer_store_dwordx2 v[134:135], v9, s[32:35], s29 offen offset:0
    v_pk_fma_f32 v[158:159], v[198:199], v[182:183], v[158:159] op_sel:[0,0,0] op_sel_hi:[1,0,1] neg_lo:[0,1,0] neg_hi:[0,1,0]
    v_pk_fma_f32 v[160:161], v[200:201], v[182:183], v[160:161] op_sel:[0,0,0] op_sel_hi:[1,0,1] neg_lo:[0,1,0] neg_hi:[0,1,0]
    v_pk_mul_f32 v[158:159], v[158:159], v[202:203]
    v_pk_mul_f32 v[160:161], v[160:161], v[204:205]
    v_cvt_pk_bf16_f32 v158, v158, v159
    v_cvt_pk_bf16_f32 v159, v160, v161
    buffer_store_dwordx2 v[158:159], v9, s[32:35], s29 offen offset:512
    s_add_u32 s29, s28, 327680
    v_pk_fma_f32 v[138:139], v[190:191], v[186:187], v[138:139] op_sel:[0,0,0] op_sel_hi:[1,0,1] neg_lo:[0,1,0] neg_hi:[0,1,0]
    v_pk_fma_f32 v[140:141], v[192:193], v[186:187], v[140:141] op_sel:[0,0,0] op_sel_hi:[1,0,1] neg_lo:[0,1,0] neg_hi:[0,1,0]
    v_pk_mul_f32 v[138:139], v[138:139], v[194:195]
    v_pk_mul_f32 v[140:141], v[140:141], v[196:197]
    v_cvt_pk_bf16_f32 v138, v138, v139
    v_cvt_pk_bf16_f32 v139, v140, v141
    buffer_store_dwordx2 v[138:139], v9, s[32:35], s29 offen offset:0
    v_pk_fma_f32 v[162:163], v[198:199], v[186:187], v[162:163] op_sel:[0,0,0] op_sel_hi:[1,0,1] neg_lo:[0,1,0] neg_hi:[0,1,0]
    v_pk_fma_f32 v[164:165], v[200:201], v[186:187], v[164:165] op_sel:[0,0,0] op_sel_hi:[1,0,1] neg_lo:[0,1,0] neg_hi:[0,1,0]
    v_pk_mul_f32 v[162:163], v[162:163], v[202:203]
    v_pk_mul_f32 v[164:165], v[164:165], v[204:205]
    v_cvt_pk_bf16_f32 v162, v162, v163
    v_cvt_pk_bf16_f32 v163, v164, v165
    buffer_store_dwordx2 v[162:163], v9, s[32:35], s29 offen offset:512
    s_endpgm
K1_done:
    s_endpgm
.globl kf_kernel
.p2align 8
.type kf_kernel,@function
kf_kernel:
    s_cmp_ge_u32 s2, 256
    s_cbranch_scc1 KF_done
    s_load_dwordx2 s[4:5], s[0:1], 72
    s_getreg_b32 s98, hwreg(HW_REG_XCC_ID, 0, 4)
    v_lshrrev_b32 v1, 6, v0
    s_nop 0
    v_readfirstlane_b32 s3, v1
    s_and_b32 s10, s98, 7
    s_andn2_b32 s2, s2, 7
    s_or_b32 s2, s2, s10
    s_lshl_b32 s8, s98, 3
    s_add_u32 s8, s8, s10
    s_lshl_b32 s8, s8, 10
    s_add_u32 s8, s8, 0x1500000
    s_lshl_b32 s10, s10, 10
    s_add_u32 s10, s10, 0x151e300
    s_mov_b32 s100, 0
    s_mov_b32 s6, 0x10000000
    s_mov_b32 s7, 0x00020000
    s_lshr_b32 s11, s2, 3
    s_lshl_b32 s11, 1, s11
    v_mov_b32 v252, s11
    v_mov_b32 v253, 1
    s_mov_b32 s9, s10
J_P2:
    s_nop 7
    s_nop 7
    s_load_dwordx2 s[12:13], s[0:1], 16
    s_mov_b32 s14, 0x80000
    s_mov_b32 s15, 0x00020000
    s_lshr_b32 s20, s2, 5
    s_lshl_b32 s20, s20, 2
    s_and_b32 s21, s3, 3
    s_add_u32 s20, s20, s21
    s_and_b32 s21, s2, 7
    s_lshl_b32 s21, s21, 2
    s_bfe_u32 s22, s2, 0x20003
    s_add_u32 s21, s21, s22
    s_lshl_b32 s21, s21, 1
    s_lshr_b32 s23, s3, 2
    s_add_u32 s21, s21, s23
    v_and_b32 v1, 63, v0
    v_and_b32 v2, 31, v1
    v_lshrrev_b32 v3, 5, v1
    s_lshl_b32 s22, s22, 6
    s_add_u32 s22, s22, s23
    s_lshl_b32 s23, s20, 1
    s_add_u32 s22, s22, s23
    s_add_u32 s22, s22, s8
    s_add_u32 s22, s22, 128
    s_lshl_b32 s23, s20, 16
    s_lshl_b32 s24, s21, 10
    s_add_u32 s23, s23, s24
    v_lshlrev_b32 v10, 5, v2
    v_lshl_add_u32 v10, v3, 4, v10
    v_add_u32 v4, s23, v10
    v_add_u32 v5, 0x1fe000, v4
    v_and_b32 v10, 15, v1
    v_lshlrev_b32 v10, 5, v10
    v_lshl_add_u32 v10, v3, 9, v10
    v_and_b32 v11, 16, v1
    v_add3_u32 v10, v10, v11, s23
    v_add_u32 v6, 0x3fe000, v10
    s_lshr_b32 s26, s3, 2
    s_mul_i32 s24, s26, 5120
    s_lshl_b32 s26, s26, 12
    s_add_u32 s27, s26, 4096
    s_and_b32 s10, s3, 3
    s_mul_i32 s10, s10, 10240
    s_add_u32 s24, s24, s10
    s_add_u32 s24, s24, 73728
    s_waitcnt lgkmcnt(0)
    buffer_load_dwordx4 v[248:251], v4, s[4:7], 0 offen
    s_mov_b32 s18, s24
    s_add_u32 m0, s18, 0
    s_nop 0
    buffer_load_dwordx4 v5, s[4:7], s26 offen offset:0 lds
    buffer_load_dwordx4 v5, s[4:7], s26 offen offset:1024 lds
    buffer_load_dwordx4 v5, s[4:7], s26 offen offset:2048 lds
    buffer_load_dwordx4 v5, s[4:7], s26 offen offset:3072 lds
    s_add_u32 m0, s18, 4096
    s_nop 0
    buffer_load_dwordx4 v5, s[4:7], s27 offen lds
    s_getpc_b64 s[30:31]
KF_PC:
    s_andn2_b32 s10, s2, 7
    s_add_u32 s10, s10, s3
    s_lshl_b32 s10, s10, 8
    s_add_u32 s11, s10, 128
    s_min_u32 s10, s10, KF_END-KF_PC
    s_min_u32 s11, s11, KF_END-KF_PC
    s_load_dword s96, s[30:31], s10
    s_load_dword s99, s[30:31], s11
    s_or_b32 s29, s3, s100
    s_cmp_lg_u32 s29, 0
    s_cbranch_scc1 P2_ncl
    s_mov_b64 exec, 1
    buffer_atomic_or v252, off, s[4:7], s8 sc0
    buffer_store_dword v253, off, s[4:7], s9 sc1
    s_mov_b64 exec, -1
P2_ncl:
    s_lshl_b32 s25, s21, 5
    s_add_u32 s25, s25, s20
    s_lshl_b32 s25, s25, 10
    s_add_u32 s25, s25, 0x600000
    v_lshlrev_b32 v10, 4, v1
    v_add_u32 v8, s25, v10
    s_sub_u32 s24, s24, s26
    v_add_u32 v174, s24, v10
    v_and_b32 v10, 15, v1
    v_lshl_add_u32 v10, v3, 4, v10
    v_lshlrev_b32 v10, 4, v10
    s_add_u32 s24, s24, 40960
    v_add_u32 v175, s24, v10
    s_mov_b32 s16, 0x3f803f80
    s_mov_b32 s17, 0x3f803f80
    s_mov_b32 s20, 0x0000ffff
    s_sub_i32 s28, 8, s21
    s_mov_b32 s21, 0x0000ffff
    v_pk_mov_b32 v[212:213], s[16:17], s[16:17]
    v_pk_mov_b32 v[214:215], s[16:17], s[16:17]
    v_pk_mov_b32 v[216:217], s[16:17], s[16:17]
    v_pk_mov_b32 v[218:219], s[16:17], s[16:17]
    v_pk_mov_b32 v[220:221], s[16:17], s[16:17]
    v_pk_mov_b32 v[222:223], s[16:17], s[16:17]
    v_pk_mov_b32 v[224:225], s[16:17], s[16:17]
    v_pk_mov_b32 v[226:227], s[16:17], s[16:17]
    v_pk_mov_b32 v[228:229], s[16:17], s[16:17]
    v_pk_mov_b32 v[230:231], s[16:17], s[16:17]
    v_pk_mov_b32 v[232:233], s[16:17], s[16:17]
    v_pk_mov_b32 v[234:235], s[16:17], s[16:17]
    v_pk_mov_b32 v[236:237], s[16:17], s[16:17]
    v_pk_mov_b32 v[238:239], s[16:17], s[16:17]
    v_pk_mov_b32 v[240:241], s[16:17], s[16:17]
    v_pk_mov_b32 v[242:243], s[16:17], s[16:17]
    v_pk_mov_b32 v[244:245], s[16:17], s[16:17]
    v_pk_mov_b32 v[246:247], s[16:17], s[16:17]
    v_mov_b32 v9, 0xce6e6b28
    s_max_i32 s28, s28, 0
    s_mov_b32 s32, 0x0
    s_mov_b32 s33, 0xf
    s_mov_b32 s34, 0x1
    s_mov_b32 s35, 0x1f
    s_mov_b32 s36, 0x3
    s_mov_b32 s37, 0x3f
    s_mov_b32 s38, 0x7
    s_mov_b32 s39, 0x7f
    s_mov_b32 s40, 0xff
    s_mov_b32 s41, 0xfff
    s_mov_b32 s42, 0x1ff
    s_mov_b32 s43, 0x1fff
    s_mov_b32 s44, 0x3ff
    s_mov_b32 s45, 0x3fff
    s_mov_b32 s46, 0x7ff
    s_mov_b32 s47, 0x7fff
    s_mov_b32 s48, 0xffff
    s_mov_b32 s49, 0xfffff
    s_mov_b32 s50, 0x1ffff
    s_mov_b32 s51, 0x1fffff
    s_mov_b32 s52, 0x3ffff
    s_mov_b32 s53, 0x3fffff
    s_mov_b32 s54, 0x7ffff
    s_mov_b32 s55, 0x7fffff
    s_mov_b32 s56, 0xffffff
    s_mov_b32 s57, 0xfffffff
    s_mov_b32 s58, 0x1ffffff
    s_mov_b32 s59, 0x1fffffff
    s_mov_b32 s60, 0x3ffffff
    s_mov_b32 s61, 0x3fffffff
    s_mov_b32 s62, 0x7ffffff
    s_mov_b32 s63, 0x7fffffff
    v_mov_b32 v156, 0xffff
    v_mov_b32 v157, 0xffff0000
    v_cndmask_b32_e64 v160, 0, v156, s[32:33]
    v_cndmask_b32_e64 v158, 0, v157, s[34:35]
    v_or_b32 v160, v160, v158
    v_cndmask_b32_e64 v161, 0, v156, s[36:37]
    v_cndmask_b32_e64 v158, 0, v157, s[38:39]
    v_or_b32 v161, v161, v158
    v_cndmask_b32_e64 v162, 0, v156, s[40:41]
    v_cndmask_b32_e64 v158, 0, v157, s[42:43]
    v_or_b32 v162, v162, v158
    v_cndmask_b32_e64 v163, 0, v156, s[44:45]
    v_cndmask_b32_e64 v158, 0, v157, s[46:47]
    v_or_b32 v163, v163, v158
    v_cndmask_b32_e64 v164, 0, v156, s[48:49]
    v_cndmask_b32_e64 v158, 0, v157, s[50:51]
    v_or_b32 v164, v164, v158
    v_cndmask_b32_e64 v165, 0, v156, s[52:53]
    v_cndmask_b32_e64 v158, 0, v157, s[54:55]
    v_or_b32 v165, v165, v158
    v_cndmask_b32_e64 v166, 0, v156, s[56:57]
    v_cndmask_b32_e64 v158, 0, v157, s[58:59]
    v_or_b32 v166, v166, v158
    v_cndmask_b32_e64 v167, 0, v156, s[60:61]
    v_cndmask_b32_e64 v158, 0, v157, s[62:63]
    v_or_b32 v167, v167, v158
    s_lshr_b32 s10, s2, 5
    s_lshl_b32 s10, s10, 7
    v_lshrrev_b32 v172, 5, v1
    v_lshlrev_b32 v172, 2, v172
    v_bfe_u32 v173, v1, 2, 2
    v_add_u32 v172, v172, v173
    v_lshlrev_b32 v172, 10, v172
    v_bfe_u32 v173, v1, 4, 1
    v_lshl_add_u32 v172, v173, 6, v172
    v_and_b32 v173, 3, v1
    v_lshl_add_u32 v172, v173, 4, v172
    v_add_u32 v254, s10, v172
    s_and_b32 s10, s3, 3
    s_lshl_b32 s24, s10, 14
    s_lshl_b32 s11, s26, 1
    s_add_u32 s24, s24, s11
    s_lshl_b32 s23, s24, 3
    s_and_b32 s10, s2, 7
    s_lshl_b32 s10, s10, 2
    s_bfe_u32 s11, s2, 0x20003
    s_add_u32 s10, s10, s11
    s_lshr_b32 s11, s2, 5
    s_lshl_b32 s25, s10, 16
    s_lshl_b32 s31, s11, 7
    s_add_u32 s31, s25, s31
    s_add_u32 s31, s31, 0x800000
    s_lshl_b32 s11, s11, 11
    s_add_u32 s25, s25, s11
    s_add_u32 s25, s25, 0x1200000
    s_lshl_b32 s10, s10, 12
    s_add_u32 s10, s10, 0x1410000
    s_movk_i32 s11, 128
    s_cmp_eq_u32 s3, 4
    s_cselect_b32 s25, s31, s25
    s_cselect_b32 s11, 1024, s11
    s_mov_b32 s31, 16384
    s_bitcmp1_b32 208, s3
    s_cselect_b32 s25, s10, s25
    s_cselect_b32 s11, 64, s11
    s_cselect_b32 s31, 1024, s31
    v_lshrrev_b32 v172, 4, v1
    v_mul_u32_u24 v172, s31, v172
    v_and_b32 v173, 15, v1
    v_mad_u32_u24 v172, v173, s11, v172
    s_add_u32 m0, s18, 40960
    s_nop 0
    buffer_load_dwordx4 v6, s[4:7], s26 offen offset:0 lds
    buffer_load_dwordx4 v6, s[4:7], s26 offen offset:1024 lds
    buffer_load_dwordx4 v6, s[4:7], s26 offen offset:2048 lds
    buffer_load_dwordx4 v6, s[4:7], s26 offen offset:3072 lds
    s_add_u32 m0, s18, 45056
    s_nop 0
    buffer_load_dwordx4 v6, s[4:7], s27 offen lds
    s_cmp_eq_u32 s28, 0
    s_cbranch_scc1 P2_fmend
    v_pk_mov_b32 v[12:13], v[8:9], v[8:9] op_sel:[1,1]
    v_pk_mov_b32 v[14:15], v[8:9], v[8:9] op_sel:[1,1]
    v_pk_mov_b32 v[16:17], v[8:9], v[8:9] op_sel:[1,1]
    v_pk_mov_b32 v[18:19], v[8:9], v[8:9] op_sel:[1,1]
    v_pk_mov_b32 v[20:21], v[8:9], v[8:9] op_sel:[1,1]
    v_pk_mov_b32 v[22:23], v[8:9], v[8:9] op_sel:[1,1]
    v_pk_mov_b32 v[24:25], v[8:9], v[8:9] op_sel:[1,1]
    v_pk_mov_b32 v[26:27], v[8:9], v[8:9] op_sel:[1,1]
    v_pk_mov_b32 v[28:29], v[8:9], v[8:9] op_sel:[1,1]
    v_pk_mov_b32 v[30:31], v[8:9], v[8:9] op_sel:[1,1]
    v_pk_mov_b32 v[32:33], v[8:9], v[8:9] op_sel:[1,1]
    v_pk_mov_b32 v[34:35], v[8:9], v[8:9] op_sel:[1,1]
    v_pk_mov_b32 v[36:37], v[8:9], v[8:9] op_sel:[1,1]
    v_pk_mov_b32 v[38:39], v[8:9], v[8:9] op_sel:[1,1]
    v_pk_mov_b32 v[40:41], v[8:9], v[8:9] op_sel:[1,1]
    v_pk_mov_b32 v[42:43], v[8:9], v[8:9] op_sel:[1,1]
    v_pk_mov_b32 v[44:45], v[8:9], v[8:9] op_sel:[1,1]
    v_pk_mov_b32 v[46:47], v[8:9], v[8:9] op_sel:[1,1]
    v_pk_mov_b32 v[48:49], v[8:9], v[8:9] op_sel:[1,1]
    v_pk_mov_b32 v[50:51], v[8:9], v[8:9] op_sel:[1,1]
    v_pk_mov_b32 v[52:53], v[8:9], v[8:9] op_sel:[1,1]
    v_pk_mov_b32 v[54:55], v[8:9], v[8:9] op_sel:[1,1]
    v_pk_mov_b32 v[56:57], v[8:9], v[8:9] op_sel:[1,1]
    v_pk_mov_b32 v[58:59], v[8:9], v[8:9] op_sel:[1,1]
    v_pk_mov_b32 v[60:61], v[8:9], v[8:9] op_sel:[1,1]
    v_pk_mov_b32 v[62:63], v[8:9], v[8:9] op_sel:[1,1]
    v_pk_mov_b32 v[64:65], v[8:9], v[8:9] op_sel:[1,1]
    v_pk_mov_b32 v[66:67], v[8:9], v[8:9] op_sel:[1,1]
    v_pk_mov_b32 v[68:69], v[8:9], v[8:9] op_sel:[1,1]
    v_pk_mov_b32 v[70:71], v[8:9], v[8:9] op_sel:[1,1]
    v_pk_mov_b32 v[72:73], v[8:9], v[8:9] op_sel:[1,1]
    v_pk_mov_b32 v[74:75], v[8:9], v[8:9] op_sel:[1,1]
    v_pk_mov_b32 v[76:77], v[8:9], v[8:9] op_sel:[1,1]
    v_pk_mov_b32 v[78:79], v[8:9], v[8:9] op_sel:[1,1]
    v_pk_mov_b32 v[80:81], v[8:9], v[8:9] op_sel:[1,1]
    v_pk_mov_b32 v[82:83], v[8:9], v[8:9] op_sel:[1,1]
    v_pk_mov_b32 v[84:85], v[8:9], v[8:9] op_sel:[1,1]
    v_pk_mov_b32 v[86:87], v[8:9], v[8:9] op_sel:[1,1]
    v_pk_mov_b32 v[88:89], v[8:9], v[8:9] op_sel:[1,1]
    v_pk_mov_b32 v[90:91], v[8:9], v[8:9] op_sel:[1,1]
    v_pk_mov_b32 v[92:93], v[8:9], v[8:9] op_sel:[1,1]
    v_pk_mov_b32 v[94:95], v[8:9], v[8:9] op_sel:[1,1]
    v_pk_mov_b32 v[96:97], v[8:9], v[8:9] op_sel:[1,1]
    v_pk_mov_b32 v[98:99], v[8:9], v[8:9] op_sel:[1,1]
    v_pk_mov_b32 v[100:101], v[8:9], v[8:9] op_sel:[1,1]
    v_pk_mov_b32 v[102:103], v[8:9], v[8:9] op_sel:[1,1]
    v_pk_mov_b32 v[104:105], v[8:9], v[8:9] op_sel:[1,1]
    v_pk_mov_b32 v[106:107], v[8:9], v[8:9] op_sel:[1,1]
    v_pk_mov_b32 v[108:109], v[8:9], v[8:9] op_sel:[1,1]
    v_pk_mov_b32 v[110:111], v[8:9], v[8:9] op_sel:[1,1]
    v_pk_mov_b32 v[112:113], v[8:9], v[8:9] op_sel:[1,1]
    v_pk_mov_b32 v[114:115], v[8:9], v[8:9] op_sel:[1,1]
    v_pk_mov_b32 v[116:117], v[8:9], v[8:9] op_sel:[1,1]
    v_pk_mov_b32 v[118:119], v[8:9], v[8:9] op_sel:[1,1]
    v_pk_mov_b32 v[120:121], v[8:9], v[8:9] op_sel:[1,1]
    v_pk_mov_b32 v[122:123], v[8:9], v[8:9] op_sel:[1,1]
    v_pk_mov_b32 v[124:125], v[8:9], v[8:9] op_sel:[1,1]
    v_pk_mov_b32 v[126:127], v[8:9], v[8:9] op_sel:[1,1]
    v_pk_mov_b32 v[128:129], v[8:9], v[8:9] op_sel:[1,1]
    v_pk_mov_b32 v[130:131], v[8:9], v[8:9] op_sel:[1,1]
    v_pk_mov_b32 v[132:133], v[8:9], v[8:9] op_sel:[1,1]
    v_pk_mov_b32 v[134:135], v[8:9], v[8:9] op_sel:[1,1]
    v_pk_mov_b32 v[136:137], v[8:9], v[8:9] op_sel:[1,1]
    v_pk_mov_b32 v[138:139], v[8:9], v[8:9] op_sel:[1,1]
P2_fmend:
    s_waitcnt vmcnt(7)
    s_cmp_eq_u32 s29, 0
    s_cbranch_scc1 P2_wk
    s_waitcnt vmcnt(5)
P2_wk:
    s_barrier
    ds_read_b128 v[176:179], v174 offset:0
    ds_read_b128 v[208:211], v174 offset:8192
    ds_read_b128 v[180:183], v174 offset:1024
    ds_read_b128 v[184:187], v174 offset:2048
    ds_read_b128 v[188:191], v174 offset:3072
    ds_read_b128 v[192:195], v174 offset:4096
    ds_read_b128 v[196:199], v174 offset:5120
    ds_read_b128 v[200:203], v174 offset:6144
    ds_read_b128 v[204:207], v174 offset:7168
    s_cmp_gt_u32 s28, 0
    s_waitcnt lgkmcnt(8)
    s_cbranch_scc1 P2_nm0
    v_mfma_f32_32x32x16_bf16 v[12:27], v[176:179], v[248:251], 0
P2_nm0:
    s_waitcnt lgkmcnt(7)
    v_mfma_f32_32x32x16_bf16 v[140:155], v[208:211], v[248:251], 0
    s_cmp_gt_u32 s28, 1
    s_waitcnt lgkmcnt(6)
    s_cbranch_scc1 P2_nm1
    v_mfma_f32_32x32x16_bf16 v[28:43], v[180:183], v[248:251], 0
P2_nm1:
    v_pk_mov_b32 v[176:177], s[16:17], s[16:17]
    v_pk_mov_b32 v[178:179], s[16:17], s[16:17]
    s_cmp_gt_u32 s28, 2
    s_waitcnt lgkmcnt(5)
    s_cbranch_scc1 P2_nm2
    v_mfma_f32_32x32x16_bf16 v[44:59], v[184:187], v[248:251], 0
P2_nm2:
    s_nop 3
    v_cndmask_b32_e64 v12, v140, v12, s[32:33]
    v_cndmask_b32_e64 v13, v141, v13, s[34:35]
    v_cndmask_b32_e64 v14, v142, v14, s[36:37]
    v_cndmask_b32_e64 v15, v143, v15, s[38:39]
    v_cndmask_b32_e64 v16, v144, v16, s[40:41]
    v_cndmask_b32_e64 v17, v145, v17, s[42:43]
    v_cndmask_b32_e64 v18, v146, v18, s[44:45]
    v_cndmask_b32_e64 v19, v147, v19, s[46:47]
    v_cndmask_b32_e64 v20, v148, v20, s[48:49]
    v_cndmask_b32_e64 v21, v149, v21, s[50:51]
    v_cndmask_b32_e64 v22, v150, v22, s[52:53]
    v_cndmask_b32_e64 v23, v151, v23, s[54:55]
    v_cndmask_b32_e64 v24, v152, v24, s[56:57]
    v_cndmask_b32_e64 v25, v153, v25, s[58:59]
    v_cndmask_b32_e64 v26, v154, v26, s[60:61]
    v_cndmask_b32_e64 v27, v155, v27, s[62:63]
    v_max3_f32 v156, v12, v13, v14
    v_max3_f32 v157, v16, v17, v18
    v_max3_f32 v158, v20, v21, v22
    v_max3_f32 v159, v24, v25, v26
    v_max_f32 v156, v156, v15
    v_max_f32 v157, v157, v19
    v_max_f32 v158, v158, v23
    v_max_f32 v159, v159, v27
    s_bitcmp1_b32 s3, 0
    s_cselect_b32 s40, 40, 32
    s_load_dwordx2 s[36:37], s[0:1], s40
    v_pk_mov_b32 v[208:209], s[16:17], s[16:17]
    v_pk_mov_b32 v[210:211], s[16:17], s[16:17]
    s_cmp_gt_u32 s28, 3
    s_waitcnt lgkmcnt(4)
    s_cbranch_scc1 P2_nm3
    v_mfma_f32_32x32x16_bf16 v[60:75], v[188:191], v[248:251], 0
P2_nm3:
    v_max3_f32 v156, v156, v28, v29
    v_max3_f32 v157, v157, v32, v33
    v_max3_f32 v158, v158, v36, v37
    v_max3_f32 v159, v159, v40, v41
    v_max3_f32 v156, v156, v30, v31
    v_max3_f32 v157, v157, v34, v35
    v_max3_f32 v158, v158, v38, v39
    v_max3_f32 v159, v159, v42, v43
    v_pk_mov_b32 v[180:181], s[16:17], s[16:17]
    v_pk_mov_b32 v[182:183], s[16:17], s[16:17]
    s_cmp_gt_u32 s28, 4
    s_waitcnt lgkmcnt(3)
    s_cbranch_scc1 P2_nm4
    v_mfma_f32_32x32x16_bf16 v[76:91], v[192:195], v[248:251], 0
P2_nm4:
    v_max3_f32 v156, v156, v44, v45
    v_max3_f32 v157, v157, v48, v49
    v_max3_f32 v158, v158, v52, v53
    v_max3_f32 v159, v159, v56, v57
    v_max3_f32 v156, v156, v46, v47
    v_max3_f32 v157, v157, v50, v51
    v_max3_f32 v158, v158, v54, v55
    v_max3_f32 v159, v159, v58, v59
    v_pk_mov_b32 v[184:185], s[16:17], s[16:17]
    v_pk_mov_b32 v[186:187], s[16:17], s[16:17]
    s_cmp_gt_u32 s28, 5
    s_waitcnt lgkmcnt(2)
    s_cbranch_scc1 P2_nm5
    v_mfma_f32_32x32x16_bf16 v[92:107], v[196:199], v[248:251], 0
P2_nm5:
    v_max3_f32 v156, v156, v60, v61
    v_max3_f32 v157, v157, v64, v65
    v_max3_f32 v158, v158, v68, v69
    v_max3_f32 v159, v159, v72, v73
    v_max3_f32 v156, v156, v62, v63
    v_max3_f32 v157, v157, v66, v67
    v_max3_f32 v158, v158, v70, v71
    v_max3_f32 v159, v159, v74, v75
    v_pk_mov_b32 v[188:189], s[16:17], s[16:17]
    v_pk_mov_b32 v[190:191], s[16:17], s[16:17]
    s_cmp_gt_u32 s28, 6
    s_waitcnt lgkmcnt(1)
    s_cbranch_scc1 P2_nm6
    v_mfma_f32_32x32x16_bf16 v[108:123], v[200:203], v[248:251], 0
P2_nm6:
    v_max3_f32 v156, v156, v76, v77
    v_max3_f32 v157, v157, v80, v81
    v_max3_f32 v158, v158, v84, v85
    v_max3_f32 v159, v159, v88, v89
    v_max3_f32 v156, v156, v78, v79
    v_max3_f32 v157, v157, v82, v83
    v_max3_f32 v158, v158, v86, v87
    v_max3_f32 v159, v159, v90, v91
    v_pk_mov_b32 v[192:193], s[16:17], s[16:17]
    v_pk_mov_b32 v[194:195], s[16:17], s[16:17]
    s_cmp_gt_u32 s28, 7
    s_waitcnt lgkmcnt(0)
    s_cbranch_scc1 P2_nm7
    v_mfma_f32_32x32x16_bf16 v[124:139], v[204:207], v[248:251], 0
P2_nm7:
    v_max3_f32 v156, v156, v92, v93
    v_max3_f32 v157, v157, v96, v97
    v_max3_f32 v158, v158, v100, v101
    v_max3_f32 v159, v159, v104, v105
    v_max3_f32 v156, v156, v94, v95
    v_max3_f32 v157, v157, v98, v99
    v_max3_f32 v158, v158, v102, v103
    v_max3_f32 v159, v159, v106, v107
    v_pk_mov_b32 v[196:197], s[16:17], s[16:17]
    v_pk_mov_b32 v[198:199], s[16:17], s[16:17]
    v_max3_f32 v156, v156, v108, v109
    v_max3_f32 v157, v157, v112, v113
    v_max3_f32 v158, v158, v116, v117
    v_max3_f32 v159, v159, v120, v121
    v_max3_f32 v156, v156, v110, v111
    v_max3_f32 v157, v157, v114, v115
    v_max3_f32 v158, v158, v118, v119
    v_max3_f32 v159, v159, v122, v123
    v_pk_mov_b32 v[200:201], s[16:17], s[16:17]
    v_pk_mov_b32 v[202:203], s[16:17], s[16:17]
    v_max3_f32 v156, v156, v124, v125
    v_max3_f32 v157, v157, v128, v129
    v_max3_f32 v158, v158, v132, v133
    v_max3_f32 v159, v159, v136, v137
    v_max3_f32 v156, v156, v126, v127
    v_max3_f32 v157, v157, v130, v131
    v_max3_f32 v158, v158, v134, v135
    v_max3_f32 v159, v159, v138, v139
    v_pk_mov_b32 v[204:205], s[16:17], s[16:17]
    v_pk_mov_b32 v[206:207], s[16:17], s[16:17]
    s_mov_b32 s34, 0x3eb8aa3b
    s_mov_b32 s35, s34
    v_max3_f32 v10, v156, v157, v158
    v_max_f32 v10, v10, v159
    v_mov_b32 v11, v10
    s_nop 1
    v_permlane32_swap_b32 v10, v11
    v_max_f32 v10, v10, v11
    v_mul_f32 v10, s34, v10
    v_mov_b32 v11, v10
    s_cmp_lt_u32 s3, 4
    s_cbranch_scc1 P2_pr0
    s_setprio 1
P2_pr0:
    s_waitcnt vmcnt(0)
    s_barrier
    s_waitcnt lgkmcnt(0)
    v_pk_fma_f32 v[12:13], v[12:13], s[34:35], v[10:11] neg_lo:[0,0,1] neg_hi:[0,0,1]
    v_pk_fma_f32 v[14:15], v[14:15], s[34:35], v[10:11] neg_lo:[0,0,1] neg_hi:[0,0,1]
    v_pk_fma_f32 v[16:17], v[16:17], s[34:35], v[10:11] neg_lo:[0,0,1] neg_hi:[0,0,1]
    v_pk_fma_f32 v[18:19], v[18:19], s[34:35], v[10:11] neg_lo:[0,0,1] neg_hi:[0,0,1]
    v_pk_fma_f32 v[20:21], v[20:21], s[34:35], v[10:11] neg_lo:[0,0,1] neg_hi:[0,0,1]
    v_pk_fma_f32 v[22:23], v[22:23], s[34:35], v[10:11] neg_lo:[0,0,1] neg_hi:[0,0,1]
    v_pk_fma_f32 v[24:25], v[24:25], s[34:35], v[10:11] neg_lo:[0,0,1] neg_hi:[0,0,1]
    v_pk_fma_f32 v[26:27], v[26:27], s[34:35], v[10:11] neg_lo:[0,0,1] neg_hi:[0,0,1]
    s_mov_b32 s38, 0x1c0000
    s_mov_b32 s39, 0x00020000
    s_lshr_b32 s40, s2, 3
    s_lshl_b32 s40, s40, 2
    s_lshr_b32 s41, s3, 1
    s_add_u32 s40, s40, s41
    s_mul_i32 s40, s40, 2048
    v_lshlrev_b32 v4, 7, v1
    s_add_u32 s41, s40, 344064
    s_mov_b64 exec, 0xffff
    buffer_load_dword v7, v4, s[36:39], s41 offen
    s_mov_b64 exec, -1
    s_mov_b64 exec, s[20:21]
    ds_read_b128 v[212:215], v175 offset:0
    ds_read_b128 v[216:219], v175 offset:512
    ds_read_b128 v[220:223], v175 offset:8192
    s_mov_b64 exec, -1
    v_exp_f32 v12, v12
    v_exp_f32 v13, v13
    v_exp_f32 v14, v14
    v_exp_f32 v15, v15
    s_mov_b64 exec, s[20:21]
    ds_read_b128 v[224:227], v175 offset:8704
    ds_read_b128 v[228:231], v175 offset:1024
    ds_read_b128 v[232:235], v175 offset:1536
    s_mov_b64 exec, -1
    v_exp_f32 v16, v16
    v_exp_f32 v17, v17
    v_exp_f32 v18, v18
    v_exp_f32 v19, v19
    s_mov_b64 exec, s[20:21]
    ds_read_b128 v[236:239], v175 offset:2048
    ds_read_b128 v[240:243], v175 offset:2560
    ds_read_b128 v[244:247], v175 offset:3072
    s_mov_b64 exec, -1
    s_add_u32 s30, s23, 0
    s_add_u32 m0, s24, 0
    s_nop 0
    buffer_load_dwordx4 v254, s[12:15], s30 offen lds
    v_exp_f32 v20, v20
    v_exp_f32 v21, v21
    v_exp_f32 v22, v22
    v_exp_f32 v23, v23
    s_mov_b64 exec, s[20:21]
    ds_read_b128 v[176:179], v175 offset:3584
    ds_read_b128 v[208:211], v175 offset:4096
    ds_read_b128 v[180:183], v175 offset:4608
    s_mov_b64 exec, -1
    v_exp_f32 v24, v24
    v_exp_f32 v25, v25
    v_exp_f32 v26, v26
    v_exp_f32 v27, v27
    v_cvt_pk_bf16_f32 v12, v12, v13
    v_cvt_pk_bf16_f32 v13, v14, v15
    v_cvt_pk_bf16_f32 v14, v16, v17
    v_cvt_pk_bf16_f32 v15, v18, v19
    v_cvt_pk_bf16_f32 v20, v20, v21
    v_cvt_pk_bf16_f32 v21, v22, v23
    v_cvt_pk_bf16_f32 v22, v24, v25
    v_cvt_pk_bf16_f32 v23, v26, v27
    v_bfi_b32 v140, v160, 0, v12
    v_and_b32 v12, v160, v12
    v_bfi_b32 v141, v161, 0, v13
    v_and_b32 v13, v161, v13
    v_bfi_b32 v142, v162, 0, v14
    v_and_b32 v14, v162, v14
    v_bfi_b32 v143, v163, 0, v15
    v_and_b32 v15, v163, v15
    v_bfi_b32 v148, v164, 0, v20
    v_and_b32 v20, v164, v20
    v_bfi_b32 v149, v165, 0, v21
    v_and_b32 v21, v165, v21
    v_bfi_b32 v150, v166, 0, v22
    v_and_b32 v22, v166, v22
    v_bfi_b32 v151, v167, 0, v23
    v_and_b32 v23, v167, v23
    v_pk_fma_f32 v[28:29], v[28:29], s[34:35], v[10:11] neg_lo:[0,0,1] neg_hi:[0,0,1]
    v_pk_fma_f32 v[30:31], v[30:31], s[34:35], v[10:11] neg_lo:[0,0,1] neg_hi:[0,0,1]
    v_pk_fma_f32 v[32:33], v[32:33], s[34:35], v[10:11] neg_lo:[0,0,1] neg_hi:[0,0,1]
    v_pk_fma_f32 v[34:35], v[34:35], s[34:35], v[10:11] neg_lo:[0,0,1] neg_hi:[0,0,1]
    v_pk_fma_f32 v[36:37], v[36:37], s[34:35], v[10:11] neg_lo:[0,0,1] neg_hi:[0,0,1]
    v_pk_fma_f32 v[38:39], v[38:39], s[34:35], v[10:11] neg_lo:[0,0,1] neg_hi:[0,0,1]
    v_pk_fma_f32 v[40:41], v[40:41], s[34:35], v[10:11] neg_lo:[0,0,1] neg_hi:[0,0,1]
    v_pk_fma_f32 v[42:43], v[42:43], s[34:35], v[10:11] neg_lo:[0,0,1] neg_hi:[0,0,1]
    s_waitcnt lgkmcnt(11)
    v_mfma_f32_32x32x16_bf16 v[156:171], v[212:215], v[12:15], 0
    s_mov_b64 exec, s[20:21]
    ds_read_b128 v[184:187], v175 offset:5120
    ds_read_b128 v[188:191], v175 offset:5632
    ds_read_b128 v[192:195], v175 offset:6144
    s_mov_b64 exec, -1
    s_add_u32 s30, s23, 8192
    s_add_u32 m0, s24, 1024
    s_nop 0
    buffer_load_dwordx4 v254, s[12:15], s30 offen lds
    v_exp_f32 v28, v28
    v_exp_f32 v29, v29
    v_exp_f32 v30, v30
    v_exp_f32 v31, v31
    s_waitcnt lgkmcnt(13)
    v_mfma_f32_32x32x16_bf16 v[156:171], v[216:219], v[20:23], v[156:171]
    s_mov_b64 exec, s[20:21]
    ds_read_b128 v[196:199], v175 offset:6656
    ds_read_b128 v[200:203], v175 offset:7168
    ds_read_b128 v[204:207], v175 offset:7680
    s_mov_b64 exec, -1
    v_exp_f32 v32, v32
    v_exp_f32 v33, v33
    v_exp_f32 v34, v34
    v_exp_f32 v35, v35
    s_waitcnt lgkmcnt(15)
    v_mfma_f32_32x32x16_bf16 v[156:171], v[220:223], v[140:143], v[156:171]
    s_add_u32 s30, s23, 16384
    s_add_u32 m0, s24, 2048
    s_nop 0
    buffer_load_dwordx4 v254, s[12:15], s30 offen lds
    v_exp_f32 v36, v36
    v_exp_f32 v37, v37
    v_exp_f32 v38, v38
    v_exp_f32 v39, v39
    s_waitcnt lgkmcnt(14)
    v_mfma_f32_32x32x16_bf16 v[156:171], v[224:227], v[148:151], v[156:171]
    v_exp_f32 v40, v40
    v_exp_f32 v41, v41
    v_exp_f32 v42, v42
    v_exp_f32 v43, v43
    v_cvt_pk_bf16_f32 v28, v28, v29
    v_cvt_pk_bf16_f32 v29, v30, v31
    v_cvt_pk_bf16_f32 v30, v32, v33
    v_cvt_pk_bf16_f32 v31, v34, v35
    v_cvt_pk_bf16_f32 v36, v36, v37
    v_cvt_pk_bf16_f32 v37, v38, v39
    v_cvt_pk_bf16_f32 v38, v40, v41
    v_cvt_pk_bf16_f32 v39, v42, v43
    v_pk_fma_f32 v[44:45], v[44:45], s[34:35], v[10:11] neg_lo:[0,0,1] neg_hi:[0,0,1]
    v_pk_fma_f32 v[46:47], v[46:47], s[34:35], v[10:11] neg_lo:[0,0,1] neg_hi:[0,0,1]
    v_pk_fma_f32 v[48:49], v[48:49], s[34:35], v[10:11] neg_lo:[0,0,1] neg_hi:[0,0,1]
    v_pk_fma_f32 v[50:51], v[50:51], s[34:35], v[10:11] neg_lo:[0,0,1] neg_hi:[0,0,1]
    v_pk_fma_f32 v[52:53], v[52:53], s[34:35], v[10:11] neg_lo:[0,0,1] neg_hi:[0,0,1]
    v_pk_fma_f32 v[54:55], v[54:55], s[34:35], v[10:11] neg_lo:[0,0,1] neg_hi:[0,0,1]
    v_pk_fma_f32 v[56:57], v[56:57], s[34:35], v[10:11] neg_lo:[0,0,1] neg_hi:[0,0,1]
    v_pk_fma_f32 v[58:59], v[58:59], s[34:35], v[10:11] neg_lo:[0,0,1] neg_hi:[0,0,1]
    s_waitcnt lgkmcnt(13)
    v_mfma_f32_32x32x16_bf16 v[156:171], v[228:231], v[28:31], v[156:171]
    s_add_u32 s30, s23, 24576
    s_add_u32 m0, s24, 3072
    s_nop 0
    buffer_load_dwordx4 v254, s[12:15], s30 offen lds
    v_exp_f32 v44, v44
    v_exp_f32 v45, v45
    v_exp_f32 v46, v46
    v_exp_f32 v47, v47
    s_waitcnt lgkmcnt(12)
    v_mfma_f32_32x32x16_bf16 v[156:171], v[232:235], v[36:39], v[156:171]
    v_exp_f32 v48, v48
    v_exp_f32 v49, v49
    v_exp_f32 v50, v50
    v_exp_f32 v51, v51
    s_add_u32 s30, s23, 32768
    s_add_u32 m0, s24, 4096
    s_nop 0
    buffer_load_dwordx4 v254, s[12:15], s30 offen lds
    v_exp_f32 v52, v52
    v_exp_f32 v53, v53
    v_exp_f32 v54, v54
    v_exp_f32 v55, v55
    v_exp_f32 v56, v56
    v_exp_f32 v57, v57
    v_exp_f32 v58, v58
    v_exp_f32 v59, v59
    v_cvt_pk_bf16_f32 v44, v44, v45
    v_cvt_pk_bf16_f32 v45, v46, v47
    v_cvt_pk_bf16_f32 v46, v48, v49
    v_cvt_pk_bf16_f32 v47, v50, v51
    v_cvt_pk_bf16_f32 v52, v52, v53
    v_cvt_pk_bf16_f32 v53, v54, v55
    v_cvt_pk_bf16_f32 v54, v56, v57
    v_cvt_pk_bf16_f32 v55, v58, v59
    v_pk_fma_f32 v[60:61], v[60:61], s[34:35], v[10:11] neg_lo:[0,0,1] neg_hi:[0,0,1]
    v_pk_fma_f32 v[62:63], v[62:63], s[34:35], v[10:11] neg_lo:[0,0,1] neg_hi:[0,0,1]
    v_pk_fma_f32 v[64:65], v[64:65], s[34:35], v[10:11] neg_lo:[0,0,1] neg_hi:[0,0,1]
    v_pk_fma_f32 v[66:67], v[66:67], s[34:35], v[10:11] neg_lo:[0,0,1] neg_hi:[0,0,1]
    v_pk_fma_f32 v[68:69], v[68:69], s[34:35], v[10:11] neg_lo:[0,0,1] neg_hi:[0,0,1]
    v_pk_fma_f32 v[70:71], v[70:71], s[34:35], v[10:11] neg_lo:[0,0,1] neg_hi:[0,0,1]
    v_pk_fma_f32 v[72:73], v[72:73], s[34:35], v[10:11] neg_lo:[0,0,1] neg_hi:[0,0,1]
    v_pk_fma_f32 v[74:75], v[74:75], s[34:35], v[10:11] neg_lo:[0,0,1] neg_hi:[0,0,1]
    s_waitcnt lgkmcnt(11)
    v_mfma_f32_32x32x16_bf16 v[156:171], v[236:239], v[44:47], v[156:171]
    s_add_u32 s30, s23, 40960
    s_add_u32 m0, s24, 5120
    s_nop 0
    buffer_load_dwordx4 v254, s[12:15], s30 offen lds
    v_exp_f32 v60, v60
    v_exp_f32 v61, v61
    v_exp_f32 v62, v62
    v_exp_f32 v63, v63
    s_waitcnt lgkmcnt(10)
    v_mfma_f32_32x32x16_bf16 v[156:171], v[240:243], v[52:55], v[156:171]
    v_exp_f32 v64, v64
    v_exp_f32 v65, v65
    v_exp_f32 v66, v66
    v_exp_f32 v67, v67
    s_add_u32 s30, s23, 49152
    s_add_u32 m0, s24, 6144
    s_nop 0
    buffer_load_dwordx4 v254, s[12:15], s30 offen lds
    v_exp_f32 v68, v68
    v_exp_f32 v69, v69
    v_exp_f32 v70, v70
    v_exp_f32 v71, v71
    v_exp_f32 v72, v72
    v_exp_f32 v73, v73
    v_exp_f32 v74, v74
    v_exp_f32 v75, v75
    v_cvt_pk_bf16_f32 v60, v60, v61
    v_cvt_pk_bf16_f32 v61, v62, v63
    v_cvt_pk_bf16_f32 v62, v64, v65
    v_cvt_pk_bf16_f32 v63, v66, v67
    v_cvt_pk_bf16_f32 v68, v68, v69
    v_cvt_pk_bf16_f32 v69, v70, v71
    v_cvt_pk_bf16_f32 v70, v72, v73
    v_cvt_pk_bf16_f32 v71, v74, v75
    v_pk_fma_f32 v[76:77], v[76:77], s[34:35], v[10:11] neg_lo:[0,0,1] neg_hi:[0,0,1]
    v_pk_fma_f32 v[78:79], v[78:79], s[34:35], v[10:11] neg_lo:[0,0,1] neg_hi:[0,0,1]
    v_pk_fma_f32 v[80:81], v[80:81], s[34:35], v[10:11] neg_lo:[0,0,1] neg_hi:[0,0,1]
    v_pk_fma_f32 v[82:83], v[82:83], s[34:35], v[10:11] neg_lo:[0,0,1] neg_hi:[0,0,1]
    v_pk_fma_f32 v[84:85], v[84:85], s[34:35], v[10:11] neg_lo:[0,0,1] neg_hi:[0,0,1]
    v_pk_fma_f32 v[86:87], v[86:87], s[34:35], v[10:11] neg_lo:[0,0,1] neg_hi:[0,0,1]
    v_pk_fma_f32 v[88:89], v[88:89], s[34:35], v[10:11] neg_lo:[0,0,1] neg_hi:[0,0,1]
    v_pk_fma_f32 v[90:91], v[90:91], s[34:35], v[10:11] neg_lo:[0,0,1] neg_hi:[0,0,1]
    s_waitcnt lgkmcnt(9)
    v_mfma_f32_32x32x16_bf16 v[156:171], v[244:247], v[60:63], v[156:171]
    s_add_u32 s30, s23, 57344
    s_add_u32 m0, s24, 7168
    s_nop 0
    buffer_load_dwordx4 v254, s[12:15], s30 offen lds
    v_exp_f32 v76, v76
    v_exp_f32 v77, v77
    v_exp_f32 v78, v78
    v_exp_f32 v79, v79
    s_waitcnt lgkmcnt(8)
    v_mfma_f32_32x32x16_bf16 v[156:171], v[176:179], v[68:71], v[156:171]
    v_exp_f32 v80, v80
    v_exp_f32 v81, v81
    v_exp_f32 v82, v82
    v_exp_f32 v83, v83
    s_cmp_lt_u32 s3, 4
    s_cbranch_scc1 P2_npre
    buffer_load_dword v7, v172, s[4:7], s25 offen
P2_npre:
    v_exp_f32 v84, v84
    v_exp_f32 v85, v85
    v_exp_f32 v86, v86
    v_exp_f32 v87, v87
    v_exp_f32 v88, v88
    v_exp_f32 v89, v89
    v_exp_f32 v90, v90
    v_exp_f32 v91, v91
    v_cvt_pk_bf16_f32 v76, v76, v77
    v_cvt_pk_bf16_f32 v77, v78, v79
    v_cvt_pk_bf16_f32 v78, v80, v81
    v_cvt_pk_bf16_f32 v79, v82, v83
    v_cvt_pk_bf16_f32 v84, v84, v85
    v_cvt_pk_bf16_f32 v85, v86, v87
    v_cvt_pk_bf16_f32 v86, v88, v89
    v_cvt_pk_bf16_f32 v87, v90, v91
    v_pk_fma_f32 v[92:93], v[92:93], s[34:35], v[10:11] neg_lo:[0,0,1] neg_hi:[0,0,1]
    v_pk_fma_f32 v[94:95], v[94:95], s[34:35], v[10:11] neg_lo:[0,0,1] neg_hi:[0,0,1]
    v_pk_fma_f32 v[96:97], v[96:97], s[34:35], v[10:11] neg_lo:[0,0,1] neg_hi:[0,0,1]
    v_pk_fma_f32 v[98:99], v[98:99], s[34:35], v[10:11] neg_lo:[0,0,1] neg_hi:[0,0,1]
    v_pk_fma_f32 v[100:101], v[100:101], s[34:35], v[10:11] neg_lo:[0,0,1] neg_hi:[0,0,1]
    v_pk_fma_f32 v[102:103], v[102:103], s[34:35], v[10:11] neg_lo:[0,0,1] neg_hi:[0,0,1]
    v_pk_fma_f32 v[104:105], v[104:105], s[34:35], v[10:11] neg_lo:[0,0,1] neg_hi:[0,0,1]
    v_pk_fma_f32 v[106:107], v[106:107], s[34:35], v[10:11] neg_lo:[0,0,1] neg_hi:[0,0,1]
    s_waitcnt lgkmcnt(7)
    v_mfma_f32_32x32x16_bf16 v[156:171], v[208:211], v[76:79], v[156:171]
    v_exp_f32 v92, v92
    v_exp_f32 v93, v93
    v_exp_f32 v94, v94
    v_exp_f32 v95, v95
    s_waitcnt lgkmcnt(6)
    v_mfma_f32_32x32x16_bf16 v[156:171], v[180:183], v[84:87], v[156:171]
    v_exp_f32 v96, v96
    v_exp_f32 v97, v97
    v_exp_f32 v98, v98
    v_exp_f32 v99, v99
    v_exp_f32 v100, v100
    v_exp_f32 v101, v101
    v_exp_f32 v102, v102
    v_exp_f32 v103, v103
    v_exp_f32 v104, v104
    v_exp_f32 v105, v105
    v_exp_f32 v106, v106
    v_exp_f32 v107, v107
    v_cvt_pk_bf16_f32 v92, v92, v93
    v_cvt_pk_bf16_f32 v93, v94, v95
    v_cvt_pk_bf16_f32 v94, v96, v97
    v_cvt_pk_bf16_f32 v95, v98, v99
    v_cvt_pk_bf16_f32 v100, v100, v101
    v_cvt_pk_bf16_f32 v101, v102, v103
    v_cvt_pk_bf16_f32 v102, v104, v105
    v_cvt_pk_bf16_f32 v103, v106, v107
    s_setprio 0
    s_cmp_lg_u32 s3, 0
    s_cbranch_scc1 P2_nrr
    s_mov_b64 exec, 1
    buffer_load_dword v253, off, s[4:7], s8 sc1
    s_mov_b64 exec, -1
P2_nrr:
    v_pk_fma_f32 v[108:109], v[108:109], s[34:35], v[10:11] neg_lo:[0,0,1] neg_hi:[0,0,1]
    v_pk_fma_f32 v[110:111], v[110:111], s[34:35], v[10:11] neg_lo:[0,0,1] neg_hi:[0,0,1]
    v_pk_fma_f32 v[112:113], v[112:113], s[34:35], v[10:11] neg_lo:[0,0,1] neg_hi:[0,0,1]
    v_pk_fma_f32 v[114:115], v[114:115], s[34:35], v[10:11] neg_lo:[0,0,1] neg_hi:[0,0,1]
    v_pk_fma_f32 v[116:117], v[116:117], s[34:35], v[10:11] neg_lo:[0,0,1] neg_hi:[0,0,1]
    v_pk_fma_f32 v[118:119], v[118:119], s[34:35], v[10:11] neg_lo:[0,0,1] neg_hi:[0,0,1]
    v_pk_fma_f32 v[120:121], v[120:121], s[34:35], v[10:11] neg_lo:[0,0,1] neg_hi:[0,0,1]
    v_pk_fma_f32 v[122:123], v[122:123], s[34:35], v[10:11] neg_lo:[0,0,1] neg_hi:[0,0,1]
    s_waitcnt lgkmcnt(5)
    v_mfma_f32_32x32x16_bf16 v[156:171], v[184:187], v[92:95], v[156:171]
    v_exp_f32 v108, v108
    v_exp_f32 v109, v109
    v_exp_f32 v110, v110
    v_exp_f32 v111, v111
    s_waitcnt lgkmcnt(4)
    v_mfma_f32_32x32x16_bf16 v[156:171], v[188:191], v[100:103], v[156:171]
    v_exp_f32 v112, v112
    v_exp_f32 v113, v113
    v_exp_f32 v114, v114
    v_exp_f32 v115, v115
    v_exp_f32 v116, v116
    v_exp_f32 v117, v117
    v_exp_f32 v118, v118
    v_exp_f32 v119, v119
    v_exp_f32 v120, v120
    v_exp_f32 v121, v121
    v_exp_f32 v122, v122
    v_exp_f32 v123, v123
    v_cvt_pk_bf16_f32 v108, v108, v109
    v_cvt_pk_bf16_f32 v109, v110, v111
    v_cvt_pk_bf16_f32 v110, v112, v113
    v_cvt_pk_bf16_f32 v111, v114, v115
    v_cvt_pk_bf16_f32 v116, v116, v117
    v_cvt_pk_bf16_f32 v117, v118, v119
    v_cvt_pk_bf16_f32 v118, v120, v121
    v_cvt_pk_bf16_f32 v119, v122, v123
    v_pk_fma_f32 v[124:125], v[124:125], s[34:35], v[10:11] neg_lo:[0,0,1] neg_hi:[0,0,1]
    v_pk_fma_f32 v[126:127], v[126:127], s[34:35], v[10:11] neg_lo:[0,0,1] neg_hi:[0,0,1]
    v_pk_fma_f32 v[128:129], v[128:129], s[34:35], v[10:11] neg_lo:[0,0,1] neg_hi:[0,0,1]
    v_pk_fma_f32 v[130:131], v[130:131], s[34:35], v[10:11] neg_lo:[0,0,1] neg_hi:[0,0,1]
    v_pk_fma_f32 v[132:133], v[132:133], s[34:35], v[10:11] neg_lo:[0,0,1] neg_hi:[0,0,1]
    v_pk_fma_f32 v[134:135], v[134:135], s[34:35], v[10:11] neg_lo:[0,0,1] neg_hi:[0,0,1]
    v_pk_fma_f32 v[136:137], v[136:137], s[34:35], v[10:11] neg_lo:[0,0,1] neg_hi:[0,0,1]
    v_pk_fma_f32 v[138:139], v[138:139], s[34:35], v[10:11] neg_lo:[0,0,1] neg_hi:[0,0,1]
    s_waitcnt lgkmcnt(3)
    v_mfma_f32_32x32x16_bf16 v[156:171], v[192:195], v[108:111], v[156:171]
    v_exp_f32 v124, v124
    v_exp_f32 v125, v125
    v_exp_f32 v126, v126
    v_exp_f32 v127, v127
    s_waitcnt lgkmcnt(2)
    v_mfma_f32_32x32x16_bf16 v[156:171], v[196:199], v[116:119], v[156:171]
    v_exp_f32 v128, v128
    v_exp_f32 v129, v129
    v_exp_f32 v130, v130
    v_exp_f32 v131, v131
    v_exp_f32 v132, v132
    v_exp_f32 v133, v133
    v_exp_f32 v134, v134
    v_exp_f32 v135, v135
    v_exp_f32 v136, v136
    v_exp_f32 v137, v137
    v_exp_f32 v138, v138
    v_exp_f32 v139, v139
    v_cvt_pk_bf16_f32 v124, v124, v125
    v_cvt_pk_bf16_f32 v125, v126, v127
    v_cvt_pk_bf16_f32 v126, v128, v129
    v_cvt_pk_bf16_f32 v127, v130, v131
    v_cvt_pk_bf16_f32 v132, v132, v133
    v_cvt_pk_bf16_f32 v133, v134, v135
    v_cvt_pk_bf16_f32 v134, v136, v137
    v_cvt_pk_bf16_f32 v135, v138, v139
    s_waitcnt lgkmcnt(1)
    v_mfma_f32_32x32x16_bf16 v[156:171], v[200:203], v[124:127], v[156:171]
    s_waitcnt lgkmcnt(0)
    v_mfma_f32_32x32x16_bf16 v[156:171], v[204:207], v[132:135], v[156:171]
    s_nop 7
    s_nop 3
    v_rcp_f32 v10, v164
    s_nop 0
    v_mul_f32 v156, v156, v10
    v_mul_f32 v157, v157, v10
    v_mul_f32 v158, v158, v10
    v_mul_f32 v159, v159, v10
    v_mul_f32 v160, v160, v10
    v_mul_f32 v161, v161, v10
    v_mul_f32 v162, v162, v10
    v_mul_f32 v163, v163, v10
    v_cvt_pk_bf16_f32 v156, v156, v157
    v_cvt_pk_bf16_f32 v157, v158, v159
    v_cvt_pk_bf16_f32 v158, v160, v161
    v_cvt_pk_bf16_f32 v159, v162, v163
    s_nop 0
    v_permlane32_swap_b32 v156, v158
    v_permlane32_swap_b32 v157, v159
    buffer_store_dwordx4 v[156:159], v8, s[4:7], 0 offen sc1
    v_mov_b32 v10, 1
    s_waitcnt vmcnt(0)
    s_mov_b64 exec, 1
    buffer_store_byte v10, off, s[4:7], s22
    s_mov_b64 exec, -1
    s_cmp_lg_u32 s100, 0
    s_cbranch_scc1 J_SLOW_claim
    s_cmp_lg_u32 s3, 0
    s_cbranch_scc1 P2_dec
    v_readfirstlane_b32 s10, v252
    v_readfirstlane_b32 s11, v253
    s_lshr_b32 s30, s2, 3
    s_lshr_b32 s10, s10, s30
    s_and_b32 s10, s10, 1
    s_cmp_lg_u32 s11, -1
    s_cselect_b32 s11, 2, 0
    s_or_b32 s10, s10, s11
    v_mov_b32 v4, s10
    v_mov_b32 v5, 0x26400
    ds_write_b32 v5, v4
    s_waitcnt lgkmcnt(0)
P2_dec:
    v_mov_b32 v5, 0x26400
    s_barrier
    ds_read_b32 v4, v5
    s_waitcnt lgkmcnt(0)
    v_readfirstlane_b32 s10, v4
    s_cmp_lg_u32 s10, 0
    s_cbranch_scc1 J_SLOW_start
    s_cmp_ge_u32 s3, 4
    s_cbranch_scc1 J_LD3
J_P3:
    s_nop 7
    s_nop 7
    s_load_dwordx2 s[10:11], s[0:1], 0
    s_and_b32 s20, s2, 7
    s_lshl_b32 s20, s20, 2
    s_bfe_u32 s22, s2, 0x20003
    s_add_u32 s20, s20, s22
    s_lshr_b32 s21, s2, 5
    v_and_b32 v1, 63, v0
    v_and_b32 v2, 15, v1
    v_lshrrev_b32 v3, 4, v1
    s_lshl_b32 s29, s22, 6
    s_lshl_b32 s23, s3, 4
    s_add_u32 s29, s29, s23
    s_add_u32 s29, s29, s8
    s_add_u32 s29, s29, 128
    s_lshl_b32 s40, s22, 2
    s_add_u32 s40, s40, s3
    s_lshl_b32 s40, s40, 3
    s_add_u32 s40, s40, s21
    s_add_u32 s40, s40, s8
    s_add_u32 s40, s40, 384
    s_mul_i32 s23, s20, 65536
    s_mul_i32 s24, s3, 8192
    s_add_u32 s23, s23, s24
    s_add_u32 s23, s23, 0x600000
    v_lshlrev_b32 v4, 4, v1
    v_add_u32 v8, s23, v4
    v_add_u32 v9, 32768, v8
    s_lshl_b32 s24, s21, 7
    s_lshl_b32 s26, s3, 14
    v_lshrrev_b32 v4, 1, v3
    v_lshlrev_b32 v4, 10, v4
    v_lshrrev_b32 v5, 2, v2
    v_lshl_add_u32 v4, v5, 6, v4
    v_and_b32 v5, 1, v3
    v_lshl_add_u32 v4, v5, 5, v4
    v_and_b32 v5, 3, v2
    v_lshl_add_u32 v4, v5, 3, v4
    v_add_u32 v11, s26, v4
    v_and_b32 v4, 31, v1
    v_lshlrev_b32 v5, 8, v4
    v_add_u32 v5, s26, v5
    v_and_b32 v4, 7, v4
    v_lshrrev_b32 v6, 5, v1
    v_xor_b32 v4, v4, v6
    v_xor_b32 v6, 0, v4
    v_lshl_add_u32 v14, v6, 4, v5
    v_xor_b32 v6, 2, v4
    v_lshl_add_u32 v15, v6, 4, v5
    v_xor_b32 v6, 4, v4
    v_lshl_add_u32 v16, v6, 4, v5
    v_xor_b32 v6, 6, v4
    v_lshl_add_u32 v17, v6, 4, v5
    s_lshl_b32 s27, s3, 12
    v_lshrrev_b32 v4, 3, v1
    v_lshlrev_b32 v5, 8, v4
    v_add_u32 v5, s27, v5
    v_and_b32 v6, 7, v1
    v_lshlrev_b32 v6, 1, v6
    v_xor_b32 v6, v6, v4
    v_lshl_add_u32 v18, v6, 4, v5
    v_xor_b32 v6, 1, v6
    v_lshl_add_u32 v19, v6, 4, v5
    s_lshl_b32 s27, s3, 4
    s_lshl_b32 s28, s20, 6
    s_add_u32 s27, s27, s28
    s_lshl_b32 s27, s27, 10
    s_add_u32 s27, s27, s24
    v_lshlrev_b32 v5, 10, v4
    v_and_b32 v6, 7, v1
    v_lshl_add_u32 v5, v6, 4, v5
    v_add_u32 v4, s27, v5
    v_add_u32 v12, 0x800000, v4
    v_add_u32 v13, 0x0, v4
    s_mov_b32 s41, 8192
    s_lshl_b32 s27, s3, 11
    v_lshrrev_b32 v4, 3, v1
    v_and_b32 v5, 3, v1
    v_lshl_add_u32 v4, v5, 4, v4
    v_lshlrev_b32 v4, 4, v4
    v_bfe_u32 v5, v1, 2, 1
    v_lshl_add_u32 v4, v5, 10, v4
    v_add_u32 v4, s27, v4
    v_add_u32 v22, 65536, v4
    v_lshlrev_b32 v4, 4, v1
    v_add_u32 v5, s27, v4
    v_add_u32 v23, 65536, v5
    s_lshl_b32 s27, s20, 2
    s_add_u32 s27, s27, s3
    s_lshl_b32 s27, s27, 4
    s_lshl_b32 s28, s21, 1
    s_add_u32 s27, s27, s28
    s_lshl_b32 s27, s27, 10
    s_add_u32 s27, s27, 0x1200000
    v_add_u32 v24, s27, v4
    s_lshl_b32 s27, s20, 2
    s_add_u32 s27, s27, s3
    s_lshl_b32 s27, s27, 10
    s_lshl_b32 s28, s21, 3
    s_add_u32 s27, s27, s28
    v_lshrrev_b32 v4, 3, v1
    v_lshlrev_b32 v4, 6, v4
    s_add_u32 s27, s27, 0x1410000
    v_add_u32 v25, s27, v4
    s_mov_b32 s44, 0x3f803f80
    s_mov_b32 s42, 0x01010101
    s_mov_b32 s43, 0x01010101
    s_waitcnt lgkmcnt(0)
    s_mov_b32 s16, s10
    s_mov_b32 s17, s11
    s_mov_b32 s18, 0x200000
    s_mov_b32 s19, 0x00020000
    s_mov_b32 s30, 0
    s_mov_b64 exec, 1
P3_poll:
    buffer_load_dwordx4 v[4:7], off, s[4:7], s29 sc1
    s_add_u32 s30, s30, 1
    s_waitcnt vmcnt(0)
    v_and_b32 v4, v4, v5
    v_and_b32 v6, v6, v7
    v_and_b32 v4, v4, v6
    s_nop 0
    v_readfirstlane_b32 s31, v4
    s_cmp_eq_u32 s31, 0x01010101
    s_cbranch_scc1 P3_poll_x
    s_cmp_lt_u32 s30, 0x20000
    s_cbranch_scc1 P3_poll
P3_poll_x:
    s_mov_b64 exec, -1
    s_mov_b32 s30, 0
    buffer_load_dwordx4 v[28:31], v8, s[4:7], s30 offen
    buffer_load_dwordx4 v[32:35], v9, s[4:7], s30 offen
    s_mov_b32 s30, 1024
    buffer_load_dwordx4 v[36:39], v8, s[4:7], s30 offen
    buffer_load_dwordx4 v[40:43], v9, s[4:7], s30 offen
    s_mov_b32 s30, 2048
    buffer_load_dwordx4 v[44:47], v8, s[4:7], s30 offen
    buffer_load_dwordx4 v[48:51], v9, s[4:7], s30 offen
    s_mov_b32 s30, 3072
    buffer_load_dwordx4 v[52:55], v8, s[4:7], s30 offen
    buffer_load_dwordx4 v[56:59], v9, s[4:7], s30 offen
    s_mov_b32 s30, 4096
    buffer_load_dwordx4 v[60:63], v8, s[4:7], s30 offen
    buffer_load_dwordx4 v[64:67], v9, s[4:7], s30 offen
    s_mov_b32 s30, 5120
    buffer_load_dwordx4 v[68:71], v8, s[4:7], s30 offen
    buffer_load_dwordx4 v[72:75], v9, s[4:7], s30 offen
    s_mov_b32 s30, 6144
    buffer_load_dwordx4 v[76:79], v8, s[4:7], s30 offen
    buffer_load_dwordx4 v[80:83], v9, s[4:7], s30 offen
    s_mov_b32 s30, 7168
    buffer_load_dwordx4 v[84:87], v8, s[4:7], s30 offen
    buffer_load_dwordx4 v[88:91], v9, s[4:7], s30 offen
    buffer_load_dwordx4 v[172:175], v13, s[16:19], 0 offen
    buffer_load_dwordx4 v[176:179], v13, s[16:19], s41 offen
    ds_read_b64_tr_b16 v[92:93], v11 offset:0
    ds_read_b64_tr_b16 v[94:95], v11 offset:512
    ds_read_b64_tr_b16 v[96:97], v11 offset:256
    ds_read_b64_tr_b16 v[98:99], v11 offset:768
    ds_read_b64_tr_b16 v[100:101], v11 offset:2048
    ds_read_b64_tr_b16 v[102:103], v11 offset:2560
    ds_read_b64_tr_b16 v[104:105], v11 offset:2304
    ds_read_b64_tr_b16 v[106:107], v11 offset:2816
    s_waitcnt lgkmcnt(4)
    s_waitcnt vmcnt(16)
    v_mfma_f32_32x32x16_bf16 v[108:123], v[92:95], v[28:31], 0
    v_mfma_f32_32x32x16_bf16 v[124:139], v[96:99], v[28:31], 0
    v_mfma_f32_32x32x16_bf16 v[140:155], v[92:95], v[32:35], 0
    v_mfma_f32_32x32x16_bf16 v[156:171], v[96:99], v[32:35], 0
    ds_read_b64_tr_b16 v[92:93], v11 offset:4096
    ds_read_b64_tr_b16 v[94:95], v11 offset:4608
    ds_read_b64_tr_b16 v[96:97], v11 offset:4352
    ds_read_b64_tr_b16 v[98:99], v11 offset:4864
    s_waitcnt lgkmcnt(4)
    s_waitcnt vmcnt(14)
    v_mfma_f32_32x32x16_bf16 v[108:123], v[100:103], v[36:39], v[108:123]
    v_mfma_f32_32x32x16_bf16 v[124:139], v[104:107], v[36:39], v[124:139]
    v_mfma_f32_32x32x16_bf16 v[140:155], v[100:103], v[40:43], v[140:155]
    v_mfma_f32_32x32x16_bf16 v[156:171], v[104:107], v[40:43], v[156:171]
    ds_read_b64_tr_b16 v[100:101], v11 offset:6144
    ds_read_b64_tr_b16 v[102:103], v11 offset:6656
    ds_read_b64_tr_b16 v[104:105], v11 offset:6400
    ds_read_b64_tr_b16 v[106:107], v11 offset:6912
    s_waitcnt lgkmcnt(4)
    s_waitcnt vmcnt(12)
    v_mfma_f32_32x32x16_bf16 v[108:123], v[92:95], v[44:47], v[108:123]
    v_mfma_f32_32x32x16_bf16 v[124:139], v[96:99], v[44:47], v[124:139]
    v_mfma_f32_32x32x16_bf16 v[140:155], v[92:95], v[48:51], v[140:155]
    v_mfma_f32_32x32x16_bf16 v[156:171], v[96:99], v[48:51], v[156:171]
    ds_read_b64_tr_b16 v[92:93], v11 offset:8192
    ds_read_b64_tr_b16 v[94:95], v11 offset:8704
    ds_read_b64_tr_b16 v[96:97], v11 offset:8448
    ds_read_b64_tr_b16 v[98:99], v11 offset:8960
    s_waitcnt lgkmcnt(4)
    s_waitcnt vmcnt(10)
    v_mfma_f32_32x32x16_bf16 v[108:123], v[100:103], v[52:55], v[108:123]
    v_mfma_f32_32x32x16_bf16 v[124:139], v[104:107], v[52:55], v[124:139]
    v_mfma_f32_32x32x16_bf16 v[140:155], v[100:103], v[56:59], v[140:155]
    v_mfma_f32_32x32x16_bf16 v[156:171], v[104:107], v[56:59], v[156:171]
    ds_read_b64_tr_b16 v[100:101], v11 offset:10240
    ds_read_b64_tr_b16 v[102:103], v11 offset:10752
    ds_read_b64_tr_b16 v[104:105], v11 offset:10496
    ds_read_b64_tr_b16 v[106:107], v11 offset:11008
    s_waitcnt lgkmcnt(4)
    s_waitcnt vmcnt(8)
    v_mfma_f32_32x32x16_bf16 v[108:123], v[92:95], v[60:63], v[108:123]
    v_mfma_f32_32x32x16_bf16 v[124:139], v[96:99], v[60:63], v[124:139]
    v_mfma_f32_32x32x16_bf16 v[140:155], v[92:95], v[64:67], v[140:155]
    v_mfma_f32_32x32x16_bf16 v[156:171], v[96:99], v[64:67], v[156:171]
    ds_read_b64_tr_b16 v[92:93], v11 offset:12288
    ds_read_b64_tr_b16 v[94:95], v11 offset:12800
    ds_read_b64_tr_b16 v[96:97], v11 offset:12544
    ds_read_b64_tr_b16 v[98:99], v11 offset:13056
    s_waitcnt lgkmcnt(4)
    s_waitcnt vmcnt(6)
    v_mfma_f32_32x32x16_bf16 v[108:123], v[100:103], v[68:71], v[108:123]
    v_mfma_f32_32x32x16_bf16 v[124:139], v[104:107], v[68:71], v[124:139]
    v_mfma_f32_32x32x16_bf16 v[140:155], v[100:103], v[72:75], v[140:155]
    v_mfma_f32_32x32x16_bf16 v[156:171], v[104:107], v[72:75], v[156:171]
    ds_read_b64_tr_b16 v[100:101], v11 offset:14336
    ds_read_b64_tr_b16 v[102:103], v11 offset:14848
    ds_read_b64_tr_b16 v[104:105], v11 offset:14592
    ds_read_b64_tr_b16 v[106:107], v11 offset:15104
    s_waitcnt lgkmcnt(4)
    s_waitcnt vmcnt(4)
    v_mfma_f32_32x32x16_bf16 v[108:123], v[92:95], v[76:79], v[108:123]
    v_mfma_f32_32x32x16_bf16 v[124:139], v[96:99], v[76:79], v[124:139]
    v_mfma_f32_32x32x16_bf16 v[140:155], v[92:95], v[80:83], v[140:155]
    v_mfma_f32_32x32x16_bf16 v[156:171], v[96:99], v[80:83], v[156:171]
    s_waitcnt lgkmcnt(0)
    s_waitcnt vmcnt(2)
    v_mfma_f32_32x32x16_bf16 v[108:123], v[100:103], v[84:87], v[108:123]
    v_mfma_f32_32x32x16_bf16 v[124:139], v[104:107], v[84:87], v[124:139]
    v_mfma_f32_32x32x16_bf16 v[140:155], v[100:103], v[88:91], v[140:155]
    v_mfma_f32_32x32x16_bf16 v[156:171], v[104:107], v[88:91], v[156:171]
    s_nop 7
    s_nop 0
    ds_write_b128 v14, v[108:111] offset:0
    ds_write_b128 v15, v[112:115] offset:0
    ds_write_b128 v16, v[116:119] offset:0
    ds_write_b128 v17, v[120:123] offset:0
    ds_write_b128 v14, v[124:127] offset:128
    ds_write_b128 v15, v[128:131] offset:128
    ds_write_b128 v16, v[132:135] offset:128
    ds_write_b128 v17, v[136:139] offset:128
    ds_write_b128 v14, v[140:143] offset:8192
    ds_write_b128 v15, v[144:147] offset:8192
    ds_write_b128 v16, v[148:151] offset:8192
    ds_write_b128 v17, v[152:155] offset:8192
    ds_write_b128 v14, v[156:159] offset:8320
    ds_write_b128 v15, v[160:163] offset:8320
    ds_write_b128 v16, v[164:167] offset:8320
    ds_write_b128 v17, v[168:171] offset:8320
    s_waitcnt lgkmcnt(0)
    s_barrier
    ds_read_b128 v[108:111], v18 offset:0
    ds_read_b128 v[112:115], v19 offset:0
    ds_read_b128 v[116:119], v18 offset:16384
    ds_read_b128 v[120:123], v19 offset:16384
    ds_read_b128 v[124:127], v18 offset:32768
    ds_read_b128 v[128:131], v19 offset:32768
    ds_read_b128 v[132:135], v18 offset:49152
    ds_read_b128 v[136:139], v19 offset:49152
    ds_read_b128 v[140:143], v18 offset:2048
    ds_read_b128 v[144:147], v19 offset:2048
    ds_read_b128 v[148:151], v18 offset:18432
    ds_read_b128 v[152:155], v19 offset:18432
    ds_read_b128 v[156:159], v18 offset:34816
    ds_read_b128 v[160:163], v19 offset:34816
    ds_read_b128 v[164:167], v18 offset:51200
    ds_read_b128 v[168:171], v19 offset:51200
    s_waitcnt lgkmcnt(12)
    v_add_f32 v108, v108, v116
    v_add_f32 v109, v109, v117
    v_add_f32 v110, v110, v118
    v_add_f32 v111, v111, v119
    v_add_f32 v112, v112, v120
    v_add_f32 v113, v113, v121
    v_add_f32 v114, v114, v122
    v_add_f32 v115, v115, v123
    s_waitcnt lgkmcnt(8)
    v_add_f32 v124, v124, v132
    v_add_f32 v125, v125, v133
    v_add_f32 v126, v126, v134
    v_add_f32 v127, v127, v135
    v_add_f32 v128, v128, v136
    v_add_f32 v129, v129, v137
    v_add_f32 v130, v130, v138
    v_add_f32 v131, v131, v139
    v_add_f32 v108, v108, v124
    v_add_f32 v109, v109, v125
    v_add_f32 v110, v110, v126
    v_add_f32 v111, v111, v127
    v_add_f32 v112, v112, v128
    v_add_f32 v113, v113, v129
    v_add_f32 v114, v114, v130
    v_add_f32 v115, v115, v131
    s_waitcnt vmcnt(0)
    v_cvt_pk_bf16_f32 v184, v108, v109
    v_lshlrev_b32 v180, 16, v184
    v_and_b32 v181, 0xffff0000, v184
    v_lshlrev_b32 v182, 16, v172
    v_and_b32 v183, 0xffff0000, v172
    v_add_f32 v180, v180, v182
    v_add_f32 v181, v181, v183
    v_cvt_pk_bf16_f32 v188, v180, v181
    v_cvt_pk_bf16_f32 v184, v110, v111
    v_lshlrev_b32 v180, 16, v184
    v_and_b32 v181, 0xffff0000, v184
    v_lshlrev_b32 v182, 16, v173
    v_and_b32 v183, 0xffff0000, v173
    v_add_f32 v180, v180, v182
    v_add_f32 v181, v181, v183
    v_cvt_pk_bf16_f32 v189, v180, v181
    v_cvt_pk_bf16_f32 v184, v112, v113
    v_lshlrev_b32 v180, 16, v184
    v_and_b32 v181, 0xffff0000, v184
    v_lshlrev_b32 v182, 16, v174
    v_and_b32 v183, 0xffff0000, v174
    v_add_f32 v180, v180, v182
    v_add_f32 v181, v181, v183
    v_cvt_pk_bf16_f32 v190, v180, v181
    v_cvt_pk_bf16_f32 v184, v114, v115
    v_lshlrev_b32 v180, 16, v184
    v_and_b32 v181, 0xffff0000, v184
    v_lshlrev_b32 v182, 16, v175
    v_and_b32 v183, 0xffff0000, v175
    v_add_f32 v180, v180, v182
    v_add_f32 v181, v181, v183
    v_cvt_pk_bf16_f32 v191, v180, v181
    buffer_store_dwordx4 v[188:191], v12, s[4:7], 0 offen sc1
    ds_write_b128 v22, v[188:191] offset:0
    v_dot2_f32_bf16 v92, v188, s44, 0
    v_dot2_f32_bf16 v93, v188, v188, 0
    v_dot2_f32_bf16 v92, v189, s44, v92
    v_dot2_f32_bf16 v93, v189, v189, v93
    v_dot2_f32_bf16 v92, v190, s44, v92
    v_dot2_f32_bf16 v93, v190, v190, v93
    v_dot2_f32_bf16 v92, v191, s44, v92
    v_dot2_f32_bf16 v93, v191, v191, v93
    s_waitcnt lgkmcnt(4)
    v_add_f32 v140, v140, v148
    v_add_f32 v141, v141, v149
    v_add_f32 v142, v142, v150
    v_add_f32 v143, v143, v151
    v_add_f32 v144, v144, v152
    v_add_f32 v145, v145, v153
    v_add_f32 v146, v146, v154
    v_add_f32 v147, v147, v155
    s_waitcnt lgkmcnt(0)
    v_add_f32 v156, v156, v164
    v_add_f32 v157, v157, v165
    v_add_f32 v158, v158, v166
    v_add_f32 v159, v159, v167
    v_add_f32 v160, v160, v168
    v_add_f32 v161, v161, v169
    v_add_f32 v162, v162, v170
    v_add_f32 v163, v163, v171
    v_add_f32 v140, v140, v156
    v_add_f32 v141, v141, v157
    v_add_f32 v142, v142, v158
    v_add_f32 v143, v143, v159
    v_add_f32 v144, v144, v160
    v_add_f32 v145, v145, v161
    v_add_f32 v146, v146, v162
    v_add_f32 v147, v147, v163
    v_cvt_pk_bf16_f32 v184, v140, v141
    v_lshlrev_b32 v180, 16, v184
    v_and_b32 v181, 0xffff0000, v184
    v_lshlrev_b32 v182, 16, v176
    v_and_b32 v183, 0xffff0000, v176
    v_add_f32 v180, v180, v182
    v_add_f32 v181, v181, v183
    v_cvt_pk_bf16_f32 v192, v180, v181
    v_cvt_pk_bf16_f32 v184, v142, v143
    v_lshlrev_b32 v180, 16, v184
    v_and_b32 v181, 0xffff0000, v184
    v_lshlrev_b32 v182, 16, v177
    v_and_b32 v183, 0xffff0000, v177
    v_add_f32 v180, v180, v182
    v_add_f32 v181, v181, v183
    v_cvt_pk_bf16_f32 v193, v180, v181
    v_cvt_pk_bf16_f32 v184, v144, v145
    v_lshlrev_b32 v180, 16, v184
    v_and_b32 v181, 0xffff0000, v184
    v_lshlrev_b32 v182, 16, v178
    v_and_b32 v183, 0xffff0000, v178
    v_add_f32 v180, v180, v182
    v_add_f32 v181, v181, v183
    v_cvt_pk_bf16_f32 v194, v180, v181
    v_cvt_pk_bf16_f32 v184, v146, v147
    v_lshlrev_b32 v180, 16, v184
    v_and_b32 v181, 0xffff0000, v184
    v_lshlrev_b32 v182, 16, v179
    v_and_b32 v183, 0xffff0000, v179
    v_add_f32 v180, v180, v182
    v_add_f32 v181, v181, v183
    v_cvt_pk_bf16_f32 v195, v180, v181
    buffer_store_dwordx4 v[192:195], v12, s[4:7], s41 offen sc1
    ds_write_b128 v22, v[192:195] offset:128
    v_dot2_f32_bf16 v94, v192, s44, 0
    v_dot2_f32_bf16 v95, v192, v192, 0
    v_dot2_f32_bf16 v94, v193, s44, v94
    v_dot2_f32_bf16 v95, v193, v193, v95
    v_dot2_f32_bf16 v94, v194, s44, v94
    v_dot2_f32_bf16 v95, v194, v194, v95
    v_dot2_f32_bf16 v94, v195, s44, v94
    v_dot2_f32_bf16 v95, v195, v195, v95
    s_waitcnt lgkmcnt(0)
    ds_read_b128 v[108:111], v23 offset:0
    ds_read_b128 v[112:115], v23 offset:1024
    v_add_f32_dpp v92, v92, v92 quad_perm:[1,0,3,2] row_mask:0xf bank_mask:0xf
    v_add_f32_dpp v93, v93, v93 quad_perm:[1,0,3,2] row_mask:0xf bank_mask:0xf
    v_add_f32_dpp v94, v94, v94 quad_perm:[1,0,3,2] row_mask:0xf bank_mask:0xf
    v_add_f32_dpp v95, v95, v95 quad_perm:[1,0,3,2] row_mask:0xf bank_mask:0xf
    v_add_f32_dpp v92, v92, v92 quad_perm:[2,3,0,1] row_mask:0xf bank_mask:0xf
    v_add_f32_dpp v93, v93, v93 quad_perm:[2,3,0,1] row_mask:0xf bank_mask:0xf
    v_add_f32_dpp v94, v94, v94 quad_perm:[2,3,0,1] row_mask:0xf bank_mask:0xf
    v_add_f32_dpp v95, v95, v95 quad_perm:[2,3,0,1] row_mask:0xf bank_mask:0xf
    v_add_f32_dpp v92, v92, v92 row_half_mirror row_mask:0xf bank_mask:0xf
    v_add_f32_dpp v93, v93, v93 row_half_mirror row_mask:0xf bank_mask:0xf
    v_add_f32_dpp v94, v94, v94 row_half_mirror row_mask:0xf bank_mask:0xf
    v_add_f32_dpp v95, v95, v95 row_half_mirror row_mask:0xf bank_mask:0xf
    s_mov_b64 exec, s[42:43]
    buffer_store_dwordx2 v[92:93], v25, s[4:7], 0 offen offset:0
    buffer_store_dwordx2 v[94:95], v25, s[4:7], 0 offen offset:512
    s_mov_b64 exec, -1
    s_waitcnt lgkmcnt(1)
    buffer_store_dwordx4 v[108:111], v24, s[4:7], 0 offen offset:0
    s_waitcnt lgkmcnt(0)
    buffer_store_dwordx4 v[112:115], v24, s[4:7], 0 offen offset:1024
    s_cmp_lg_u32 s100, 0
    s_cbranch_scc0 P3_fast
    v_mov_b32 v4, 1
    s_waitcnt vmcnt(0)
    s_mov_b64 exec, 1
    buffer_store_byte v4, off, s[4:7], s40
    s_mov_b64 exec, -1
    s_branch J_SLOW_next
P3_fast:
    s_mov_b32 s41, s40
J_P4:
    s_nop 7
    s_nop 7
    v_and_b32 v1, 63, v0
    v_and_b32 v2, 15, v1
    v_lshrrev_b32 v3, 4, v1
    s_and_b32 s20, s2, 7
    s_lshl_b32 s20, s20, 1
    s_bfe_u32 s22, s2, 0x10003
    s_add_u32 s20, s20, s22
    s_lshr_b32 s21, s2, 4
    s_lshl_b32 s40, s22, 1
    s_lshr_b32 s23, s3, 1
    s_add_u32 s40, s40, s23
    s_lshl_b32 s40, s40, 4
    s_add_u32 s40, s40, s21
    s_lshl_b32 s40, s40, 1
    s_and_b32 s23, s3, 1
    s_add_u32 s40, s40, s23
    s_add_u32 s40, s40, s8
    s_add_u32 s40, s40, 512
    v_lshlrev_b32 v4, 3, v3
    v_lshrrev_b32 v5, 2, v2
    v_add_u32 v4, v4, v5
    v_lshlrev_b32 v4, 6, v4
    v_and_b32 v5, 3, v2
    v_lshl_add_u32 v4, v5, 3, v4
    s_and_b32 s30, s21, 1
    v_and_b32 v5, 1, v3
    v_xor_b32 v5, s30, v5
    v_lshl_add_u32 v10, v5, 5, v4
    v_xor_b32 v5, 1, v5
    v_lshl_add_u32 v4, v5, 5, v4
    s_lshl_b32 s30, s30, 11
    v_add_u32 v11, s30, v4
    v_add_u32 v12, 73728, v10
    v_add_u32 v13, 73728, v11
    s_lshl_b32 s28, s3, 11
    s_add_u32 s28, s28, 16384
    v_lshlrev_b32 v4, 4, v1
    v_add_u32 v14, s28, v4
    v_add_u32 v15, 73728, v14
    v_lshrrev_b32 v4, 1, v3
    v_lshlrev_b32 v4, 5, v4
    v_add_u32 v4, v4, v2
    v_lshlrev_b32 v4, 4, v4
    v_and_b32 v5, 1, v3
    v_lshl_add_u32 v9, v5, 3, v4
    s_lshl_b32 s25, s20, 2
    s_add_u32 s25, s25, s3
    s_mul_i32 s25, s25, 112
    s_mul_i32 s30, s21, 7
    s_add_u32 s25, s25, s30
    s_lshl_b32 s25, s25, 10
    s_add_u32 s25, s25, 0xa00000
    v_lshlrev_b32 v8, 7, v1
    v_lshlrev_b32 v4, 4, v3
    v_add_u32 v17, 0x26000, v4
    s_lshl_b32 s30, s20, 2
    s_add_u32 s30, s30, s3
    s_lshl_b32 s30, s30, 11
    s_add_u32 s30, s30, 0x1410000
    v_lshl_add_u32 v4, v2, 6, v4
    v_lshlrev_b32 v4, 0, v4
    v_add_u32 v16, s30, v4
    s_cmp_lg_u32 s100, 0
    s_cbranch_scc1 P4_go
    v_mov_b32 v4, 1
    s_waitcnt vmcnt(0)
    s_mov_b64 exec, 1
    buffer_store_byte v4, off, s[4:7], s41
    s_mov_b64 exec, -1
P4_go:
    s_barrier
    ds_read_b128 v[32:35], v15 offset:0
    ds_read_b128 v[36:39], v15 offset:1024
    ds_read_b64_tr_b16 v[48:49], v12 offset:0
    ds_read_b64_tr_b16 v[50:51], v12 offset:256
    ds_read_b64_tr_b16 v[52:53], v13 offset:0
    ds_read_b64_tr_b16 v[54:55], v13 offset:256
    ds_read_b64_tr_b16 v[56:57], v12 offset:2048
    ds_read_b64_tr_b16 v[58:59], v12 offset:2304
    ds_read_b64_tr_b16 v[60:61], v13 offset:2048
    ds_read_b64_tr_b16 v[62:63], v13 offset:2304
    ds_read_b64_tr_b16 v[64:65], v12 offset:4096
    ds_read_b64_tr_b16 v[66:67], v12 offset:4352
    ds_read_b64_tr_b16 v[68:69], v13 offset:4096
    ds_read_b64_tr_b16 v[70:71], v13 offset:4352
    ds_read_b64_tr_b16 v[72:73], v12 offset:6144
    ds_read_b64_tr_b16 v[74:75], v12 offset:6400
    buffer_load_dwordx4 v[18:21], v16, s[4:7], 0 offen offset:0
    buffer_load_dwordx4 v[22:25], v16, s[4:7], 0 offen offset:1024
    s_waitcnt lgkmcnt(0)
    v_mfma_f32_16x16x32_bf16 v[104:107], v[48:51], v[32:35], 0
    ds_read_b64_tr_b16 v[76:77], v12 offset:8192
    ds_read_b64_tr_b16 v[78:79], v12 offset:8448
    v_mfma_f32_16x16x32_bf16 v[160:163], v[48:51], v[36:39], 0
    ds_read_b64_tr_b16 v[80:81], v13 offset:8192
    ds_read_b64_tr_b16 v[82:83], v13 offset:8448
    v_mfma_f32_16x16x32_bf16 v[108:111], v[52:55], v[32:35], 0
    ds_read_b64_tr_b16 v[84:85], v12 offset:10240
    ds_read_b64_tr_b16 v[86:87], v12 offset:10496
    v_mfma_f32_16x16x32_bf16 v[164:167], v[52:55], v[36:39], 0
    ds_read_b64_tr_b16 v[88:89], v13 offset:10240
    ds_read_b64_tr_b16 v[90:91], v13 offset:10496
    v_mfma_f32_16x16x32_bf16 v[112:115], v[56:59], v[32:35], 0
    ds_read_b64_tr_b16 v[92:93], v12 offset:12288
    ds_read_b64_tr_b16 v[94:95], v12 offset:12544
    v_mfma_f32_16x16x32_bf16 v[168:171], v[56:59], v[36:39], 0
    ds_read_b64_tr_b16 v[96:97], v13 offset:12288
    ds_read_b64_tr_b16 v[98:99], v13 offset:12544
    v_mfma_f32_16x16x32_bf16 v[116:119], v[60:63], v[32:35], 0
    ds_read_b64_tr_b16 v[100:101], v12 offset:14336
    ds_read_b64_tr_b16 v[102:103], v12 offset:14592
    v_mfma_f32_16x16x32_bf16 v[172:175], v[60:63], v[36:39], 0
    v_mfma_f32_16x16x32_bf16 v[120:123], v[64:67], v[32:35], 0
    v_mfma_f32_16x16x32_bf16 v[176:179], v[64:67], v[36:39], 0
    v_mfma_f32_16x16x32_bf16 v[124:127], v[68:71], v[32:35], 0
    v_mfma_f32_16x16x32_bf16 v[180:183], v[68:71], v[36:39], 0
    v_mfma_f32_16x16x32_bf16 v[128:131], v[72:75], v[32:35], 0
    v_mfma_f32_16x16x32_bf16 v[184:187], v[72:75], v[36:39], 0
    s_waitcnt lgkmcnt(0)
    s_barrier
    v_mfma_f32_16x16x32_bf16 v[132:135], v[76:79], v[32:35], 0
    ds_read_b128 v[40:43], v15 offset:24576
    ds_read_b128 v[44:47], v15 offset:25600
    v_mfma_f32_16x16x32_bf16 v[188:191], v[76:79], v[36:39], 0
    ds_read_b64_tr_b16 v[48:49], v12 offset:24576
    ds_read_b64_tr_b16 v[50:51], v12 offset:24832
    v_mfma_f32_16x16x32_bf16 v[136:139], v[80:83], v[32:35], 0
    ds_read_b64_tr_b16 v[52:53], v13 offset:24576
    ds_read_b64_tr_b16 v[54:55], v13 offset:24832
    v_mfma_f32_16x16x32_bf16 v[192:195], v[80:83], v[36:39], 0
    ds_read_b64_tr_b16 v[56:57], v12 offset:26624
    ds_read_b64_tr_b16 v[58:59], v12 offset:26880
    v_mfma_f32_16x16x32_bf16 v[140:143], v[84:87], v[32:35], 0
    ds_read_b64_tr_b16 v[60:61], v13 offset:26624
    ds_read_b64_tr_b16 v[62:63], v13 offset:26880
    v_mfma_f32_16x16x32_bf16 v[196:199], v[84:87], v[36:39], 0
    ds_read_b64_tr_b16 v[64:65], v12 offset:28672
    ds_read_b64_tr_b16 v[66:67], v12 offset:28928
    v_mfma_f32_16x16x32_bf16 v[144:147], v[88:91], v[32:35], 0
    ds_read_b64_tr_b16 v[68:69], v13 offset:28672
    ds_read_b64_tr_b16 v[70:71], v13 offset:28928
    v_mfma_f32_16x16x32_bf16 v[200:203], v[88:91], v[36:39], 0
    ds_read_b64_tr_b16 v[72:73], v12 offset:30720
    ds_read_b64_tr_b16 v[74:75], v12 offset:30976
    v_mfma_f32_16x16x32_bf16 v[148:151], v[92:95], v[32:35], 0
    v_mfma_f32_16x16x32_bf16 v[204:207], v[92:95], v[36:39], 0
    v_mfma_f32_16x16x32_bf16 v[152:155], v[96:99], v[32:35], 0
    v_mfma_f32_16x16x32_bf16 v[208:211], v[96:99], v[36:39], 0
    v_mfma_f32_16x16x32_bf16 v[156:159], v[100:103], v[32:35], 0
    v_mfma_f32_16x16x32_bf16 v[212:215], v[100:103], v[36:39], 0
    s_waitcnt lgkmcnt(0)
    v_mfma_f32_16x16x32_bf16 v[104:107], v[48:51], v[40:43], v[104:107]
    ds_read_b64_tr_b16 v[76:77], v12 offset:32768
    ds_read_b64_tr_b16 v[78:79], v12 offset:33024
    v_mfma_f32_16x16x32_bf16 v[160:163], v[48:51], v[44:47], v[160:163]
    ds_read_b64_tr_b16 v[80:81], v13 offset:32768
    ds_read_b64_tr_b16 v[82:83], v13 offset:33024
    v_mfma_f32_16x16x32_bf16 v[108:111], v[52:55], v[40:43], v[108:111]
    ds_read_b64_tr_b16 v[84:85], v12 offset:34816
    ds_read_b64_tr_b16 v[86:87], v12 offset:35072
    v_mfma_f32_16x16x32_bf16 v[164:167], v[52:55], v[44:47], v[164:167]
    ds_read_b64_tr_b16 v[88:89], v13 offset:34816
    ds_read_b64_tr_b16 v[90:91], v13 offset:35072
    v_mfma_f32_16x16x32_bf16 v[112:115], v[56:59], v[40:43], v[112:115]
    ds_read_b64_tr_b16 v[92:93], v12 offset:36864
    ds_read_b64_tr_b16 v[94:95], v12 offset:37120
    v_mfma_f32_16x16x32_bf16 v[168:171], v[56:59], v[44:47], v[168:171]
    ds_read_b64_tr_b16 v[96:97], v13 offset:36864
    ds_read_b64_tr_b16 v[98:99], v13 offset:37120
    v_mfma_f32_16x16x32_bf16 v[116:119], v[60:63], v[40:43], v[116:119]
    ds_read_b64_tr_b16 v[100:101], v12 offset:38912
    ds_read_b64_tr_b16 v[102:103], v12 offset:39168
    v_mfma_f32_16x16x32_bf16 v[172:175], v[60:63], v[44:47], v[172:175]
    v_mfma_f32_16x16x32_bf16 v[120:123], v[64:67], v[40:43], v[120:123]
    v_mfma_f32_16x16x32_bf16 v[176:179], v[64:67], v[44:47], v[176:179]
    v_mfma_f32_16x16x32_bf16 v[124:127], v[68:71], v[40:43], v[124:127]
    v_mfma_f32_16x16x32_bf16 v[180:183], v[68:71], v[44:47], v[180:183]
    v_mfma_f32_16x16x32_bf16 v[128:131], v[72:75], v[40:43], v[128:131]
    v_mfma_f32_16x16x32_bf16 v[184:187], v[72:75], v[44:47], v[184:187]
    s_waitcnt lgkmcnt(0)
    s_barrier
    v_mfma_f32_16x16x32_bf16 v[132:135], v[76:79], v[40:43], v[132:135]
    ds_read_b128 v[32:35], v15 offset:49152
    ds_read_b128 v[36:39], v15 offset:50176
    v_mfma_f32_16x16x32_bf16 v[188:191], v[76:79], v[44:47], v[188:191]
    ds_read_b64_tr_b16 v[48:49], v12 offset:49152
    ds_read_b64_tr_b16 v[50:51], v12 offset:49408
    v_mfma_f32_16x16x32_bf16 v[136:139], v[80:83], v[40:43], v[136:139]
    ds_read_b64_tr_b16 v[52:53], v13 offset:49152
    ds_read_b64_tr_b16 v[54:55], v13 offset:49408
    v_mfma_f32_16x16x32_bf16 v[192:195], v[80:83], v[44:47], v[192:195]
    ds_read_b64_tr_b16 v[56:57], v12 offset:51200
    ds_read_b64_tr_b16 v[58:59], v12 offset:51456
    v_mfma_f32_16x16x32_bf16 v[140:143], v[84:87], v[40:43], v[140:143]
    ds_read_b64_tr_b16 v[60:61], v13 offset:51200
    ds_read_b64_tr_b16 v[62:63], v13 offset:51456
    v_mfma_f32_16x16x32_bf16 v[196:199], v[84:87], v[44:47], v[196:199]
    ds_read_b64_tr_b16 v[64:65], v12 offset:53248
    ds_read_b64_tr_b16 v[66:67], v12 offset:53504
    v_mfma_f32_16x16x32_bf16 v[144:147], v[88:91], v[40:43], v[144:147]
    ds_read_b64_tr_b16 v[68:69], v13 offset:53248
    ds_read_b64_tr_b16 v[70:71], v13 offset:53504
    v_mfma_f32_16x16x32_bf16 v[200:203], v[88:91], v[44:47], v[200:203]
    ds_read_b64_tr_b16 v[72:73], v12 offset:55296
    ds_read_b64_tr_b16 v[74:75], v12 offset:55552
    v_mfma_f32_16x16x32_bf16 v[148:151], v[92:95], v[40:43], v[148:151]
    v_mfma_f32_16x16x32_bf16 v[204:207], v[92:95], v[44:47], v[204:207]
    v_mfma_f32_16x16x32_bf16 v[152:155], v[96:99], v[40:43], v[152:155]
    v_mfma_f32_16x16x32_bf16 v[208:211], v[96:99], v[44:47], v[208:211]
    v_mfma_f32_16x16x32_bf16 v[156:159], v[100:103], v[40:43], v[156:159]
    v_mfma_f32_16x16x32_bf16 v[212:215], v[100:103], v[44:47], v[212:215]
    s_waitcnt lgkmcnt(0)
    v_mfma_f32_16x16x32_bf16 v[104:107], v[48:51], v[32:35], v[104:107]
    ds_read_b64_tr_b16 v[76:77], v12 offset:57344
    ds_read_b64_tr_b16 v[78:79], v12 offset:57600
    v_mfma_f32_16x16x32_bf16 v[160:163], v[48:51], v[36:39], v[160:163]
    ds_read_b64_tr_b16 v[80:81], v13 offset:57344
    ds_read_b64_tr_b16 v[82:83], v13 offset:57600
    v_mfma_f32_16x16x32_bf16 v[108:111], v[52:55], v[32:35], v[108:111]
    ds_read_b64_tr_b16 v[84:85], v12 offset:59392
    ds_read_b64_tr_b16 v[86:87], v12 offset:59648
    v_mfma_f32_16x16x32_bf16 v[164:167], v[52:55], v[36:39], v[164:167]
    ds_read_b64_tr_b16 v[88:89], v13 offset:59392
    ds_read_b64_tr_b16 v[90:91], v13 offset:59648
    v_mfma_f32_16x16x32_bf16 v[112:115], v[56:59], v[32:35], v[112:115]
    ds_read_b64_tr_b16 v[92:93], v12 offset:61440
    ds_read_b64_tr_b16 v[94:95], v12 offset:61696
    v_mfma_f32_16x16x32_bf16 v[168:171], v[56:59], v[36:39], v[168:171]
    ds_read_b64_tr_b16 v[96:97], v13 offset:61440
    ds_read_b64_tr_b16 v[98:99], v13 offset:61696
    v_mfma_f32_16x16x32_bf16 v[116:119], v[60:63], v[32:35], v[116:119]
    ds_read_b64_tr_b16 v[100:101], v12 offset:63488
    ds_read_b64_tr_b16 v[102:103], v12 offset:63744
    v_mfma_f32_16x16x32_bf16 v[172:175], v[60:63], v[36:39], v[172:175]
    v_mfma_f32_16x16x32_bf16 v[120:123], v[64:67], v[32:35], v[120:123]
    v_mfma_f32_16x16x32_bf16 v[176:179], v[64:67], v[36:39], v[176:179]
    v_mfma_f32_16x16x32_bf16 v[124:127], v[68:71], v[32:35], v[124:127]
    v_mfma_f32_16x16x32_bf16 v[180:183], v[68:71], v[36:39], v[180:183]
    v_mfma_f32_16x16x32_bf16 v[128:131], v[72:75], v[32:35], v[128:131]
    v_mfma_f32_16x16x32_bf16 v[184:187], v[72:75], v[36:39], v[184:187]
    s_waitcnt lgkmcnt(0)
    s_barrier
    v_mfma_f32_16x16x32_bf16 v[132:135], v[76:79], v[32:35], v[132:135]
    ds_read_b128 v[40:43], v14 offset:0
    ds_read_b128 v[44:47], v14 offset:1024
    v_mfma_f32_16x16x32_bf16 v[188:191], v[76:79], v[36:39], v[188:191]
    ds_read_b64_tr_b16 v[48:49], v10 offset:0
    ds_read_b64_tr_b16 v[50:51], v10 offset:256
    v_mfma_f32_16x16x32_bf16 v[136:139], v[80:83], v[32:35], v[136:139]
    ds_read_b64_tr_b16 v[52:53], v11 offset:0
    ds_read_b64_tr_b16 v[54:55], v11 offset:256
    v_mfma_f32_16x16x32_bf16 v[192:195], v[80:83], v[36:39], v[192:195]
    ds_read_b64_tr_b16 v[56:57], v10 offset:2048
    ds_read_b64_tr_b16 v[58:59], v10 offset:2304
    v_mfma_f32_16x16x32_bf16 v[140:143], v[84:87], v[32:35], v[140:143]
    ds_read_b64_tr_b16 v[60:61], v11 offset:2048
    ds_read_b64_tr_b16 v[62:63], v11 offset:2304
    v_mfma_f32_16x16x32_bf16 v[196:199], v[84:87], v[36:39], v[196:199]
    ds_read_b64_tr_b16 v[64:65], v10 offset:4096
    ds_read_b64_tr_b16 v[66:67], v10 offset:4352
    v_mfma_f32_16x16x32_bf16 v[144:147], v[88:91], v[32:35], v[144:147]
    ds_read_b64_tr_b16 v[68:69], v11 offset:4096
    ds_read_b64_tr_b16 v[70:71], v11 offset:4352
    v_mfma_f32_16x16x32_bf16 v[200:203], v[88:91], v[36:39], v[200:203]
    ds_read_b64_tr_b16 v[72:73], v10 offset:6144
    ds_read_b64_tr_b16 v[74:75], v10 offset:6400
    v_mfma_f32_16x16x32_bf16 v[148:151], v[92:95], v[32:35], v[148:151]
    v_mfma_f32_16x16x32_bf16 v[204:207], v[92:95], v[36:39], v[204:207]
    v_mfma_f32_16x16x32_bf16 v[152:155], v[96:99], v[32:35], v[152:155]
    v_mfma_f32_16x16x32_bf16 v[208:211], v[96:99], v[36:39], v[208:211]
    v_mfma_f32_16x16x32_bf16 v[156:159], v[100:103], v[32:35], v[156:159]
    v_mfma_f32_16x16x32_bf16 v[212:215], v[100:103], v[36:39], v[212:215]
    s_waitcnt lgkmcnt(0)
    v_mfma_f32_16x16x32_bf16 v[104:107], v[48:51], v[40:43], v[104:107]
    ds_read_b64_tr_b16 v[76:77], v10 offset:8192
    ds_read_b64_tr_b16 v[78:79], v10 offset:8448
    v_mfma_f32_16x16x32_bf16 v[160:163], v[48:51], v[44:47], v[160:163]
    ds_read_b64_tr_b16 v[80:81], v11 offset:8192
    ds_read_b64_tr_b16 v[82:83], v11 offset:8448
    v_mfma_f32_16x16x32_bf16 v[108:111], v[52:55], v[40:43], v[108:111]
    ds_read_b64_tr_b16 v[84:85], v10 offset:10240
    ds_read_b64_tr_b16 v[86:87], v10 offset:10496
    v_mfma_f32_16x16x32_bf16 v[164:167], v[52:55], v[44:47], v[164:167]
    ds_read_b64_tr_b16 v[88:89], v11 offset:10240
    ds_read_b64_tr_b16 v[90:91], v11 offset:10496
    v_mfma_f32_16x16x32_bf16 v[112:115], v[56:59], v[40:43], v[112:115]
    ds_read_b64_tr_b16 v[92:93], v10 offset:12288
    ds_read_b64_tr_b16 v[94:95], v10 offset:12544
    v_mfma_f32_16x16x32_bf16 v[168:171], v[56:59], v[44:47], v[168:171]
    ds_read_b64_tr_b16 v[96:97], v11 offset:12288
    ds_read_b64_tr_b16 v[98:99], v11 offset:12544
    v_mfma_f32_16x16x32_bf16 v[116:119], v[60:63], v[40:43], v[116:119]
    ds_read_b64_tr_b16 v[100:101], v10 offset:14336
    ds_read_b64_tr_b16 v[102:103], v10 offset:14592
    v_mfma_f32_16x16x32_bf16 v[172:175], v[60:63], v[44:47], v[172:175]
    v_mfma_f32_16x16x32_bf16 v[120:123], v[64:67], v[40:43], v[120:123]
    v_mfma_f32_16x16x32_bf16 v[176:179], v[64:67], v[44:47], v[176:179]
    v_mfma_f32_16x16x32_bf16 v[124:127], v[68:71], v[40:43], v[124:127]
    v_mfma_f32_16x16x32_bf16 v[180:183], v[68:71], v[44:47], v[180:183]
    v_mfma_f32_16x16x32_bf16 v[128:131], v[72:75], v[40:43], v[128:131]
    v_mfma_f32_16x16x32_bf16 v[184:187], v[72:75], v[44:47], v[184:187]
    s_waitcnt lgkmcnt(0)
    s_barrier
    v_mfma_f32_16x16x32_bf16 v[132:135], v[76:79], v[40:43], v[132:135]
    ds_read_b128 v[32:35], v14 offset:24576
    ds_read_b128 v[36:39], v14 offset:25600
    v_mfma_f32_16x16x32_bf16 v[188:191], v[76:79], v[44:47], v[188:191]
    ds_read_b64_tr_b16 v[48:49], v10 offset:24576
    ds_read_b64_tr_b16 v[50:51], v10 offset:24832
    v_mfma_f32_16x16x32_bf16 v[136:139], v[80:83], v[40:43], v[136:139]
    ds_read_b64_tr_b16 v[52:53], v11 offset:24576
    ds_read_b64_tr_b16 v[54:55], v11 offset:24832
    v_mfma_f32_16x16x32_bf16 v[192:195], v[80:83], v[44:47], v[192:195]
    ds_read_b64_tr_b16 v[56:57], v10 offset:26624
    ds_read_b64_tr_b16 v[58:59], v10 offset:26880
    v_mfma_f32_16x16x32_bf16 v[140:143], v[84:87], v[40:43], v[140:143]
    ds_read_b64_tr_b16 v[60:61], v11 offset:26624
    ds_read_b64_tr_b16 v[62:63], v11 offset:26880
    v_mfma_f32_16x16x32_bf16 v[196:199], v[84:87], v[44:47], v[196:199]
    ds_read_b64_tr_b16 v[64:65], v10 offset:28672
    ds_read_b64_tr_b16 v[66:67], v10 offset:28928
    v_mfma_f32_16x16x32_bf16 v[144:147], v[88:91], v[40:43], v[144:147]
    ds_read_b64_tr_b16 v[68:69], v11 offset:28672
    ds_read_b64_tr_b16 v[70:71], v11 offset:28928
    v_mfma_f32_16x16x32_bf16 v[200:203], v[88:91], v[44:47], v[200:203]
    ds_read_b64_tr_b16 v[72:73], v10 offset:30720
    ds_read_b64_tr_b16 v[74:75], v10 offset:30976
    v_mfma_f32_16x16x32_bf16 v[148:151], v[92:95], v[40:43], v[148:151]
    v_mfma_f32_16x16x32_bf16 v[204:207], v[92:95], v[44:47], v[204:207]
    v_mfma_f32_16x16x32_bf16 v[152:155], v[96:99], v[40:43], v[152:155]
    v_mfma_f32_16x16x32_bf16 v[208:211], v[96:99], v[44:47], v[208:211]
    v_mfma_f32_16x16x32_bf16 v[156:159], v[100:103], v[40:43], v[156:159]
    v_mfma_f32_16x16x32_bf16 v[212:215], v[100:103], v[44:47], v[212:215]
    s_waitcnt lgkmcnt(0)
    s_waitcnt vmcnt(0)
    v_mfma_f32_16x16x32_bf16 v[104:107], v[48:51], v[32:35], v[104:107]
    ds_read_b64_tr_b16 v[76:77], v10 offset:32768
    ds_read_b64_tr_b16 v[78:79], v10 offset:33024
    v_mfma_f32_16x16x32_bf16 v[160:163], v[48:51], v[36:39], v[160:163]
    ds_read_b64_tr_b16 v[80:81], v11 offset:32768
    ds_read_b64_tr_b16 v[82:83], v11 offset:33024
    v_mfma_f32_16x16x32_bf16 v[108:111], v[52:55], v[32:35], v[108:111]
    ds_read_b64_tr_b16 v[84:85], v10 offset:34816
    ds_read_b64_tr_b16 v[86:87], v10 offset:35072
    v_mfma_f32_16x16x32_bf16 v[164:167], v[52:55], v[36:39], v[164:167]
    ds_read_b64_tr_b16 v[88:89], v11 offset:34816
    ds_read_b64_tr_b16 v[90:91], v11 offset:35072
    v_mfma_f32_16x16x32_bf16 v[112:115], v[56:59], v[32:35], v[112:115]
    ds_read_b64_tr_b16 v[92:93], v10 offset:36864
    ds_read_b64_tr_b16 v[94:95], v10 offset:37120
    v_mfma_f32_16x16x32_bf16 v[168:171], v[56:59], v[36:39], v[168:171]
    ds_read_b64_tr_b16 v[96:97], v11 offset:36864
    ds_read_b64_tr_b16 v[98:99], v11 offset:37120
    v_mfma_f32_16x16x32_bf16 v[116:119], v[60:63], v[32:35], v[116:119]
    ds_read_b64_tr_b16 v[100:101], v10 offset:38912
    ds_read_b64_tr_b16 v[102:103], v10 offset:39168
    v_add_f32 v18, v18, v20
    v_mov_b32 v20, v18
    v_mfma_f32_16x16x32_bf16 v[172:175], v[60:63], v[36:39], v[172:175]
    s_nop 0
    v_permlane32_swap_b32 v18, v20
    v_add_f32 v18, v18, v20
    v_mfma_f32_16x16x32_bf16 v[120:123], v[64:67], v[32:35], v[120:123]
    v_mov_b32 v20, v18
    s_nop 1
    v_permlane16_swap_b32 v18, v20
    v_mfma_f32_16x16x32_bf16 v[176:179], v[64:67], v[36:39], v[176:179]
    v_add_f32 v18, v18, v20
    v_add_f32 v19, v19, v21
    v_mfma_f32_16x16x32_bf16 v[124:127], v[68:71], v[32:35], v[124:127]
    v_mov_b32 v21, v19
    s_nop 1
    v_permlane32_swap_b32 v19, v21
    v_mfma_f32_16x16x32_bf16 v[180:183], v[68:71], v[36:39], v[180:183]
    v_add_f32 v19, v19, v21
    v_mov_b32 v21, v19
    v_mfma_f32_16x16x32_bf16 v[128:131], v[72:75], v[32:35], v[128:131]
    s_nop 0
    v_permlane16_swap_b32 v19, v21
    v_add_f32 v19, v19, v21
    v_mfma_f32_16x16x32_bf16 v[184:187], v[72:75], v[36:39], v[184:187]
    v_add_f32 v22, v22, v24
    v_mov_b32 v24, v22
    s_waitcnt lgkmcnt(0)
    s_barrier
    v_mfma_f32_16x16x32_bf16 v[132:135], v[76:79], v[32:35], v[132:135]
    ds_read_b128 v[40:43], v14 offset:49152
    ds_read_b128 v[44:47], v14 offset:50176
    v_mfma_f32_16x16x32_bf16 v[188:191], v[76:79], v[36:39], v[188:191]
    ds_read_b64_tr_b16 v[48:49], v10 offset:49152
    ds_read_b64_tr_b16 v[50:51], v10 offset:49408
    v_mfma_f32_16x16x32_bf16 v[136:139], v[80:83], v[32:35], v[136:139]
    ds_read_b64_tr_b16 v[52:53], v11 offset:49152
    ds_read_b64_tr_b16 v[54:55], v11 offset:49408
    v_mfma_f32_16x16x32_bf16 v[192:195], v[80:83], v[36:39], v[192:195]
    ds_read_b64_tr_b16 v[56:57], v10 offset:51200
    ds_read_b64_tr_b16 v[58:59], v10 offset:51456
    v_mfma_f32_16x16x32_bf16 v[140:143], v[84:87], v[32:35], v[140:143]
    ds_read_b64_tr_b16 v[60:61], v11 offset:51200
    ds_read_b64_tr_b16 v[62:63], v11 offset:51456
    v_mfma_f32_16x16x32_bf16 v[196:199], v[84:87], v[36:39], v[196:199]
    ds_read_b64_tr_b16 v[64:65], v10 offset:53248
    ds_read_b64_tr_b16 v[66:67], v10 offset:53504
    v_mfma_f32_16x16x32_bf16 v[144:147], v[88:91], v[32:35], v[144:147]
    ds_read_b64_tr_b16 v[68:69], v11 offset:53248
    ds_read_b64_tr_b16 v[70:71], v11 offset:53504
    v_mfma_f32_16x16x32_bf16 v[200:203], v[88:91], v[36:39], v[200:203]
    ds_read_b64_tr_b16 v[72:73], v10 offset:55296
    ds_read_b64_tr_b16 v[74:75], v10 offset:55552
    v_permlane32_swap_b32 v22, v24
    v_add_f32 v22, v22, v24
    v_mfma_f32_16x16x32_bf16 v[148:151], v[92:95], v[32:35], v[148:151]
    v_mov_b32 v24, v22
    s_nop 1
    v_permlane16_swap_b32 v22, v24
    v_mfma_f32_16x16x32_bf16 v[204:207], v[92:95], v[36:39], v[204:207]
    v_add_f32 v22, v22, v24
    v_add_f32 v23, v23, v25
    v_mfma_f32_16x16x32_bf16 v[152:155], v[96:99], v[32:35], v[152:155]
    v_mov_b32 v25, v23
    s_nop 1
    v_permlane32_swap_b32 v23, v25
    v_mfma_f32_16x16x32_bf16 v[208:211], v[96:99], v[36:39], v[208:211]
    v_add_f32 v23, v23, v25
    v_mov_b32 v25, v23
    v_mfma_f32_16x16x32_bf16 v[156:159], v[100:103], v[32:35], v[156:159]
    s_nop 0
    v_permlane16_swap_b32 v23, v25
    v_add_f32 v23, v23, v25
    v_mfma_f32_16x16x32_bf16 v[212:215], v[100:103], v[36:39], v[212:215]
    v_mul_f32 v26, 0x3b000000, v18
    v_mul_f32 v30, 0x3b000000, v19
    s_waitcnt lgkmcnt(0)
    v_mfma_f32_16x16x32_bf16 v[104:107], v[48:51], v[40:43], v[104:107]
    ds_read_b64_tr_b16 v[76:77], v10 offset:57344
    ds_read_b64_tr_b16 v[78:79], v10 offset:57600
    v_mfma_f32_16x16x32_bf16 v[160:163], v[48:51], v[44:47], v[160:163]
    ds_read_b64_tr_b16 v[80:81], v11 offset:57344
    ds_read_b64_tr_b16 v[82:83], v11 offset:57600
    v_mfma_f32_16x16x32_bf16 v[108:111], v[52:55], v[40:43], v[108:111]
    ds_read_b64_tr_b16 v[84:85], v10 offset:59392
    ds_read_b64_tr_b16 v[86:87], v10 offset:59648
    v_mfma_f32_16x16x32_bf16 v[164:167], v[52:55], v[44:47], v[164:167]
    ds_read_b64_tr_b16 v[88:89], v11 offset:59392
    ds_read_b64_tr_b16 v[90:91], v11 offset:59648
    v_mfma_f32_16x16x32_bf16 v[112:115], v[56:59], v[40:43], v[112:115]
    ds_read_b64_tr_b16 v[92:93], v10 offset:61440
    ds_read_b64_tr_b16 v[94:95], v10 offset:61696
    v_mfma_f32_16x16x32_bf16 v[168:171], v[56:59], v[44:47], v[168:171]
    ds_read_b64_tr_b16 v[96:97], v11 offset:61440
    ds_read_b64_tr_b16 v[98:99], v11 offset:61696
    v_mfma_f32_16x16x32_bf16 v[116:119], v[60:63], v[40:43], v[116:119]
    ds_read_b64_tr_b16 v[100:101], v10 offset:63488
    ds_read_b64_tr_b16 v[102:103], v10 offset:63744
    v_fma_f32 v30, -v26, v26, v30
    v_max_f32 v30, 0, v30
    v_mfma_f32_16x16x32_bf16 v[172:175], v[60:63], v[44:47], v[172:175]
    v_cvt_pk_bf16_f32 v216, v26, v30
    v_lshlrev_b32 v26, 16, v216
    v_mfma_f32_16x16x32_bf16 v[120:123], v[64:67], v[40:43], v[120:123]
    v_and_b32 v30, 0xffff0000, v216
    v_add_f32 v30, 0x3727c5ac, v30
    v_mfma_f32_16x16x32_bf16 v[176:179], v[64:67], v[44:47], v[176:179]
    v_cvt_pk_bf16_f32 v216, v30, v30
    v_lshlrev_b32 v30, 16, v216
    v_mfma_f32_16x16x32_bf16 v[124:127], v[68:71], v[40:43], v[124:127]
    v_sqrt_f32 v30, v30
    s_nop 0
    v_cvt_pk_bf16_f32 v216, v30, v30
    v_mfma_f32_16x16x32_bf16 v[180:183], v[68:71], v[44:47], v[180:183]
    v_lshlrev_b32 v30, 16, v216
    v_rcp_f32 v216, v30
    v_mfma_f32_16x16x32_bf16 v[128:131], v[72:75], v[40:43], v[128:131]
    v_mul_f32 v28, 0xbfb8aa3b, v216
    v_mul_f32 v30, v30, v30
    v_mfma_f32_16x16x32_bf16 v[184:187], v[72:75], v[44:47], v[184:187]
    v_mul_f32 v27, 0x3b000000, v22
    v_mul_f32 v31, 0x3b000000, v23
    s_waitcnt lgkmcnt(0)
    s_barrier
    v_mfma_f32_16x16x32_bf16 v[132:135], v[76:79], v[40:43], v[132:135]
    ds_read_b128 v[32:35], v15 offset:0
    ds_read_b128 v[36:39], v15 offset:1024
    v_mfma_f32_16x16x32_bf16 v[188:191], v[76:79], v[44:47], v[188:191]
    ds_read_b64_tr_b16 v[48:49], v12 offset:0
    ds_read_b64_tr_b16 v[50:51], v12 offset:256
    v_mfma_f32_16x16x32_bf16 v[136:139], v[80:83], v[40:43], v[136:139]
    ds_read_b64_tr_b16 v[52:53], v13 offset:0
    ds_read_b64_tr_b16 v[54:55], v13 offset:256
    v_mfma_f32_16x16x32_bf16 v[192:195], v[80:83], v[44:47], v[192:195]
    ds_read_b64_tr_b16 v[56:57], v12 offset:2048
    ds_read_b64_tr_b16 v[58:59], v12 offset:2304
    v_mfma_f32_16x16x32_bf16 v[140:143], v[84:87], v[40:43], v[140:143]
    ds_read_b64_tr_b16 v[60:61], v13 offset:2048
    ds_read_b64_tr_b16 v[62:63], v13 offset:2304
    v_mfma_f32_16x16x32_bf16 v[196:199], v[84:87], v[44:47], v[196:199]
    ds_read_b64_tr_b16 v[64:65], v12 offset:4096
    ds_read_b64_tr_b16 v[66:67], v12 offset:4352
    v_mfma_f32_16x16x32_bf16 v[144:147], v[88:91], v[40:43], v[144:147]
    ds_read_b64_tr_b16 v[68:69], v13 offset:4096
    ds_read_b64_tr_b16 v[70:71], v13 offset:4352
    v_mfma_f32_16x16x32_bf16 v[200:203], v[88:91], v[44:47], v[200:203]
    ds_read_b64_tr_b16 v[72:73], v12 offset:6144
    ds_read_b64_tr_b16 v[74:75], v12 offset:6400
    v_fma_f32 v31, -v27, v27, v31
    v_max_f32 v31, 0, v31
    v_mfma_f32_16x16x32_bf16 v[148:151], v[92:95], v[40:43], v[148:151]
    v_cvt_pk_bf16_f32 v216, v27, v31
    v_lshlrev_b32 v27, 16, v216
    v_mfma_f32_16x16x32_bf16 v[204:207], v[92:95], v[44:47], v[204:207]
    v_and_b32 v31, 0xffff0000, v216
    v_add_f32 v31, 0x3727c5ac, v31
    v_mfma_f32_16x16x32_bf16 v[152:155], v[96:99], v[40:43], v[152:155]
    v_cvt_pk_bf16_f32 v216, v31, v31
    v_lshlrev_b32 v31, 16, v216
    v_mfma_f32_16x16x32_bf16 v[208:211], v[96:99], v[44:47], v[208:211]
    v_sqrt_f32 v31, v31
    s_nop 0
    v_cvt_pk_bf16_f32 v216, v31, v31
    v_mfma_f32_16x16x32_bf16 v[156:159], v[100:103], v[40:43], v[156:159]
    v_lshlrev_b32 v31, 16, v216
    v_rcp_f32 v216, v31
    v_mfma_f32_16x16x32_bf16 v[212:215], v[100:103], v[44:47], v[212:215]
    v_mul_f32 v29, 0xbfb8aa3b, v216
    v_mul_f32 v31, v31, v31
    s_waitcnt lgkmcnt(0)
    v_mfma_f32_16x16x32_bf16 v[104:107], v[48:51], v[32:35], v[104:107]
    ds_read_b64_tr_b16 v[76:77], v12 offset:8192
    ds_read_b64_tr_b16 v[78:79], v12 offset:8448
    v_mfma_f32_16x16x32_bf16 v[160:163], v[48:51], v[36:39], v[160:163]
    ds_read_b64_tr_b16 v[80:81], v13 offset:8192
    ds_read_b64_tr_b16 v[82:83], v13 offset:8448
    v_mfma_f32_16x16x32_bf16 v[108:111], v[52:55], v[32:35], v[108:111]
    ds_read_b64_tr_b16 v[84:85], v12 offset:10240
    ds_read_b64_tr_b16 v[86:87], v12 offset:10496
    v_mfma_f32_16x16x32_bf16 v[164:167], v[52:55], v[36:39], v[164:167]
    ds_read_b64_tr_b16 v[88:89], v13 offset:10240
    ds_read_b64_tr_b16 v[90:91], v13 offset:10496
    v_mfma_f32_16x16x32_bf16 v[112:115], v[56:59], v[32:35], v[112:115]
    ds_read_b64_tr_b16 v[92:93], v12 offset:12288
    ds_read_b64_tr_b16 v[94:95], v12 offset:12544
    v_mfma_f32_16x16x32_bf16 v[168:171], v[56:59], v[36:39], v[168:171]
    ds_read_b64_tr_b16 v[96:97], v13 offset:12288
    ds_read_b64_tr_b16 v[98:99], v13 offset:12544
    v_mfma_f32_16x16x32_bf16 v[116:119], v[60:63], v[32:35], v[116:119]
    ds_read_b64_tr_b16 v[100:101], v12 offset:14336
    ds_read_b64_tr_b16 v[102:103], v12 offset:14592
    v_mfma_f32_16x16x32_bf16 v[172:175], v[60:63], v[36:39], v[172:175]
    v_mfma_f32_16x16x32_bf16 v[120:123], v[64:67], v[32:35], v[120:123]
    v_mfma_f32_16x16x32_bf16 v[176:179], v[64:67], v[36:39], v[176:179]
    v_mfma_f32_16x16x32_bf16 v[124:127], v[68:71], v[32:35], v[124:127]
    v_mfma_f32_16x16x32_bf16 v[180:183], v[68:71], v[36:39], v[180:183]
    v_mfma_f32_16x16x32_bf16 v[128:131], v[72:75], v[32:35], v[128:131]
    v_mfma_f32_16x16x32_bf16 v[184:187], v[72:75], v[36:39], v[184:187]
    s_waitcnt lgkmcnt(0)
    s_barrier
    v_mfma_f32_16x16x32_bf16 v[132:135], v[76:79], v[32:35], v[132:135]
    ds_read_b128 v[40:43], v15 offset:24576
    ds_read_b128 v[44:47], v15 offset:25600
    v_mfma_f32_16x16x32_bf16 v[188:191], v[76:79], v[36:39], v[188:191]
    ds_read_b64_tr_b16 v[48:49], v12 offset:24576
    ds_read_b64_tr_b16 v[50:51], v12 offset:24832
    v_mfma_f32_16x16x32_bf16 v[136:139], v[80:83], v[32:35], v[136:139]
    ds_read_b64_tr_b16 v[52:53], v13 offset:24576
    ds_read_b64_tr_b16 v[54:55], v13 offset:24832
    v_mfma_f32_16x16x32_bf16 v[192:195], v[80:83], v[36:39], v[192:195]
    ds_read_b64_tr_b16 v[56:57], v12 offset:26624
    ds_read_b64_tr_b16 v[58:59], v12 offset:26880
    v_mfma_f32_16x16x32_bf16 v[140:143], v[84:87], v[32:35], v[140:143]
    ds_read_b64_tr_b16 v[60:61], v13 offset:26624
    ds_read_b64_tr_b16 v[62:63], v13 offset:26880
    v_mfma_f32_16x16x32_bf16 v[196:199], v[84:87], v[36:39], v[196:199]
    ds_read_b64_tr_b16 v[64:65], v12 offset:28672
    ds_read_b64_tr_b16 v[66:67], v12 offset:28928
    v_mfma_f32_16x16x32_bf16 v[144:147], v[88:91], v[32:35], v[144:147]
    ds_read_b64_tr_b16 v[68:69], v13 offset:28672
    ds_read_b64_tr_b16 v[70:71], v13 offset:28928
    v_mfma_f32_16x16x32_bf16 v[200:203], v[88:91], v[36:39], v[200:203]
    ds_read_b64_tr_b16 v[72:73], v12 offset:30720
    ds_read_b64_tr_b16 v[74:75], v12 offset:30976
    v_mfma_f32_16x16x32_bf16 v[148:151], v[92:95], v[32:35], v[148:151]
    v_mfma_f32_16x16x32_bf16 v[204:207], v[92:95], v[36:39], v[204:207]
    v_mfma_f32_16x16x32_bf16 v[152:155], v[96:99], v[32:35], v[152:155]
    v_mfma_f32_16x16x32_bf16 v[208:211], v[96:99], v[36:39], v[208:211]
    v_mfma_f32_16x16x32_bf16 v[156:159], v[100:103], v[32:35], v[156:159]
    v_mfma_f32_16x16x32_bf16 v[212:215], v[100:103], v[36:39], v[212:215]
    s_waitcnt lgkmcnt(0)
    v_mfma_f32_16x16x32_bf16 v[104:107], v[48:51], v[40:43], v[104:107]
    ds_read_b64_tr_b16 v[76:77], v12 offset:32768
    ds_read_b64_tr_b16 v[78:79], v12 offset:33024
    v_mfma_f32_16x16x32_bf16 v[160:163], v[48:51], v[44:47], v[160:163]
    ds_read_b64_tr_b16 v[80:81], v13 offset:32768
    ds_read_b64_tr_b16 v[82:83], v13 offset:33024
    v_mfma_f32_16x16x32_bf16 v[108:111], v[52:55], v[40:43], v[108:111]
    ds_read_b64_tr_b16 v[84:85], v12 offset:34816
    ds_read_b64_tr_b16 v[86:87], v12 offset:35072
    v_mfma_f32_16x16x32_bf16 v[164:167], v[52:55], v[44:47], v[164:167]
    ds_read_b64_tr_b16 v[88:89], v13 offset:34816
    ds_read_b64_tr_b16 v[90:91], v13 offset:35072
    v_mfma_f32_16x16x32_bf16 v[112:115], v[56:59], v[40:43], v[112:115]
    ds_read_b64_tr_b16 v[92:93], v12 offset:36864
    ds_read_b64_tr_b16 v[94:95], v12 offset:37120
    v_mfma_f32_16x16x32_bf16 v[168:171], v[56:59], v[44:47], v[168:171]
    ds_read_b64_tr_b16 v[96:97], v13 offset:36864
    ds_read_b64_tr_b16 v[98:99], v13 offset:37120
    v_mfma_f32_16x16x32_bf16 v[116:119], v[60:63], v[40:43], v[116:119]
    ds_read_b64_tr_b16 v[100:101], v12 offset:38912
    ds_read_b64_tr_b16 v[102:103], v12 offset:39168
    v_mfma_f32_16x16x32_bf16 v[172:175], v[60:63], v[44:47], v[172:175]
    v_mfma_f32_16x16x32_bf16 v[120:123], v[64:67], v[40:43], v[120:123]
    v_mfma_f32_16x16x32_bf16 v[176:179], v[64:67], v[44:47], v[176:179]
    v_mfma_f32_16x16x32_bf16 v[124:127], v[68:71], v[40:43], v[124:127]
    v_mfma_f32_16x16x32_bf16 v[180:183], v[68:71], v[44:47], v[180:183]
    v_mfma_f32_16x16x32_bf16 v[128:131], v[72:75], v[40:43], v[128:131]
    v_mfma_f32_16x16x32_bf16 v[184:187], v[72:75], v[44:47], v[184:187]
    s_waitcnt lgkmcnt(0)
    s_barrier
    v_mfma_f32_16x16x32_bf16 v[132:135], v[76:79], v[40:43], v[132:135]
    ds_read_b128 v[32:35], v15 offset:49152
    ds_read_b128 v[36:39], v15 offset:50176
    v_mfma_f32_16x16x32_bf16 v[188:191], v[76:79], v[44:47], v[188:191]
    ds_read_b64_tr_b16 v[48:49], v12 offset:49152
    ds_read_b64_tr_b16 v[50:51], v12 offset:49408
    v_mfma_f32_16x16x32_bf16 v[136:139], v[80:83], v[40:43], v[136:139]
    ds_read_b64_tr_b16 v[52:53], v13 offset:49152
    ds_read_b64_tr_b16 v[54:55], v13 offset:49408
    v_mfma_f32_16x16x32_bf16 v[192:195], v[80:83], v[44:47], v[192:195]
    ds_read_b64_tr_b16 v[56:57], v12 offset:51200
    ds_read_b64_tr_b16 v[58:59], v12 offset:51456
    v_mfma_f32_16x16x32_bf16 v[140:143], v[84:87], v[40:43], v[140:143]
    ds_read_b64_tr_b16 v[60:61], v13 offset:51200
    ds_read_b64_tr_b16 v[62:63], v13 offset:51456
    v_mfma_f32_16x16x32_bf16 v[196:199], v[84:87], v[44:47], v[196:199]
    ds_read_b64_tr_b16 v[64:65], v12 offset:53248
    ds_read_b64_tr_b16 v[66:67], v12 offset:53504
    v_mfma_f32_16x16x32_bf16 v[144:147], v[88:91], v[40:43], v[144:147]
    ds_read_b64_tr_b16 v[68:69], v13 offset:53248
    ds_read_b64_tr_b16 v[70:71], v13 offset:53504
    v_mfma_f32_16x16x32_bf16 v[200:203], v[88:91], v[44:47], v[200:203]
    ds_read_b64_tr_b16 v[72:73], v12 offset:55296
    ds_read_b64_tr_b16 v[74:75], v12 offset:55552
    v_mfma_f32_16x16x32_bf16 v[148:151], v[92:95], v[40:43], v[148:151]
    v_mfma_f32_16x16x32_bf16 v[204:207], v[92:95], v[44:47], v[204:207]
    v_mfma_f32_16x16x32_bf16 v[152:155], v[96:99], v[40:43], v[152:155]
    v_mfma_f32_16x16x32_bf16 v[208:211], v[96:99], v[44:47], v[208:211]
    v_mfma_f32_16x16x32_bf16 v[156:159], v[100:103], v[40:43], v[156:159]
    v_mfma_f32_16x16x32_bf16 v[212:215], v[100:103], v[44:47], v[212:215]
    s_waitcnt lgkmcnt(0)
    v_mfma_f32_16x16x32_bf16 v[104:107], v[48:51], v[32:35], v[104:107]
    ds_read_b64_tr_b16 v[76:77], v12 offset:57344
    ds_read_b64_tr_b16 v[78:79], v12 offset:57600
    v_mfma_f32_16x16x32_bf16 v[160:163], v[48:51], v[36:39], v[160:163]
    ds_read_b64_tr_b16 v[80:81], v13 offset:57344
    ds_read_b64_tr_b16 v[82:83], v13 offset:57600
    v_mfma_f32_16x16x32_bf16 v[108:111], v[52:55], v[32:35], v[108:111]
    ds_read_b64_tr_b16 v[84:85], v12 offset:59392
    ds_read_b64_tr_b16 v[86:87], v12 offset:59648
    v_mfma_f32_16x16x32_bf16 v[164:167], v[52:55], v[36:39], v[164:167]
    ds_read_b64_tr_b16 v[88:89], v13 offset:59392
    ds_read_b64_tr_b16 v[90:91], v13 offset:59648
    v_mfma_f32_16x16x32_bf16 v[112:115], v[56:59], v[32:35], v[112:115]
    ds_read_b64_tr_b16 v[92:93], v12 offset:61440
    ds_read_b64_tr_b16 v[94:95], v12 offset:61696
    v_mfma_f32_16x16x32_bf16 v[168:171], v[56:59], v[36:39], v[168:171]
    ds_read_b64_tr_b16 v[96:97], v13 offset:61440
    ds_read_b64_tr_b16 v[98:99], v13 offset:61696
    v_mfma_f32_16x16x32_bf16 v[116:119], v[60:63], v[32:35], v[116:119]
    ds_read_b64_tr_b16 v[100:101], v12 offset:63488
    ds_read_b64_tr_b16 v[102:103], v12 offset:63744
    v_mfma_f32_16x16x32_bf16 v[172:175], v[60:63], v[36:39], v[172:175]
    v_mfma_f32_16x16x32_bf16 v[120:123], v[64:67], v[32:35], v[120:123]
    v_mfma_f32_16x16x32_bf16 v[176:179], v[64:67], v[36:39], v[176:179]
    v_mfma_f32_16x16x32_bf16 v[124:127], v[68:71], v[32:35], v[124:127]
    v_mfma_f32_16x16x32_bf16 v[180:183], v[68:71], v[36:39], v[180:183]
    v_mfma_f32_16x16x32_bf16 v[128:131], v[72:75], v[32:35], v[128:131]
    v_mfma_f32_16x16x32_bf16 v[184:187], v[72:75], v[36:39], v[184:187]
    s_waitcnt lgkmcnt(0)
    s_barrier
    v_mfma_f32_16x16x32_bf16 v[132:135], v[76:79], v[32:35], v[132:135]
    ds_read_b128 v[40:43], v14 offset:0
    ds_read_b128 v[44:47], v14 offset:1024
    v_mfma_f32_16x16x32_bf16 v[188:191], v[76:79], v[36:39], v[188:191]
    ds_read_b64_tr_b16 v[48:49], v10 offset:0
    ds_read_b64_tr_b16 v[50:51], v10 offset:256
    v_mfma_f32_16x16x32_bf16 v[136:139], v[80:83], v[32:35], v[136:139]
    ds_read_b64_tr_b16 v[52:53], v11 offset:0
    ds_read_b64_tr_b16 v[54:55], v11 offset:256
    v_mfma_f32_16x16x32_bf16 v[192:195], v[80:83], v[36:39], v[192:195]
    ds_read_b64_tr_b16 v[56:57], v10 offset:2048
    ds_read_b64_tr_b16 v[58:59], v10 offset:2304
    v_mfma_f32_16x16x32_bf16 v[140:143], v[84:87], v[32:35], v[140:143]
    ds_read_b64_tr_b16 v[60:61], v11 offset:2048
    ds_read_b64_tr_b16 v[62:63], v11 offset:2304
    v_mfma_f32_16x16x32_bf16 v[196:199], v[84:87], v[36:39], v[196:199]
    ds_read_b64_tr_b16 v[64:65], v10 offset:4096
    ds_read_b64_tr_b16 v[66:67], v10 offset:4352
    v_mfma_f32_16x16x32_bf16 v[144:147], v[88:91], v[32:35], v[144:147]
    ds_read_b64_tr_b16 v[68:69], v11 offset:4096
    ds_read_b64_tr_b16 v[70:71], v11 offset:4352
    v_mfma_f32_16x16x32_bf16 v[200:203], v[88:91], v[36:39], v[200:203]
    ds_read_b64_tr_b16 v[72:73], v10 offset:6144
    ds_read_b64_tr_b16 v[74:75], v10 offset:6400
    v_mfma_f32_16x16x32_bf16 v[148:151], v[92:95], v[32:35], v[148:151]
    v_mfma_f32_16x16x32_bf16 v[204:207], v[92:95], v[36:39], v[204:207]
    v_mfma_f32_16x16x32_bf16 v[152:155], v[96:99], v[32:35], v[152:155]
    v_mfma_f32_16x16x32_bf16 v[208:211], v[96:99], v[36:39], v[208:211]
    v_mfma_f32_16x16x32_bf16 v[156:159], v[100:103], v[32:35], v[156:159]
    v_mfma_f32_16x16x32_bf16 v[212:215], v[100:103], v[36:39], v[212:215]
    s_waitcnt lgkmcnt(0)
    v_mfma_f32_16x16x32_bf16 v[104:107], v[48:51], v[40:43], v[104:107]
    ds_read_b64_tr_b16 v[76:77], v10 offset:8192
    ds_read_b64_tr_b16 v[78:79], v10 offset:8448
    v_mfma_f32_16x16x32_bf16 v[160:163], v[48:51], v[44:47], v[160:163]
    ds_read_b64_tr_b16 v[80:81], v11 offset:8192
    ds_read_b64_tr_b16 v[82:83], v11 offset:8448
    v_mfma_f32_16x16x32_bf16 v[108:111], v[52:55], v[40:43], v[108:111]
    ds_read_b64_tr_b16 v[84:85], v10 offset:10240
    ds_read_b64_tr_b16 v[86:87], v10 offset:10496
    v_mfma_f32_16x16x32_bf16 v[164:167], v[52:55], v[44:47], v[164:167]
    ds_read_b64_tr_b16 v[88:89], v11 offset:10240
    ds_read_b64_tr_b16 v[90:91], v11 offset:10496
    v_mfma_f32_16x16x32_bf16 v[112:115], v[56:59], v[40:43], v[112:115]
    ds_read_b64_tr_b16 v[92:93], v10 offset:12288
    ds_read_b64_tr_b16 v[94:95], v10 offset:12544
    v_mfma_f32_16x16x32_bf16 v[168:171], v[56:59], v[44:47], v[168:171]
    ds_read_b64_tr_b16 v[96:97], v11 offset:12288
    ds_read_b64_tr_b16 v[98:99], v11 offset:12544
    v_mfma_f32_16x16x32_bf16 v[116:119], v[60:63], v[40:43], v[116:119]
    ds_read_b64_tr_b16 v[100:101], v10 offset:14336
    ds_read_b64_tr_b16 v[102:103], v10 offset:14592
    v_mfma_f32_16x16x32_bf16 v[172:175], v[60:63], v[44:47], v[172:175]
    v_mfma_f32_16x16x32_bf16 v[120:123], v[64:67], v[40:43], v[120:123]
    v_mfma_f32_16x16x32_bf16 v[176:179], v[64:67], v[44:47], v[176:179]
    v_mfma_f32_16x16x32_bf16 v[124:127], v[68:71], v[40:43], v[124:127]
    v_mfma_f32_16x16x32_bf16 v[180:183], v[68:71], v[44:47], v[180:183]
    v_mfma_f32_16x16x32_bf16 v[128:131], v[72:75], v[40:43], v[128:131]
    v_mfma_f32_16x16x32_bf16 v[184:187], v[72:75], v[44:47], v[184:187]
    s_waitcnt lgkmcnt(0)
    s_barrier
    v_mfma_f32_16x16x32_bf16 v[132:135], v[76:79], v[40:43], v[132:135]
    ds_read_b128 v[32:35], v14 offset:24576
    ds_read_b128 v[36:39], v14 offset:25600
    v_mfma_f32_16x16x32_bf16 v[188:191], v[76:79], v[44:47], v[188:191]
    ds_read_b64_tr_b16 v[48:49], v10 offset:24576
    ds_read_b64_tr_b16 v[50:51], v10 offset:24832
    v_mfma_f32_16x16x32_bf16 v[136:139], v[80:83], v[40:43], v[136:139]
    ds_read_b64_tr_b16 v[52:53], v11 offset:24576
    ds_read_b64_tr_b16 v[54:55], v11 offset:24832
    v_mfma_f32_16x16x32_bf16 v[192:195], v[80:83], v[44:47], v[192:195]
    ds_read_b64_tr_b16 v[56:57], v10 offset:26624
    ds_read_b64_tr_b16 v[58:59], v10 offset:26880
    v_mfma_f32_16x16x32_bf16 v[140:143], v[84:87], v[40:43], v[140:143]
    ds_read_b64_tr_b16 v[60:61], v11 offset:26624
    ds_read_b64_tr_b16 v[62:63], v11 offset:26880
    v_mfma_f32_16x16x32_bf16 v[196:199], v[84:87], v[44:47], v[196:199]
    ds_read_b64_tr_b16 v[64:65], v10 offset:28672
    ds_read_b64_tr_b16 v[66:67], v10 offset:28928
    v_mfma_f32_16x16x32_bf16 v[144:147], v[88:91], v[40:43], v[144:147]
    ds_read_b64_tr_b16 v[68:69], v11 offset:28672
    ds_read_b64_tr_b16 v[70:71], v11 offset:28928
    v_mfma_f32_16x16x32_bf16 v[200:203], v[88:91], v[44:47], v[200:203]
    ds_read_b64_tr_b16 v[72:73], v10 offset:30720
    ds_read_b64_tr_b16 v[74:75], v10 offset:30976
    v_mfma_f32_16x16x32_bf16 v[148:151], v[92:95], v[40:43], v[148:151]
    v_mfma_f32_16x16x32_bf16 v[204:207], v[92:95], v[44:47], v[204:207]
    v_mfma_f32_16x16x32_bf16 v[152:155], v[96:99], v[40:43], v[152:155]
    v_mfma_f32_16x16x32_bf16 v[208:211], v[96:99], v[44:47], v[208:211]
    v_mfma_f32_16x16x32_bf16 v[156:159], v[100:103], v[40:43], v[156:159]
    v_mfma_f32_16x16x32_bf16 v[212:215], v[100:103], v[44:47], v[212:215]
    s_waitcnt lgkmcnt(0)
    v_mfma_f32_16x16x32_bf16 v[104:107], v[48:51], v[32:35], v[104:107]
    ds_read_b64_tr_b16 v[76:77], v10 offset:32768
    ds_read_b64_tr_b16 v[78:79], v10 offset:33024
    v_mfma_f32_16x16x32_bf16 v[160:163], v[48:51], v[36:39], v[160:163]
    ds_read_b64_tr_b16 v[80:81], v11 offset:32768
    ds_read_b64_tr_b16 v[82:83], v11 offset:33024
    v_mfma_f32_16x16x32_bf16 v[108:111], v[52:55], v[32:35], v[108:111]
    ds_read_b64_tr_b16 v[84:85], v10 offset:34816
    ds_read_b64_tr_b16 v[86:87], v10 offset:35072
    v_mfma_f32_16x16x32_bf16 v[164:167], v[52:55], v[36:39], v[164:167]
    ds_read_b64_tr_b16 v[88:89], v11 offset:34816
    ds_read_b64_tr_b16 v[90:91], v11 offset:35072
    v_mfma_f32_16x16x32_bf16 v[112:115], v[56:59], v[32:35], v[112:115]
    ds_read_b64_tr_b16 v[92:93], v10 offset:36864
    ds_read_b64_tr_b16 v[94:95], v10 offset:37120
    v_mfma_f32_16x16x32_bf16 v[168:171], v[56:59], v[36:39], v[168:171]
    ds_read_b64_tr_b16 v[96:97], v11 offset:36864
    ds_read_b64_tr_b16 v[98:99], v11 offset:37120
    v_mfma_f32_16x16x32_bf16 v[116:119], v[60:63], v[32:35], v[116:119]
    ds_read_b64_tr_b16 v[100:101], v10 offset:38912
    ds_read_b64_tr_b16 v[102:103], v10 offset:39168
    v_mfma_f32_16x16x32_bf16 v[172:175], v[60:63], v[36:39], v[172:175]
    v_mfma_f32_16x16x32_bf16 v[120:123], v[64:67], v[32:35], v[120:123]
    v_mfma_f32_16x16x32_bf16 v[176:179], v[64:67], v[36:39], v[176:179]
    v_mfma_f32_16x16x32_bf16 v[124:127], v[68:71], v[32:35], v[124:127]
    v_mfma_f32_16x16x32_bf16 v[180:183], v[68:71], v[36:39], v[180:183]
    v_mfma_f32_16x16x32_bf16 v[128:131], v[72:75], v[32:35], v[128:131]
    v_mfma_f32_16x16x32_bf16 v[184:187], v[72:75], v[36:39], v[184:187]
    s_waitcnt lgkmcnt(0)
    s_barrier
    v_mfma_f32_16x16x32_bf16 v[132:135], v[76:79], v[32:35], v[132:135]
    ds_read_b128 v[40:43], v14 offset:49152
    ds_read_b128 v[44:47], v14 offset:50176
    v_mfma_f32_16x16x32_bf16 v[188:191], v[76:79], v[36:39], v[188:191]
    ds_read_b64_tr_b16 v[48:49], v10 offset:49152
    ds_read_b64_tr_b16 v[50:51], v10 offset:49408
    v_mfma_f32_16x16x32_bf16 v[136:139], v[80:83], v[32:35], v[136:139]
    ds_read_b64_tr_b16 v[52:53], v11 offset:49152
    ds_read_b64_tr_b16 v[54:55], v11 offset:49408
    v_mfma_f32_16x16x32_bf16 v[192:195], v[80:83], v[36:39], v[192:195]
    ds_read_b64_tr_b16 v[56:57], v10 offset:51200
    ds_read_b64_tr_b16 v[58:59], v10 offset:51456
    v_mfma_f32_16x16x32_bf16 v[140:143], v[84:87], v[32:35], v[140:143]
    ds_read_b64_tr_b16 v[60:61], v11 offset:51200
    ds_read_b64_tr_b16 v[62:63], v11 offset:51456
    v_mfma_f32_16x16x32_bf16 v[196:199], v[84:87], v[36:39], v[196:199]
    ds_read_b64_tr_b16 v[64:65], v10 offset:53248
    ds_read_b64_tr_b16 v[66:67], v10 offset:53504
    v_mfma_f32_16x16x32_bf16 v[144:147], v[88:91], v[32:35], v[144:147]
    ds_read_b64_tr_b16 v[68:69], v11 offset:53248
    ds_read_b64_tr_b16 v[70:71], v11 offset:53504
    v_mfma_f32_16x16x32_bf16 v[200:203], v[88:91], v[36:39], v[200:203]
    ds_read_b64_tr_b16 v[72:73], v10 offset:55296
    ds_read_b64_tr_b16 v[74:75], v10 offset:55552
    v_mfma_f32_16x16x32_bf16 v[148:151], v[92:95], v[32:35], v[148:151]
    v_mfma_f32_16x16x32_bf16 v[204:207], v[92:95], v[36:39], v[204:207]
    v_mfma_f32_16x16x32_bf16 v[152:155], v[96:99], v[32:35], v[152:155]
    v_mfma_f32_16x16x32_bf16 v[208:211], v[96:99], v[36:39], v[208:211]
    v_mfma_f32_16x16x32_bf16 v[156:159], v[100:103], v[32:35], v[156:159]
    v_mfma_f32_16x16x32_bf16 v[212:215], v[100:103], v[36:39], v[212:215]
    s_waitcnt lgkmcnt(0)
    v_mfma_f32_16x16x32_bf16 v[104:107], v[48:51], v[40:43], v[104:107]
    ds_read_b64_tr_b16 v[76:77], v10 offset:57344
    ds_read_b64_tr_b16 v[78:79], v10 offset:57600
    v_mfma_f32_16x16x32_bf16 v[160:163], v[48:51], v[44:47], v[160:163]
    ds_read_b64_tr_b16 v[80:81], v11 offset:57344
    ds_read_b64_tr_b16 v[82:83], v11 offset:57600
    v_mfma_f32_16x16x32_bf16 v[108:111], v[52:55], v[40:43], v[108:111]
    ds_read_b64_tr_b16 v[84:85], v10 offset:59392
    ds_read_b64_tr_b16 v[86:87], v10 offset:59648
    v_mfma_f32_16x16x32_bf16 v[164:167], v[52:55], v[44:47], v[164:167]
    ds_read_b64_tr_b16 v[88:89], v11 offset:59392
    ds_read_b64_tr_b16 v[90:91], v11 offset:59648
    v_mfma_f32_16x16x32_bf16 v[112:115], v[56:59], v[40:43], v[112:115]
    ds_read_b64_tr_b16 v[92:93], v10 offset:61440
    ds_read_b64_tr_b16 v[94:95], v10 offset:61696
    v_mfma_f32_16x16x32_bf16 v[168:171], v[56:59], v[44:47], v[168:171]
    ds_read_b64_tr_b16 v[96:97], v11 offset:61440
    ds_read_b64_tr_b16 v[98:99], v11 offset:61696
    v_mfma_f32_16x16x32_bf16 v[116:119], v[60:63], v[40:43], v[116:119]
    ds_read_b64_tr_b16 v[100:101], v10 offset:63488
    ds_read_b64_tr_b16 v[102:103], v10 offset:63744
    v_mfma_f32_16x16x32_bf16 v[172:175], v[60:63], v[44:47], v[172:175]
    v_mfma_f32_16x16x32_bf16 v[120:123], v[64:67], v[40:43], v[120:123]
    v_mfma_f32_16x16x32_bf16 v[176:179], v[64:67], v[44:47], v[176:179]
    v_mfma_f32_16x16x32_bf16 v[124:127], v[68:71], v[40:43], v[124:127]
    v_mfma_f32_16x16x32_bf16 v[180:183], v[68:71], v[44:47], v[180:183]
    v_mfma_f32_16x16x32_bf16 v[128:131], v[72:75], v[40:43], v[128:131]
    v_mfma_f32_16x16x32_bf16 v[184:187], v[72:75], v[44:47], v[184:187]
    s_waitcnt lgkmcnt(0)
    s_barrier
    v_mfma_f32_16x16x32_bf16 v[132:135], v[76:79], v[40:43], v[132:135]
    ds_read_b128 v[32:35], v15 offset:0
    ds_read_b128 v[36:39], v15 offset:1024
    v_mfma_f32_16x16x32_bf16 v[188:191], v[76:79], v[44:47], v[188:191]
    ds_read_b64_tr_b16 v[48:49], v12 offset:0
    ds_read_b64_tr_b16 v[50:51], v12 offset:256
    v_mfma_f32_16x16x32_bf16 v[136:139], v[80:83], v[40:43], v[136:139]
    ds_read_b64_tr_b16 v[52:53], v13 offset:0
    ds_read_b64_tr_b16 v[54:55], v13 offset:256
    v_mfma_f32_16x16x32_bf16 v[192:195], v[80:83], v[44:47], v[192:195]
    ds_read_b64_tr_b16 v[56:57], v12 offset:2048
    ds_read_b64_tr_b16 v[58:59], v12 offset:2304
    v_mfma_f32_16x16x32_bf16 v[140:143], v[84:87], v[40:43], v[140:143]
    ds_read_b64_tr_b16 v[60:61], v13 offset:2048
    ds_read_b64_tr_b16 v[62:63], v13 offset:2304
    v_mfma_f32_16x16x32_bf16 v[196:199], v[84:87], v[44:47], v[196:199]
    ds_read_b64_tr_b16 v[64:65], v12 offset:4096
    ds_read_b64_tr_b16 v[66:67], v12 offset:4352
    v_mfma_f32_16x16x32_bf16 v[144:147], v[88:91], v[40:43], v[144:147]
    ds_read_b64_tr_b16 v[68:69], v13 offset:4096
    ds_read_b64_tr_b16 v[70:71], v13 offset:4352
    v_mfma_f32_16x16x32_bf16 v[200:203], v[88:91], v[44:47], v[200:203]
    ds_read_b64_tr_b16 v[72:73], v12 offset:6144
    ds_read_b64_tr_b16 v[74:75], v12 offset:6400
    v_mfma_f32_16x16x32_bf16 v[148:151], v[92:95], v[40:43], v[148:151]
    v_mfma_f32_16x16x32_bf16 v[204:207], v[92:95], v[44:47], v[204:207]
    v_mfma_f32_16x16x32_bf16 v[152:155], v[96:99], v[40:43], v[152:155]
    v_mfma_f32_16x16x32_bf16 v[208:211], v[96:99], v[44:47], v[208:211]
    v_mfma_f32_16x16x32_bf16 v[156:159], v[100:103], v[40:43], v[156:159]
    v_mfma_f32_16x16x32_bf16 v[212:215], v[100:103], v[44:47], v[212:215]
    s_waitcnt lgkmcnt(0)
    v_mfma_f32_16x16x32_bf16 v[104:107], v[48:51], v[32:35], v[104:107]
    ds_read_b64_tr_b16 v[76:77], v12 offset:8192
    ds_read_b64_tr_b16 v[78:79], v12 offset:8448
    v_mfma_f32_16x16x32_bf16 v[160:163], v[48:51], v[36:39], v[160:163]
    ds_read_b64_tr_b16 v[80:81], v13 offset:8192
    ds_read_b64_tr_b16 v[82:83], v13 offset:8448
    v_mfma_f32_16x16x32_bf16 v[108:111], v[52:55], v[32:35], v[108:111]
    ds_read_b64_tr_b16 v[84:85], v12 offset:10240
    ds_read_b64_tr_b16 v[86:87], v12 offset:10496
    v_mfma_f32_16x16x32_bf16 v[164:167], v[52:55], v[36:39], v[164:167]
    ds_read_b64_tr_b16 v[88:89], v13 offset:10240
    ds_read_b64_tr_b16 v[90:91], v13 offset:10496
    v_mfma_f32_16x16x32_bf16 v[112:115], v[56:59], v[32:35], v[112:115]
    ds_read_b64_tr_b16 v[92:93], v12 offset:12288
    ds_read_b64_tr_b16 v[94:95], v12 offset:12544
    v_mfma_f32_16x16x32_bf16 v[168:171], v[56:59], v[36:39], v[168:171]
    ds_read_b64_tr_b16 v[96:97], v13 offset:12288
    ds_read_b64_tr_b16 v[98:99], v13 offset:12544
    v_mfma_f32_16x16x32_bf16 v[116:119], v[60:63], v[32:35], v[116:119]
    ds_read_b64_tr_b16 v[100:101], v12 offset:14336
    ds_read_b64_tr_b16 v[102:103], v12 offset:14592
    v_mfma_f32_16x16x32_bf16 v[172:175], v[60:63], v[36:39], v[172:175]
    v_mfma_f32_16x16x32_bf16 v[120:123], v[64:67], v[32:35], v[120:123]
    v_mfma_f32_16x16x32_bf16 v[176:179], v[64:67], v[36:39], v[176:179]
    v_mfma_f32_16x16x32_bf16 v[124:127], v[68:71], v[32:35], v[124:127]
    v_mfma_f32_16x16x32_bf16 v[180:183], v[68:71], v[36:39], v[180:183]
    v_mfma_f32_16x16x32_bf16 v[128:131], v[72:75], v[32:35], v[128:131]
    v_mfma_f32_16x16x32_bf16 v[184:187], v[72:75], v[36:39], v[184:187]
    s_waitcnt lgkmcnt(0)
    s_barrier
    v_mfma_f32_16x16x32_bf16 v[132:135], v[76:79], v[32:35], v[132:135]
    ds_read_b128 v[40:43], v15 offset:24576
    ds_read_b128 v[44:47], v15 offset:25600
    v_mfma_f32_16x16x32_bf16 v[188:191], v[76:79], v[36:39], v[188:191]
    ds_read_b64_tr_b16 v[48:49], v12 offset:24576
    ds_read_b64_tr_b16 v[50:51], v12 offset:24832
    v_mfma_f32_16x16x32_bf16 v[136:139], v[80:83], v[32:35], v[136:139]
    ds_read_b64_tr_b16 v[52:53], v13 offset:24576
    ds_read_b64_tr_b16 v[54:55], v13 offset:24832
    v_mfma_f32_16x16x32_bf16 v[192:195], v[80:83], v[36:39], v[192:195]
    ds_read_b64_tr_b16 v[56:57], v12 offset:26624
    ds_read_b64_tr_b16 v[58:59], v12 offset:26880
    v_mfma_f32_16x16x32_bf16 v[140:143], v[84:87], v[32:35], v[140:143]
    ds_read_b64_tr_b16 v[60:61], v13 offset:26624
    ds_read_b64_tr_b16 v[62:63], v13 offset:26880
    v_mfma_f32_16x16x32_bf16 v[196:199], v[84:87], v[36:39], v[196:199]
    ds_read_b64_tr_b16 v[64:65], v12 offset:28672
    ds_read_b64_tr_b16 v[66:67], v12 offset:28928
    v_mfma_f32_16x16x32_bf16 v[144:147], v[88:91], v[32:35], v[144:147]
    ds_read_b64_tr_b16 v[68:69], v13 offset:28672
    ds_read_b64_tr_b16 v[70:71], v13 offset:28928
    v_mfma_f32_16x16x32_bf16 v[200:203], v[88:91], v[36:39], v[200:203]
    ds_read_b64_tr_b16 v[72:73], v12 offset:30720
    ds_read_b64_tr_b16 v[74:75], v12 offset:30976
    v_mfma_f32_16x16x32_bf16 v[148:151], v[92:95], v[32:35], v[148:151]
    v_mfma_f32_16x16x32_bf16 v[204:207], v[92:95], v[36:39], v[204:207]
    v_mfma_f32_16x16x32_bf16 v[152:155], v[96:99], v[32:35], v[152:155]
    v_mfma_f32_16x16x32_bf16 v[208:211], v[96:99], v[36:39], v[208:211]
    v_mfma_f32_16x16x32_bf16 v[156:159], v[100:103], v[32:35], v[156:159]
    v_mfma_f32_16x16x32_bf16 v[212:215], v[100:103], v[36:39], v[212:215]
    s_waitcnt lgkmcnt(0)
    v_mfma_f32_16x16x32_bf16 v[104:107], v[48:51], v[40:43], v[104:107]
    ds_read_b64_tr_b16 v[76:77], v12 offset:32768
    ds_read_b64_tr_b16 v[78:79], v12 offset:33024
    v_mfma_f32_16x16x32_bf16 v[160:163], v[48:51], v[44:47], v[160:163]
    ds_read_b64_tr_b16 v[80:81], v13 offset:32768
    ds_read_b64_tr_b16 v[82:83], v13 offset:33024
    v_mfma_f32_16x16x32_bf16 v[108:111], v[52:55], v[40:43], v[108:111]
    ds_read_b64_tr_b16 v[84:85], v12 offset:34816
    ds_read_b64_tr_b16 v[86:87], v12 offset:35072
    v_mfma_f32_16x16x32_bf16 v[164:167], v[52:55], v[44:47], v[164:167]
    ds_read_b64_tr_b16 v[88:89], v13 offset:34816
    ds_read_b64_tr_b16 v[90:91], v13 offset:35072
    v_mfma_f32_16x16x32_bf16 v[112:115], v[56:59], v[40:43], v[112:115]
    ds_read_b64_tr_b16 v[92:93], v12 offset:36864
    ds_read_b64_tr_b16 v[94:95], v12 offset:37120
    v_mfma_f32_16x16x32_bf16 v[168:171], v[56:59], v[44:47], v[168:171]
    ds_read_b64_tr_b16 v[96:97], v13 offset:36864
    ds_read_b64_tr_b16 v[98:99], v13 offset:37120
    v_mfma_f32_16x16x32_bf16 v[116:119], v[60:63], v[40:43], v[116:119]
    ds_read_b64_tr_b16 v[100:101], v12 offset:38912
    ds_read_b64_tr_b16 v[102:103], v12 offset:39168
    v_mfma_f32_16x16x32_bf16 v[172:175], v[60:63], v[44:47], v[172:175]
    v_mfma_f32_16x16x32_bf16 v[120:123], v[64:67], v[40:43], v[120:123]
    v_mfma_f32_16x16x32_bf16 v[176:179], v[64:67], v[44:47], v[176:179]
    v_mfma_f32_16x16x32_bf16 v[124:127], v[68:71], v[40:43], v[124:127]
    v_mfma_f32_16x16x32_bf16 v[180:183], v[68:71], v[44:47], v[180:183]
    v_mfma_f32_16x16x32_bf16 v[128:131], v[72:75], v[40:43], v[128:131]
    v_mfma_f32_16x16x32_bf16 v[184:187], v[72:75], v[44:47], v[184:187]
    s_waitcnt lgkmcnt(0)
    s_barrier
    v_mfma_f32_16x16x32_bf16 v[132:135], v[76:79], v[40:43], v[132:135]
    ds_read_b128 v[32:35], v15 offset:49152
    ds_read_b128 v[36:39], v15 offset:50176
    v_mfma_f32_16x16x32_bf16 v[188:191], v[76:79], v[44:47], v[188:191]
    ds_read_b64_tr_b16 v[48:49], v12 offset:49152
    ds_read_b64_tr_b16 v[50:51], v12 offset:49408
    v_mfma_f32_16x16x32_bf16 v[136:139], v[80:83], v[40:43], v[136:139]
    ds_read_b64_tr_b16 v[52:53], v13 offset:49152
    ds_read_b64_tr_b16 v[54:55], v13 offset:49408
    v_mfma_f32_16x16x32_bf16 v[192:195], v[80:83], v[44:47], v[192:195]
    ds_read_b64_tr_b16 v[56:57], v12 offset:51200
    ds_read_b64_tr_b16 v[58:59], v12 offset:51456
    v_mfma_f32_16x16x32_bf16 v[140:143], v[84:87], v[40:43], v[140:143]
    ds_read_b64_tr_b16 v[60:61], v13 offset:51200
    ds_read_b64_tr_b16 v[62:63], v13 offset:51456
    v_mfma_f32_16x16x32_bf16 v[196:199], v[84:87], v[44:47], v[196:199]
    ds_read_b64_tr_b16 v[64:65], v12 offset:53248
    ds_read_b64_tr_b16 v[66:67], v12 offset:53504
    v_mfma_f32_16x16x32_bf16 v[144:147], v[88:91], v[40:43], v[144:147]
    ds_read_b64_tr_b16 v[68:69], v13 offset:53248
    ds_read_b64_tr_b16 v[70:71], v13 offset:53504
    v_mfma_f32_16x16x32_bf16 v[200:203], v[88:91], v[44:47], v[200:203]
    ds_read_b64_tr_b16 v[72:73], v12 offset:55296
    ds_read_b64_tr_b16 v[74:75], v12 offset:55552
    v_mfma_f32_16x16x32_bf16 v[148:151], v[92:95], v[40:43], v[148:151]
    v_mfma_f32_16x16x32_bf16 v[204:207], v[92:95], v[44:47], v[204:207]
    v_mfma_f32_16x16x32_bf16 v[152:155], v[96:99], v[40:43], v[152:155]
    v_mfma_f32_16x16x32_bf16 v[208:211], v[96:99], v[44:47], v[208:211]
    v_mfma_f32_16x16x32_bf16 v[156:159], v[100:103], v[40:43], v[156:159]
    v_mfma_f32_16x16x32_bf16 v[212:215], v[100:103], v[44:47], v[212:215]
    s_waitcnt lgkmcnt(0)
    v_mfma_f32_16x16x32_bf16 v[104:107], v[48:51], v[32:35], v[104:107]
    ds_read_b64_tr_b16 v[76:77], v12 offset:57344
    ds_read_b64_tr_b16 v[78:79], v12 offset:57600
    v_mfma_f32_16x16x32_bf16 v[160:163], v[48:51], v[36:39], v[160:163]
    ds_read_b64_tr_b16 v[80:81], v13 offset:57344
    ds_read_b64_tr_b16 v[82:83], v13 offset:57600
    v_mfma_f32_16x16x32_bf16 v[108:111], v[52:55], v[32:35], v[108:111]
    ds_read_b64_tr_b16 v[84:85], v12 offset:59392
    ds_read_b64_tr_b16 v[86:87], v12 offset:59648
    v_mfma_f32_16x16x32_bf16 v[164:167], v[52:55], v[36:39], v[164:167]
    ds_read_b64_tr_b16 v[88:89], v13 offset:59392
    ds_read_b64_tr_b16 v[90:91], v13 offset:59648
    v_mfma_f32_16x16x32_bf16 v[112:115], v[56:59], v[32:35], v[112:115]
    ds_read_b64_tr_b16 v[92:93], v12 offset:61440
    ds_read_b64_tr_b16 v[94:95], v12 offset:61696
    v_mfma_f32_16x16x32_bf16 v[168:171], v[56:59], v[36:39], v[168:171]
    ds_read_b64_tr_b16 v[96:97], v13 offset:61440
    ds_read_b64_tr_b16 v[98:99], v13 offset:61696
    v_mfma_f32_16x16x32_bf16 v[116:119], v[60:63], v[32:35], v[116:119]
    ds_read_b64_tr_b16 v[100:101], v12 offset:63488
    ds_read_b64_tr_b16 v[102:103], v12 offset:63744
    v_mfma_f32_16x16x32_bf16 v[172:175], v[60:63], v[36:39], v[172:175]
    v_mfma_f32_16x16x32_bf16 v[120:123], v[64:67], v[32:35], v[120:123]
    v_mfma_f32_16x16x32_bf16 v[176:179], v[64:67], v[36:39], v[176:179]
    v_mfma_f32_16x16x32_bf16 v[124:127], v[68:71], v[32:35], v[124:127]
    v_mfma_f32_16x16x32_bf16 v[180:183], v[68:71], v[36:39], v[180:183]
    v_mfma_f32_16x16x32_bf16 v[128:131], v[72:75], v[32:35], v[128:131]
    v_mfma_f32_16x16x32_bf16 v[184:187], v[72:75], v[36:39], v[184:187]
    s_waitcnt lgkmcnt(0)
    s_barrier
    v_mfma_f32_16x16x32_bf16 v[132:135], v[76:79], v[32:35], v[132:135]
    ds_read_b128 v[40:43], v14 offset:0
    ds_read_b128 v[44:47], v14 offset:1024
    v_mfma_f32_16x16x32_bf16 v[188:191], v[76:79], v[36:39], v[188:191]
    ds_read_b64_tr_b16 v[48:49], v10 offset:0
    ds_read_b64_tr_b16 v[50:51], v10 offset:256
    v_mfma_f32_16x16x32_bf16 v[136:139], v[80:83], v[32:35], v[136:139]
    ds_read_b64_tr_b16 v[52:53], v11 offset:0
    ds_read_b64_tr_b16 v[54:55], v11 offset:256
    v_mfma_f32_16x16x32_bf16 v[192:195], v[80:83], v[36:39], v[192:195]
    ds_read_b64_tr_b16 v[56:57], v10 offset:2048
    ds_read_b64_tr_b16 v[58:59], v10 offset:2304
    v_mfma_f32_16x16x32_bf16 v[140:143], v[84:87], v[32:35], v[140:143]
    ds_read_b64_tr_b16 v[60:61], v11 offset:2048
    ds_read_b64_tr_b16 v[62:63], v11 offset:2304
    v_mfma_f32_16x16x32_bf16 v[196:199], v[84:87], v[36:39], v[196:199]
    ds_read_b64_tr_b16 v[64:65], v10 offset:4096
    ds_read_b64_tr_b16 v[66:67], v10 offset:4352
    v_mfma_f32_16x16x32_bf16 v[144:147], v[88:91], v[32:35], v[144:147]
    ds_read_b64_tr_b16 v[68:69], v11 offset:4096
    ds_read_b64_tr_b16 v[70:71], v11 offset:4352
    v_mfma_f32_16x16x32_bf16 v[200:203], v[88:91], v[36:39], v[200:203]
    ds_read_b64_tr_b16 v[72:73], v10 offset:6144
    ds_read_b64_tr_b16 v[74:75], v10 offset:6400
    v_mfma_f32_16x16x32_bf16 v[148:151], v[92:95], v[32:35], v[148:151]
    v_mfma_f32_16x16x32_bf16 v[204:207], v[92:95], v[36:39], v[204:207]
    v_mfma_f32_16x16x32_bf16 v[152:155], v[96:99], v[32:35], v[152:155]
    v_mfma_f32_16x16x32_bf16 v[208:211], v[96:99], v[36:39], v[208:211]
    v_mfma_f32_16x16x32_bf16 v[156:159], v[100:103], v[32:35], v[156:159]
    v_mfma_f32_16x16x32_bf16 v[212:215], v[100:103], v[36:39], v[212:215]
    s_waitcnt lgkmcnt(0)
    v_mfma_f32_16x16x32_bf16 v[104:107], v[48:51], v[40:43], v[104:107]
    ds_read_b64_tr_b16 v[76:77], v10 offset:8192
    ds_read_b64_tr_b16 v[78:79], v10 offset:8448
    v_mfma_f32_16x16x32_bf16 v[160:163], v[48:51], v[44:47], v[160:163]
    ds_read_b64_tr_b16 v[80:81], v11 offset:8192
    ds_read_b64_tr_b16 v[82:83], v11 offset:8448
    v_mfma_f32_16x16x32_bf16 v[108:111], v[52:55], v[40:43], v[108:111]
    ds_read_b64_tr_b16 v[84:85], v10 offset:10240
    ds_read_b64_tr_b16 v[86:87], v10 offset:10496
    v_mfma_f32_16x16x32_bf16 v[164:167], v[52:55], v[44:47], v[164:167]
    ds_read_b64_tr_b16 v[88:89], v11 offset:10240
    ds_read_b64_tr_b16 v[90:91], v11 offset:10496
    v_mfma_f32_16x16x32_bf16 v[112:115], v[56:59], v[40:43], v[112:115]
    ds_read_b64_tr_b16 v[92:93], v10 offset:12288
    ds_read_b64_tr_b16 v[94:95], v10 offset:12544
    v_mfma_f32_16x16x32_bf16 v[168:171], v[56:59], v[44:47], v[168:171]
    ds_read_b64_tr_b16 v[96:97], v11 offset:12288
    ds_read_b64_tr_b16 v[98:99], v11 offset:12544
    v_mfma_f32_16x16x32_bf16 v[116:119], v[60:63], v[40:43], v[116:119]
    ds_read_b64_tr_b16 v[100:101], v10 offset:14336
    ds_read_b64_tr_b16 v[102:103], v10 offset:14592
    v_mfma_f32_16x16x32_bf16 v[172:175], v[60:63], v[44:47], v[172:175]
    v_mfma_f32_16x16x32_bf16 v[120:123], v[64:67], v[40:43], v[120:123]
    v_mfma_f32_16x16x32_bf16 v[176:179], v[64:67], v[44:47], v[176:179]
    v_mfma_f32_16x16x32_bf16 v[124:127], v[68:71], v[40:43], v[124:127]
    v_mfma_f32_16x16x32_bf16 v[180:183], v[68:71], v[44:47], v[180:183]
    v_mfma_f32_16x16x32_bf16 v[128:131], v[72:75], v[40:43], v[128:131]
    v_mfma_f32_16x16x32_bf16 v[184:187], v[72:75], v[44:47], v[184:187]
    s_waitcnt lgkmcnt(0)
    v_mfma_f32_16x16x32_bf16 v[132:135], v[76:79], v[40:43], v[132:135]
    v_mfma_f32_16x16x32_bf16 v[188:191], v[76:79], v[44:47], v[188:191]
    v_mfma_f32_16x16x32_bf16 v[136:139], v[80:83], v[40:43], v[136:139]
    v_mfma_f32_16x16x32_bf16 v[192:195], v[80:83], v[44:47], v[192:195]
    v_mfma_f32_16x16x32_bf16 v[140:143], v[84:87], v[40:43], v[140:143]
    v_mfma_f32_16x16x32_bf16 v[196:199], v[84:87], v[44:47], v[196:199]
    v_mfma_f32_16x16x32_bf16 v[144:147], v[88:91], v[40:43], v[144:147]
    v_mfma_f32_16x16x32_bf16 v[200:203], v[88:91], v[44:47], v[200:203]
    v_mfma_f32_16x16x32_bf16 v[148:151], v[92:95], v[40:43], v[148:151]
    v_mfma_f32_16x16x32_bf16 v[204:207], v[92:95], v[44:47], v[204:207]
    v_mfma_f32_16x16x32_bf16 v[152:155], v[96:99], v[40:43], v[152:155]
    v_mfma_f32_16x16x32_bf16 v[208:211], v[96:99], v[44:47], v[208:211]
    v_mfma_f32_16x16x32_bf16 v[156:159], v[100:103], v[40:43], v[156:159]
    v_mfma_f32_16x16x32_bf16 v[212:215], v[100:103], v[44:47], v[212:215]
    s_waitcnt vmcnt(0)
    s_barrier
    ds_read_b128 v[48:51], v17 offset:0
    ds_read_b128 v[52:55], v17 offset:64
    ds_read_b128 v[56:59], v17 offset:128
    ds_read_b128 v[60:63], v17 offset:192
    ds_read_b128 v[64:67], v17 offset:256
    ds_read_b128 v[68:71], v17 offset:320
    ds_read_b128 v[72:75], v17 offset:384
    ds_read_b128 v[76:79], v17 offset:448
    ds_read_b128 v[80:83], v17 offset:512
    ds_read_b128 v[84:87], v17 offset:576
    ds_read_b128 v[88:91], v17 offset:640
    ds_read_b128 v[92:95], v17 offset:704
    ds_read_b128 v[96:99], v17 offset:768
    ds_read_b128 v[100:103], v17 offset:832
    s_waitcnt lgkmcnt(0)
    s_add_u32 s29, s25, 0
    v_pk_fma_f32 v[104:105], v[48:49], v[26:27], v[104:105] op_sel:[0,0,0] op_sel_hi:[1,0,1] neg_lo:[0,1,0] neg_hi:[0,1,0]
    v_pk_fma_f32 v[106:107], v[50:51], v[26:27], v[106:107] op_sel:[0,0,0] op_sel_hi:[1,0,1] neg_lo:[0,1,0] neg_hi:[0,1,0]
    v_pk_mul_f32 v[224:225], v[104:105], v[28:29] op_sel:[0,0] op_sel_hi:[1,0]
    v_pk_mul_f32 v[226:227], v[106:107], v[28:29] op_sel:[0,0] op_sel_hi:[1,0]
    v_exp_f32 v224, v224
    v_exp_f32 v225, v225
    v_exp_f32 v226, v226
    v_exp_f32 v227, v227
    v_pk_fma_f32 v[132:133], v[76:77], v[26:27], v[132:133] op_sel:[0,0,0] op_sel_hi:[1,0,1] neg_lo:[0,1,0] neg_hi:[0,1,0]
    v_pk_fma_f32 v[134:135], v[78:79], v[26:27], v[134:135] op_sel:[0,0,0] op_sel_hi:[1,0,1] neg_lo:[0,1,0] neg_hi:[0,1,0]
    v_pk_fma_f32 v[224:225], v[224:225], v[30:31], v[30:31] op_sel:[0,0,0] op_sel_hi:[1,0,0]
    v_pk_fma_f32 v[226:227], v[226:227], v[30:31], v[30:31] op_sel:[0,0,0] op_sel_hi:[1,0,0]
    v_rcp_f32 v224, v224
    v_rcp_f32 v225, v225
    v_rcp_f32 v226, v226
    v_rcp_f32 v227, v227
    v_pk_mul_f32 v[104:105], v[104:105], v[132:133]
    v_pk_mul_f32 v[106:107], v[106:107], v[134:135]
    v_pk_mul_f32 v[104:105], v[104:105], v[224:225]
    v_pk_mul_f32 v[106:107], v[106:107], v[226:227]
    v_cvt_pk_bf16_f32 v228, v104, v105
    v_cvt_pk_bf16_f32 v229, v106, v107
    buffer_store_dwordx2 v[228:229], v9, s[4:7], s29 offen offset:0 sc1
    v_pk_fma_f32 v[160:161], v[48:49], v[26:27], v[160:161] op_sel:[0,1,0] op_sel_hi:[1,1,1] neg_lo:[0,1,0] neg_hi:[0,1,0]
    v_pk_fma_f32 v[162:163], v[50:51], v[26:27], v[162:163] op_sel:[0,1,0] op_sel_hi:[1,1,1] neg_lo:[0,1,0] neg_hi:[0,1,0]
    v_pk_mul_f32 v[232:233], v[160:161], v[28:29] op_sel:[0,1] op_sel_hi:[1,1]
    v_pk_mul_f32 v[234:235], v[162:163], v[28:29] op_sel:[0,1] op_sel_hi:[1,1]
    v_exp_f32 v232, v232
    v_exp_f32 v233, v233
    v_exp_f32 v234, v234
    v_exp_f32 v235, v235
    v_pk_fma_f32 v[188:189], v[76:77], v[26:27], v[188:189] op_sel:[0,1,0] op_sel_hi:[1,1,1] neg_lo:[0,1,0] neg_hi:[0,1,0]
    v_pk_fma_f32 v[190:191], v[78:79], v[26:27], v[190:191] op_sel:[0,1,0] op_sel_hi:[1,1,1] neg_lo:[0,1,0] neg_hi:[0,1,0]
    v_pk_fma_f32 v[232:233], v[232:233], v[30:31], v[30:31] op_sel:[0,1,1] op_sel_hi:[1,1,1]
    v_pk_fma_f32 v[234:235], v[234:235], v[30:31], v[30:31] op_sel:[0,1,1] op_sel_hi:[1,1,1]
    v_rcp_f32 v232, v232
    v_rcp_f32 v233, v233
    v_rcp_f32 v234, v234
    v_rcp_f32 v235, v235
    v_pk_mul_f32 v[160:161], v[160:161], v[188:189]
    v_pk_mul_f32 v[162:163], v[162:163], v[190:191]
    v_pk_mul_f32 v[160:161], v[160:161], v[232:233]
    v_pk_mul_f32 v[162:163], v[162:163], v[234:235]
    v_cvt_pk_bf16_f32 v236, v160, v161
    v_cvt_pk_bf16_f32 v237, v162, v163
    buffer_store_dwordx2 v[236:237], v9, s[4:7], s29 offen offset:256 sc1
    s_add_u32 s29, s25, 1024
    v_pk_fma_f32 v[108:109], v[52:53], v[26:27], v[108:109] op_sel:[0,0,0] op_sel_hi:[1,0,1] neg_lo:[0,1,0] neg_hi:[0,1,0]
    v_pk_fma_f32 v[110:111], v[54:55], v[26:27], v[110:111] op_sel:[0,0,0] op_sel_hi:[1,0,1] neg_lo:[0,1,0] neg_hi:[0,1,0]
    v_pk_mul_f32 v[240:241], v[108:109], v[28:29] op_sel:[0,0] op_sel_hi:[1,0]
    v_pk_mul_f32 v[242:243], v[110:111], v[28:29] op_sel:[0,0] op_sel_hi:[1,0]
    v_exp_f32 v240, v240
    v_exp_f32 v241, v241
    v_exp_f32 v242, v242
    v_exp_f32 v243, v243
    v_pk_fma_f32 v[136:137], v[80:81], v[26:27], v[136:137] op_sel:[0,0,0] op_sel_hi:[1,0,1] neg_lo:[0,1,0] neg_hi:[0,1,0]
    v_pk_fma_f32 v[138:139], v[82:83], v[26:27], v[138:139] op_sel:[0,0,0] op_sel_hi:[1,0,1] neg_lo:[0,1,0] neg_hi:[0,1,0]
    v_pk_fma_f32 v[240:241], v[240:241], v[30:31], v[30:31] op_sel:[0,0,0] op_sel_hi:[1,0,0]
    v_pk_fma_f32 v[242:243], v[242:243], v[30:31], v[30:31] op_sel:[0,0,0] op_sel_hi:[1,0,0]
    v_rcp_f32 v240, v240
    v_rcp_f32 v241, v241
    v_rcp_f32 v242, v242
    v_rcp_f32 v243, v243
    v_pk_mul_f32 v[108:109], v[108:109], v[136:137]
    v_pk_mul_f32 v[110:111], v[110:111], v[138:139]
    v_pk_mul_f32 v[108:109], v[108:109], v[240:241]
    v_pk_mul_f32 v[110:111], v[110:111], v[242:243]
    v_cvt_pk_bf16_f32 v244, v108, v109
    v_cvt_pk_bf16_f32 v245, v110, v111
    buffer_store_dwordx2 v[244:245], v9, s[4:7], s29 offen offset:0 sc1
    v_pk_fma_f32 v[164:165], v[52:53], v[26:27], v[164:165] op_sel:[0,1,0] op_sel_hi:[1,1,1] neg_lo:[0,1,0] neg_hi:[0,1,0]
    v_pk_fma_f32 v[166:167], v[54:55], v[26:27], v[166:167] op_sel:[0,1,0] op_sel_hi:[1,1,1] neg_lo:[0,1,0] neg_hi:[0,1,0]
    v_pk_mul_f32 v[248:249], v[164:165], v[28:29] op_sel:[0,1] op_sel_hi:[1,1]
    v_pk_mul_f32 v[250:251], v[166:167], v[28:29] op_sel:[0,1] op_sel_hi:[1,1]
    v_exp_f32 v248, v248
    v_exp_f32 v249, v249
    v_exp_f32 v250, v250
    v_exp_f32 v251, v251
    v_pk_fma_f32 v[192:193], v[80:81], v[26:27], v[192:193] op_sel:[0,1,0] op_sel_hi:[1,1,1] neg_lo:[0,1,0] neg_hi:[0,1,0]
    v_pk_fma_f32 v[194:195], v[82:83], v[26:27], v[194:195] op_sel:[0,1,0] op_sel_hi:[1,1,1] neg_lo:[0,1,0] neg_hi:[0,1,0]
    v_pk_fma_f32 v[248:249], v[248:249], v[30:31], v[30:31] op_sel:[0,1,1] op_sel_hi:[1,1,1]
    v_pk_fma_f32 v[250:251], v[250:251], v[30:31], v[30:31] op_sel:[0,1,1] op_sel_hi:[1,1,1]
    v_rcp_f32 v248, v248
    v_rcp_f32 v249, v249
    v_rcp_f32 v250, v250
    v_rcp_f32 v251, v251
    v_pk_mul_f32 v[164:165], v[164:165], v[192:193]
    v_pk_mul_f32 v[166:167], v[166:167], v[194:195]
    v_pk_mul_f32 v[164:165], v[164:165], v[248:249]
    v_pk_mul_f32 v[166:167], v[166:167], v[250:251]
    v_cvt_pk_bf16_f32 v252, v164, v165
    v_cvt_pk_bf16_f32 v253, v166, v167
    buffer_store_dwordx2 v[252:253], v9, s[4:7], s29 offen offset:256 sc1
    s_add_u32 s29, s25, 2048
    v_pk_fma_f32 v[112:113], v[56:57], v[26:27], v[112:113] op_sel:[0,0,0] op_sel_hi:[1,0,1] neg_lo:[0,1,0] neg_hi:[0,1,0]
    v_pk_fma_f32 v[114:115], v[58:59], v[26:27], v[114:115] op_sel:[0,0,0] op_sel_hi:[1,0,1] neg_lo:[0,1,0] neg_hi:[0,1,0]
    v_pk_mul_f32 v[224:225], v[112:113], v[28:29] op_sel:[0,0] op_sel_hi:[1,0]
    v_pk_mul_f32 v[226:227], v[114:115], v[28:29] op_sel:[0,0] op_sel_hi:[1,0]
    v_exp_f32 v224, v224
    v_exp_f32 v225, v225
    v_exp_f32 v226, v226
    v_exp_f32 v227, v227
    v_pk_fma_f32 v[140:141], v[84:85], v[26:27], v[140:141] op_sel:[0,0,0] op_sel_hi:[1,0,1] neg_lo:[0,1,0] neg_hi:[0,1,0]
    v_pk_fma_f32 v[142:143], v[86:87], v[26:27], v[142:143] op_sel:[0,0,0] op_sel_hi:[1,0,1] neg_lo:[0,1,0] neg_hi:[0,1,0]
    v_pk_fma_f32 v[224:225], v[224:225], v[30:31], v[30:31] op_sel:[0,0,0] op_sel_hi:[1,0,0]
    v_pk_fma_f32 v[226:227], v[226:227], v[30:31], v[30:31] op_sel:[0,0,0] op_sel_hi:[1,0,0]
    v_rcp_f32 v224, v224
    v_rcp_f32 v225, v225
    v_rcp_f32 v226, v226
    v_rcp_f32 v227, v227
    v_pk_mul_f32 v[112:113], v[112:113], v[140:141]
    v_pk_mul_f32 v[114:115], v[114:115], v[142:143]
    v_pk_mul_f32 v[112:113], v[112:113], v[224:225]
    v_pk_mul_f32 v[114:115], v[114:115], v[226:227]
    v_cvt_pk_bf16_f32 v228, v112, v113
    v_cvt_pk_bf16_f32 v229, v114, v115
    buffer_store_dwordx2 v[228:229], v9, s[4:7], s29 offen offset:0 sc1
    v_pk_fma_f32 v[168:169], v[56:57], v[26:27], v[168:169] op_sel:[0,1,0] op_sel_hi:[1,1,1] neg_lo:[0,1,0] neg_hi:[0,1,0]
    v_pk_fma_f32 v[170:171], v[58:59], v[26:27], v[170:171] op_sel:[0,1,0] op_sel_hi:[1,1,1] neg_lo:[0,1,0] neg_hi:[0,1,0]
    v_pk_mul_f32 v[232:233], v[168:169], v[28:29] op_sel:[0,1] op_sel_hi:[1,1]
    v_pk_mul_f32 v[234:235], v[170:171], v[28:29] op_sel:[0,1] op_sel_hi:[1,1]
    v_exp_f32 v232, v232
    v_exp_f32 v233, v233
    v_exp_f32 v234, v234
    v_exp_f32 v235, v235
    v_pk_fma_f32 v[196:197], v[84:85], v[26:27], v[196:197] op_sel:[0,1,0] op_sel_hi:[1,1,1] neg_lo:[0,1,0] neg_hi:[0,1,0]
    v_pk_fma_f32 v[198:199], v[86:87], v[26:27], v[198:199] op_sel:[0,1,0] op_sel_hi:[1,1,1] neg_lo:[0,1,0] neg_hi:[0,1,0]
    v_pk_fma_f32 v[232:233], v[232:233], v[30:31], v[30:31] op_sel:[0,1,1] op_sel_hi:[1,1,1]
    v_pk_fma_f32 v[234:235], v[234:235], v[30:31], v[30:31] op_sel:[0,1,1] op_sel_hi:[1,1,1]
    v_rcp_f32 v232, v232
    v_rcp_f32 v233, v233
    v_rcp_f32 v234, v234
    v_rcp_f32 v235, v235
    v_pk_mul_f32 v[168:169], v[168:169], v[196:197]
    v_pk_mul_f32 v[170:171], v[170:171], v[198:199]
    v_pk_mul_f32 v[168:169], v[168:169], v[232:233]
    v_pk_mul_f32 v[170:171], v[170:171], v[234:235]
    v_cvt_pk_bf16_f32 v236, v168, v169
    v_cvt_pk_bf16_f32 v237, v170, v171
    buffer_store_dwordx2 v[236:237], v9, s[4:7], s29 offen offset:256 sc1
    s_add_u32 s29, s25, 3072
    v_pk_fma_f32 v[116:117], v[60:61], v[26:27], v[116:117] op_sel:[0,0,0] op_sel_hi:[1,0,1] neg_lo:[0,1,0] neg_hi:[0,1,0]
    v_pk_fma_f32 v[118:119], v[62:63], v[26:27], v[118:119] op_sel:[0,0,0] op_sel_hi:[1,0,1] neg_lo:[0,1,0] neg_hi:[0,1,0]
    v_pk_mul_f32 v[240:241], v[116:117], v[28:29] op_sel:[0,0] op_sel_hi:[1,0]
    v_pk_mul_f32 v[242:243], v[118:119], v[28:29] op_sel:[0,0] op_sel_hi:[1,0]
    v_exp_f32 v240, v240
    v_exp_f32 v241, v241
    v_exp_f32 v242, v242
    v_exp_f32 v243, v243
    v_pk_fma_f32 v[144:145], v[88:89], v[26:27], v[144:145] op_sel:[0,0,0] op_sel_hi:[1,0,1] neg_lo:[0,1,0] neg_hi:[0,1,0]
    v_pk_fma_f32 v[146:147], v[90:91], v[26:27], v[146:147] op_sel:[0,0,0] op_sel_hi:[1,0,1] neg_lo:[0,1,0] neg_hi:[0,1,0]
    v_pk_fma_f32 v[240:241], v[240:241], v[30:31], v[30:31] op_sel:[0,0,0] op_sel_hi:[1,0,0]
    v_pk_fma_f32 v[242:243], v[242:243], v[30:31], v[30:31] op_sel:[0,0,0] op_sel_hi:[1,0,0]
    v_rcp_f32 v240, v240
    v_rcp_f32 v241, v241
    v_rcp_f32 v242, v242
    v_rcp_f32 v243, v243
    v_pk_mul_f32 v[116:117], v[116:117], v[144:145]
    v_pk_mul_f32 v[118:119], v[118:119], v[146:147]
    v_pk_mul_f32 v[116:117], v[116:117], v[240:241]
    v_pk_mul_f32 v[118:119], v[118:119], v[242:243]
    v_cvt_pk_bf16_f32 v244, v116, v117
    v_cvt_pk_bf16_f32 v245, v118, v119
    buffer_store_dwordx2 v[244:245], v9, s[4:7], s29 offen offset:0 sc1
    v_pk_fma_f32 v[172:173], v[60:61], v[26:27], v[172:173] op_sel:[0,1,0] op_sel_hi:[1,1,1] neg_lo:[0,1,0] neg_hi:[0,1,0]
    v_pk_fma_f32 v[174:175], v[62:63], v[26:27], v[174:175] op_sel:[0,1,0] op_sel_hi:[1,1,1] neg_lo:[0,1,0] neg_hi:[0,1,0]
    v_pk_mul_f32 v[248:249], v[172:173], v[28:29] op_sel:[0,1] op_sel_hi:[1,1]
    v_pk_mul_f32 v[250:251], v[174:175], v[28:29] op_sel:[0,1] op_sel_hi:[1,1]
    v_exp_f32 v248, v248
    v_exp_f32 v249, v249
    v_exp_f32 v250, v250
    v_exp_f32 v251, v251
    v_pk_fma_f32 v[200:201], v[88:89], v[26:27], v[200:201] op_sel:[0,1,0] op_sel_hi:[1,1,1] neg_lo:[0,1,0] neg_hi:[0,1,0]
    v_pk_fma_f32 v[202:203], v[90:91], v[26:27], v[202:203] op_sel:[0,1,0] op_sel_hi:[1,1,1] neg_lo:[0,1,0] neg_hi:[0,1,0]
    v_pk_fma_f32 v[248:249], v[248:249], v[30:31], v[30:31] op_sel:[0,1,1] op_sel_hi:[1,1,1]
    v_pk_fma_f32 v[250:251], v[250:251], v[30:31], v[30:31] op_sel:[0,1,1] op_sel_hi:[1,1,1]
    v_rcp_f32 v248, v248
    v_rcp_f32 v249, v249
    v_rcp_f32 v250, v250
    v_rcp_f32 v251, v251
    v_pk_mul_f32 v[172:173], v[172:173], v[200:201]
    v_pk_mul_f32 v[174:175], v[174:175], v[202:203]
    v_pk_mul_f32 v[172:173], v[172:173], v[248:249]
    v_pk_mul_f32 v[174:175], v[174:175], v[250:251]
    v_cvt_pk_bf16_f32 v252, v172, v173
    v_cvt_pk_bf16_f32 v253, v174, v175
    buffer_store_dwordx2 v[252:253], v9, s[4:7], s29 offen offset:256 sc1
    s_add_u32 s29, s25, 4096
    v_pk_fma_f32 v[120:121], v[64:65], v[26:27], v[120:121] op_sel:[0,0,0] op_sel_hi:[1,0,1] neg_lo:[0,1,0] neg_hi:[0,1,0]
    v_pk_fma_f32 v[122:123], v[66:67], v[26:27], v[122:123] op_sel:[0,0,0] op_sel_hi:[1,0,1] neg_lo:[0,1,0] neg_hi:[0,1,0]
    v_pk_mul_f32 v[224:225], v[120:121], v[28:29] op_sel:[0,0] op_sel_hi:[1,0]
    v_pk_mul_f32 v[226:227], v[122:123], v[28:29] op_sel:[0,0] op_sel_hi:[1,0]
    v_exp_f32 v224, v224
    v_exp_f32 v225, v225
    v_exp_f32 v226, v226
    v_exp_f32 v227, v227
    v_pk_fma_f32 v[148:149], v[92:93], v[26:27], v[148:149] op_sel:[0,0,0] op_sel_hi:[1,0,1] neg_lo:[0,1,0] neg_hi:[0,1,0]
    v_pk_fma_f32 v[150:151], v[94:95], v[26:27], v[150:151] op_sel:[0,0,0] op_sel_hi:[1,0,1] neg_lo:[0,1,0] neg_hi:[0,1,0]
    v_pk_fma_f32 v[224:225], v[224:225], v[30:31], v[30:31] op_sel:[0,0,0] op_sel_hi:[1,0,0]
    v_pk_fma_f32 v[226:227], v[226:227], v[30:31], v[30:31] op_sel:[0,0,0] op_sel_hi:[1,0,0]
    v_rcp_f32 v224, v224
    v_rcp_f32 v225, v225
    v_rcp_f32 v226, v226
    v_rcp_f32 v227, v227
    v_pk_mul_f32 v[120:121], v[120:121], v[148:149]
    v_pk_mul_f32 v[122:123], v[122:123], v[150:151]
    v_pk_mul_f32 v[120:121], v[120:121], v[224:225]
    v_pk_mul_f32 v[122:123], v[122:123], v[226:227]
    v_cvt_pk_bf16_f32 v228, v120, v121
    v_cvt_pk_bf16_f32 v229, v122, v123
    buffer_store_dwordx2 v[228:229], v9, s[4:7], s29 offen offset:0 sc1
    v_pk_fma_f32 v[176:177], v[64:65], v[26:27], v[176:177] op_sel:[0,1,0] op_sel_hi:[1,1,1] neg_lo:[0,1,0] neg_hi:[0,1,0]
    v_pk_fma_f32 v[178:179], v[66:67], v[26:27], v[178:179] op_sel:[0,1,0] op_sel_hi:[1,1,1] neg_lo:[0,1,0] neg_hi:[0,1,0]
    v_pk_mul_f32 v[232:233], v[176:177], v[28:29] op_sel:[0,1] op_sel_hi:[1,1]
    v_pk_mul_f32 v[234:235], v[178:179], v[28:29] op_sel:[0,1] op_sel_hi:[1,1]
    v_exp_f32 v232, v232
    v_exp_f32 v233, v233
    v_exp_f32 v234, v234
    v_exp_f32 v235, v235
    v_pk_fma_f32 v[204:205], v[92:93], v[26:27], v[204:205] op_sel:[0,1,0] op_sel_hi:[1,1,1] neg_lo:[0,1,0] neg_hi:[0,1,0]
    v_pk_fma_f32 v[206:207], v[94:95], v[26:27], v[206:207] op_sel:[0,1,0] op_sel_hi:[1,1,1] neg_lo:[0,1,0] neg_hi:[0,1,0]
    v_pk_fma_f32 v[232:233], v[232:233], v[30:31], v[30:31] op_sel:[0,1,1] op_sel_hi:[1,1,1]
    v_pk_fma_f32 v[234:235], v[234:235], v[30:31], v[30:31] op_sel:[0,1,1] op_sel_hi:[1,1,1]
    v_rcp_f32 v232, v232
    v_rcp_f32 v233, v233
    v_rcp_f32 v234, v234
    v_rcp_f32 v235, v235
    v_pk_mul_f32 v[176:177], v[176:177], v[204:205]
    v_pk_mul_f32 v[178:179], v[178:179], v[206:207]
    v_pk_mul_f32 v[176:177], v[176:177], v[232:233]
    v_pk_mul_f32 v[178:179], v[178:179], v[234:235]
    v_cvt_pk_bf16_f32 v236, v176, v177
    v_cvt_pk_bf16_f32 v237, v178, v179
    buffer_store_dwordx2 v[236:237], v9, s[4:7], s29 offen offset:256 sc1
    s_add_u32 s29, s25, 5120
    v_pk_fma_f32 v[124:125], v[68:69], v[26:27], v[124:125] op_sel:[0,0,0] op_sel_hi:[1,0,1] neg_lo:[0,1,0] neg_hi:[0,1,0]
    v_pk_fma_f32 v[126:127], v[70:71], v[26:27], v[126:127] op_sel:[0,0,0] op_sel_hi:[1,0,1] neg_lo:[0,1,0] neg_hi:[0,1,0]
    v_pk_mul_f32 v[240:241], v[124:125], v[28:29] op_sel:[0,0] op_sel_hi:[1,0]
    v_pk_mul_f32 v[242:243], v[126:127], v[28:29] op_sel:[0,0] op_sel_hi:[1,0]
    v_exp_f32 v240, v240
    v_exp_f32 v241, v241
    v_exp_f32 v242, v242
    v_exp_f32 v243, v243
    v_pk_fma_f32 v[152:153], v[96:97], v[26:27], v[152:153] op_sel:[0,0,0] op_sel_hi:[1,0,1] neg_lo:[0,1,0] neg_hi:[0,1,0]
    v_pk_fma_f32 v[154:155], v[98:99], v[26:27], v[154:155] op_sel:[0,0,0] op_sel_hi:[1,0,1] neg_lo:[0,1,0] neg_hi:[0,1,0]
    v_pk_fma_f32 v[240:241], v[240:241], v[30:31], v[30:31] op_sel:[0,0,0] op_sel_hi:[1,0,0]
    v_pk_fma_f32 v[242:243], v[242:243], v[30:31], v[30:31] op_sel:[0,0,0] op_sel_hi:[1,0,0]
    v_rcp_f32 v240, v240
    v_rcp_f32 v241, v241
    v_rcp_f32 v242, v242
    v_rcp_f32 v243, v243
    v_pk_mul_f32 v[124:125], v[124:125], v[152:153]
    v_pk_mul_f32 v[126:127], v[126:127], v[154:155]
    v_pk_mul_f32 v[124:125], v[124:125], v[240:241]
    v_pk_mul_f32 v[126:127], v[126:127], v[242:243]
    v_cvt_pk_bf16_f32 v244, v124, v125
    v_cvt_pk_bf16_f32 v245, v126, v127
    buffer_store_dwordx2 v[244:245], v9, s[4:7], s29 offen offset:0 sc1
    v_pk_fma_f32 v[180:181], v[68:69], v[26:27], v[180:181] op_sel:[0,1,0] op_sel_hi:[1,1,1] neg_lo:[0,1,0] neg_hi:[0,1,0]
    v_pk_fma_f32 v[182:183], v[70:71], v[26:27], v[182:183] op_sel:[0,1,0] op_sel_hi:[1,1,1] neg_lo:[0,1,0] neg_hi:[0,1,0]
    v_pk_mul_f32 v[248:249], v[180:181], v[28:29] op_sel:[0,1] op_sel_hi:[1,1]
    v_pk_mul_f32 v[250:251], v[182:183], v[28:29] op_sel:[0,1] op_sel_hi:[1,1]
    v_exp_f32 v248, v248
    v_exp_f32 v249, v249
    v_exp_f32 v250, v250
    v_exp_f32 v251, v251
    v_pk_fma_f32 v[208:209], v[96:97], v[26:27], v[208:209] op_sel:[0,1,0] op_sel_hi:[1,1,1] neg_lo:[0,1,0] neg_hi:[0,1,0]
    v_pk_fma_f32 v[210:211], v[98:99], v[26:27], v[210:211] op_sel:[0,1,0] op_sel_hi:[1,1,1] neg_lo:[0,1,0] neg_hi:[0,1,0]
    v_pk_fma_f32 v[248:249], v[248:249], v[30:31], v[30:31] op_sel:[0,1,1] op_sel_hi:[1,1,1]
    v_pk_fma_f32 v[250:251], v[250:251], v[30:31], v[30:31] op_sel:[0,1,1] op_sel_hi:[1,1,1]
    v_rcp_f32 v248, v248
    v_rcp_f32 v249, v249
    v_rcp_f32 v250, v250
    v_rcp_f32 v251, v251
    v_pk_mul_f32 v[180:181], v[180:181], v[208:209]
    v_pk_mul_f32 v[182:183], v[182:183], v[210:211]
    v_pk_mul_f32 v[180:181], v[180:181], v[248:249]
    v_pk_mul_f32 v[182:183], v[182:183], v[250:251]
    v_cvt_pk_bf16_f32 v252, v180, v181
    v_cvt_pk_bf16_f32 v253, v182, v183
    buffer_store_dwordx2 v[252:253], v9, s[4:7], s29 offen offset:256 sc1
    s_add_u32 s29, s25, 6144
    v_pk_fma_f32 v[128:129], v[72:73], v[26:27], v[128:129] op_sel:[0,0,0] op_sel_hi:[1,0,1] neg_lo:[0,1,0] neg_hi:[0,1,0]
    v_pk_fma_f32 v[130:131], v[74:75], v[26:27], v[130:131] op_sel:[0,0,0] op_sel_hi:[1,0,1] neg_lo:[0,1,0] neg_hi:[0,1,0]
    v_pk_mul_f32 v[224:225], v[128:129], v[28:29] op_sel:[0,0] op_sel_hi:[1,0]
    v_pk_mul_f32 v[226:227], v[130:131], v[28:29] op_sel:[0,0] op_sel_hi:[1,0]
    v_exp_f32 v224, v224
    v_exp_f32 v225, v225
    v_exp_f32 v226, v226
    v_exp_f32 v227, v227
    v_pk_fma_f32 v[156:157], v[100:101], v[26:27], v[156:157] op_sel:[0,0,0] op_sel_hi:[1,0,1] neg_lo:[0,1,0] neg_hi:[0,1,0]
    v_pk_fma_f32 v[158:159], v[102:103], v[26:27], v[158:159] op_sel:[0,0,0] op_sel_hi:[1,0,1] neg_lo:[0,1,0] neg_hi:[0,1,0]
    v_pk_fma_f32 v[224:225], v[224:225], v[30:31], v[30:31] op_sel:[0,0,0] op_sel_hi:[1,0,0]
    v_pk_fma_f32 v[226:227], v[226:227], v[30:31], v[30:31] op_sel:[0,0,0] op_sel_hi:[1,0,0]
    v_rcp_f32 v224, v224
    v_rcp_f32 v225, v225
    v_rcp_f32 v226, v226
    v_rcp_f32 v227, v227
    v_pk_mul_f32 v[128:129], v[128:129], v[156:157]
    v_pk_mul_f32 v[130:131], v[130:131], v[158:159]
    v_pk_mul_f32 v[128:129], v[128:129], v[224:225]
    v_pk_mul_f32 v[130:131], v[130:131], v[226:227]
    v_cvt_pk_bf16_f32 v228, v128, v129
    v_cvt_pk_bf16_f32 v229, v130, v131
    buffer_store_dwordx2 v[228:229], v9, s[4:7], s29 offen offset:0 sc1
    v_pk_fma_f32 v[184:185], v[72:73], v[26:27], v[184:185] op_sel:[0,1,0] op_sel_hi:[1,1,1] neg_lo:[0,1,0] neg_hi:[0,1,0]
    v_pk_fma_f32 v[186:187], v[74:75], v[26:27], v[186:187] op_sel:[0,1,0] op_sel_hi:[1,1,1] neg_lo:[0,1,0] neg_hi:[0,1,0]
    v_pk_mul_f32 v[232:233], v[184:185], v[28:29] op_sel:[0,1] op_sel_hi:[1,1]
    v_pk_mul_f32 v[234:235], v[186:187], v[28:29] op_sel:[0,1] op_sel_hi:[1,1]
    v_exp_f32 v232, v232
    v_exp_f32 v233, v233
    v_exp_f32 v234, v234
    v_exp_f32 v235, v235
    v_pk_fma_f32 v[212:213], v[100:101], v[26:27], v[212:213] op_sel:[0,1,0] op_sel_hi:[1,1,1] neg_lo:[0,1,0] neg_hi:[0,1,0]
    v_pk_fma_f32 v[214:215], v[102:103], v[26:27], v[214:215] op_sel:[0,1,0] op_sel_hi:[1,1,1] neg_lo:[0,1,0] neg_hi:[0,1,0]
    v_pk_fma_f32 v[232:233], v[232:233], v[30:31], v[30:31] op_sel:[0,1,1] op_sel_hi:[1,1,1]
    v_pk_fma_f32 v[234:235], v[234:235], v[30:31], v[30:31] op_sel:[0,1,1] op_sel_hi:[1,1,1]
    v_rcp_f32 v232, v232
    v_rcp_f32 v233, v233
    v_rcp_f32 v234, v234
    v_rcp_f32 v235, v235
    v_pk_mul_f32 v[184:185], v[184:185], v[212:213]
    v_pk_mul_f32 v[186:187], v[186:187], v[214:215]
    v_pk_mul_f32 v[184:185], v[184:185], v[232:233]
    v_pk_mul_f32 v[186:187], v[186:187], v[234:235]
    v_cvt_pk_bf16_f32 v236, v184, v185
    v_cvt_pk_bf16_f32 v237, v186, v187
    buffer_store_dwordx2 v[236:237], v9, s[4:7], s29 offen offset:256 sc1
    s_cmp_lg_u32 s100, 0
    s_cbranch_scc0 J_P5
    v_mov_b32 v4, 1
    s_waitcnt vmcnt(0)
    s_mov_b64 exec, 1
    buffer_store_byte v4, off, s[4:7], s40
    s_mov_b64 exec, -1
    s_branch J_SLOW_next
J_P5:
    s_nop 7
    s_nop 7
    s_load_dwordx2 s[10:11], s[0:1], 56
    s_load_dwordx2 s[12:13], s[0:1], 48
    s_and_b32 s20, s2, 7
    s_lshl_b32 s20, s20, 2
    s_bfe_u32 s22, s2, 0x20003
    s_add_u32 s20, s20, s22
    s_lshr_b32 s21, s2, 5
    v_and_b32 v1, 63, v0
    v_and_b32 v2, 15, v1
    v_lshrrev_b32 v3, 4, v1
    s_lshl_b32 s29, s22, 5
    s_lshl_b32 s23, s3, 3
    s_add_u32 s29, s29, s23
    s_add_u32 s29, s29, s8
    s_add_u32 s29, s29, 512
    s_mul_i32 s23, s20, 229376
    s_mul_i32 s24, s3, 28672
    s_add_u32 s23, s23, s24
    s_add_u32 s23, s23, 0xa00000
    v_lshlrev_b32 v4, 4, v1
    v_add_u32 v8, s23, v4
    v_add_u32 v9, 114688, v8
    s_lshl_b32 s24, s21, 7
    v_lshrrev_b32 v4, 5, v1
    v_lshlrev_b32 v4, 2, v4
    v_bfe_u32 v5, v1, 2, 2
    v_add_u32 v4, v4, v5
    v_lshlrev_b32 v4, 10, v4
    v_bfe_u32 v5, v1, 4, 1
    v_lshl_add_u32 v4, v5, 6, v4
    v_and_b32 v5, 3, v1
    v_lshl_add_u32 v4, v5, 4, v4
    v_add_u32 v10, s24, v4
    s_mul_i32 s25, s3, 458752
    s_lshl_b32 s26, s3, 11
    v_lshrrev_b32 v4, 1, v3
    v_lshlrev_b32 v4, 10, v4
    v_lshrrev_b32 v5, 2, v2
    v_lshl_add_u32 v4, v5, 6, v4
    v_and_b32 v5, 1, v3
    v_lshl_add_u32 v4, v5, 5, v4
    v_and_b32 v5, 3, v2
    v_lshl_add_u32 v4, v5, 3, v4
    v_add_u32 v11, s26, v4
    v_add_u32 v22, 0x10000, v11
    v_add_u32 v23, 0x20000, v11
    v_and_b32 v4, 31, v1
    v_lshrrev_b32 v5, 3, v4
    v_lshlrev_b32 v5, 13, v5
    v_and_b32 v6, 7, v4
    v_lshl_add_u32 v5, v6, 8, v5
    v_add_u32 v5, s26, v5
    v_and_b32 v4, 7, v4
    v_lshrrev_b32 v6, 5, v1
    v_xor_b32 v4, v4, v6
    v_xor_b32 v6, 0, v4
    v_lshl_add_u32 v14, v6, 4, v5
    v_xor_b32 v6, 2, v4
    v_lshl_add_u32 v15, v6, 4, v5
    v_xor_b32 v6, 4, v4
    v_lshl_add_u32 v16, v6, 4, v5
    v_xor_b32 v6, 6, v4
    v_lshl_add_u32 v17, v6, 4, v5
    s_lshl_b32 s27, s3, 14
    v_lshrrev_b32 v4, 3, v1
    v_lshlrev_b32 v5, 8, v4
    v_add_u32 v5, s27, v5
    v_and_b32 v6, 7, v1
    v_lshlrev_b32 v6, 1, v6
    v_xor_b32 v6, v6, v4
    v_lshl_add_u32 v18, v6, 4, v5
    v_xor_b32 v6, 1, v6
    v_lshl_add_u32 v19, v6, 4, v5
    s_lshl_b32 s27, s3, 4
    s_lshl_b32 s28, s20, 6
    s_add_u32 s27, s27, s28
    s_lshl_b32 s27, s27, 10
    s_add_u32 s27, s27, s24
    v_lshlrev_b32 v5, 10, v4
    v_and_b32 v6, 7, v1
    v_lshl_add_u32 v5, v6, 4, v5
    v_add_u32 v4, s27, v5
    v_add_u32 v12, 0x0, v4
    v_add_u32 v13, 0x800000, v4
    s_mov_b32 s41, 8192
    s_waitcnt lgkmcnt(0)
    s_mov_b32 s16, s10
    s_mov_b32 s17, s11
    s_mov_b32 s18, 0x200000
    s_mov_b32 s19, 0x00020000
    s_mov_b32 s14, 0x1c0000
    s_mov_b32 s15, 0x00020000
    s_cmp_lg_u32 s100, 0
    s_cbranch_scc1 P5_go
    v_mov_b32 v4, 1
    s_waitcnt vmcnt(0)
    s_mov_b64 exec, 1
    buffer_store_byte v4, off, s[4:7], s40
    s_mov_b64 exec, -1
P5_go:
    v_mov_b32 v5, 0x26400
    s_barrier
    ds_read_b32 v4, v5 offset:4
    s_waitcnt lgkmcnt(0)
    v_readfirstlane_b32 s96, v4
    s_mov_b32 s30, 0
    s_mov_b64 exec, 1
P5_poll:
    buffer_load_dwordx2 v[4:5], off, s[4:7], s29 sc1
    s_add_u32 s30, s30, 1
    s_waitcnt vmcnt(0)
    v_and_b32 v4, v4, v5
    s_nop 0
    v_readfirstlane_b32 s31, v4
    s_cmp_eq_u32 s31, 0x01010101
    s_cbranch_scc1 P5_poll_x
    s_cmp_lt_u32 s30, 0x20000
    s_cbranch_scc1 P5_poll
P5_poll_x:
    s_mov_b64 exec, -1
    s_lshl_b32 s31, s3, 3
    s_add_u32 s31, s31, 0x26480
    v_mov_b32 v4, s31
    v_mov_b32 v5, 1
    s_mov_b32 s30, 0
    buffer_load_dwordx4 v[24:27], v8, s[4:7], s30 offen
    buffer_load_dwordx4 v[28:31], v9, s[4:7], s30 offen
    s_mov_b32 s30, 1024
    buffer_load_dwordx4 v[32:35], v8, s[4:7], s30 offen
    buffer_load_dwordx4 v[36:39], v9, s[4:7], s30 offen
    s_mov_b32 s30, 2048
    buffer_load_dwordx4 v[40:43], v8, s[4:7], s30 offen
    buffer_load_dwordx4 v[44:47], v9, s[4:7], s30 offen
    s_mov_b32 s30, 3072
    buffer_load_dwordx4 v[48:51], v8, s[4:7], s30 offen
    buffer_load_dwordx4 v[52:55], v9, s[4:7], s30 offen
    s_mov_b32 s30, 4096
    buffer_load_dwordx4 v[56:59], v8, s[4:7], s30 offen
    buffer_load_dwordx4 v[60:63], v9, s[4:7], s30 offen
    s_mov_b32 s30, 5120
    buffer_load_dwordx4 v[64:67], v8, s[4:7], s30 offen
    buffer_load_dwordx4 v[68:71], v9, s[4:7], s30 offen
    s_mov_b32 s30, 6144
    buffer_load_dwordx4 v[72:75], v8, s[4:7], s30 offen
    buffer_load_dwordx4 v[76:79], v9, s[4:7], s30 offen
    s_mov_b32 s30, 7168
    buffer_load_dwordx4 v[80:83], v8, s[4:7], s30 offen
    buffer_load_dwordx4 v[84:87], v9, s[4:7], s30 offen
    s_mov_b32 s30, 8192
    buffer_load_dwordx4 v[88:91], v8, s[4:7], s30 offen
    buffer_load_dwordx4 v[92:95], v9, s[4:7], s30 offen
    s_mov_b32 s30, 9216
    buffer_load_dwordx4 v[96:99], v8, s[4:7], s30 offen
    buffer_load_dwordx4 v[100:103], v9, s[4:7], s30 offen
    s_mov_b32 s30, 10240
    buffer_load_dwordx4 v[104:107], v8, s[4:7], s30 offen
    buffer_load_dwordx4 v[108:111], v9, s[4:7], s30 offen
    s_mov_b32 s30, 11264
    buffer_load_dwordx4 v[112:115], v8, s[4:7], s30 offen
    buffer_load_dwordx4 v[116:119], v9, s[4:7], s30 offen
    s_mov_b32 s30, 12288
    buffer_load_dwordx4 v[120:123], v8, s[4:7], s30 offen
    buffer_load_dwordx4 v[124:127], v9, s[4:7], s30 offen
    s_mov_b32 s30, 13312
    buffer_load_dwordx4 v[128:131], v8, s[4:7], s30 offen
    buffer_load_dwordx4 v[132:135], v9, s[4:7], s30 offen
    s_mov_b32 s30, 14336
    buffer_load_dwordx4 v[136:139], v8, s[4:7], s30 offen
    buffer_load_dwordx4 v[140:143], v9, s[4:7], s30 offen
    buffer_load_dwordx4 v[232:235], v13, s[4:7], 0 offen
    buffer_load_dwordx4 v[236:239], v13, s[4:7], s41 offen
    ds_read_b64_tr_b16 v[152:153], v11 offset:24576
    ds_read_b64_tr_b16 v[154:155], v11 offset:25088
    ds_read_b64_tr_b16 v[156:157], v11 offset:24832
    ds_read_b64_tr_b16 v[158:159], v11 offset:25344
    ds_read_b64_tr_b16 v[160:161], v11 offset:32768
    ds_read_b64_tr_b16 v[162:163], v11 offset:33280
    ds_read_b64_tr_b16 v[164:165], v11 offset:33024
    ds_read_b64_tr_b16 v[166:167], v11 offset:33536
    s_waitcnt lgkmcnt(4)
    s_waitcnt vmcnt(30)
    v_mfma_f32_32x32x16_bf16 v[168:183], v[152:155], v[24:27], 0
    v_mfma_f32_32x32x16_bf16 v[184:199], v[156:159], v[24:27], 0
    v_mfma_f32_32x32x16_bf16 v[200:215], v[152:155], v[28:31], 0
    v_mfma_f32_32x32x16_bf16 v[216:231], v[156:159], v[28:31], 0
    s_mov_b32 s30, 15360
    buffer_load_dwordx4 v[144:147], v8, s[4:7], s30 offen
    buffer_load_dwordx4 v[148:151], v9, s[4:7], s30 offen
    ds_read_b64_tr_b16 v[152:153], v11 offset:40960
    ds_read_b64_tr_b16 v[154:155], v11 offset:41472
    ds_read_b64_tr_b16 v[156:157], v11 offset:41216
    ds_read_b64_tr_b16 v[158:159], v11 offset:41728
    s_waitcnt lgkmcnt(4)
    s_waitcnt vmcnt(30)
    v_mfma_f32_32x32x16_bf16 v[168:183], v[160:163], v[32:35], v[168:183]
    v_mfma_f32_32x32x16_bf16 v[184:199], v[164:167], v[32:35], v[184:199]
    v_mfma_f32_32x32x16_bf16 v[200:215], v[160:163], v[36:39], v[200:215]
    v_mfma_f32_32x32x16_bf16 v[216:231], v[164:167], v[36:39], v[216:231]
    s_mov_b32 s30, 16384
    buffer_load_dwordx4 v[24:27], v8, s[4:7], s30 offen
    buffer_load_dwordx4 v[28:31], v9, s[4:7], s30 offen
    ds_read_b64_tr_b16 v[160:161], v11 offset:49152
    ds_read_b64_tr_b16 v[162:163], v11 offset:49664
    ds_read_b64_tr_b16 v[164:165], v11 offset:49408
    ds_read_b64_tr_b16 v[166:167], v11 offset:49920
    s_waitcnt lgkmcnt(4)
    s_waitcnt vmcnt(30)
    v_mfma_f32_32x32x16_bf16 v[168:183], v[152:155], v[40:43], v[168:183]
    v_mfma_f32_32x32x16_bf16 v[184:199], v[156:159], v[40:43], v[184:199]
    v_mfma_f32_32x32x16_bf16 v[200:215], v[152:155], v[44:47], v[200:215]
    v_mfma_f32_32x32x16_bf16 v[216:231], v[156:159], v[44:47], v[216:231]
    s_mov_b32 s30, 17408
    buffer_load_dwordx4 v[32:35], v8, s[4:7], s30 offen
    buffer_load_dwordx4 v[36:39], v9, s[4:7], s30 offen
    ds_read_b64_tr_b16 v[152:153], v11 offset:57344
    ds_read_b64_tr_b16 v[154:155], v11 offset:57856
    ds_read_b64_tr_b16 v[156:157], v11 offset:57600
    ds_read_b64_tr_b16 v[158:159], v11 offset:58112
    s_waitcnt lgkmcnt(4)
    s_waitcnt vmcnt(30)
    v_mfma_f32_32x32x16_bf16 v[168:183], v[160:163], v[48:51], v[168:183]
    v_mfma_f32_32x32x16_bf16 v[184:199], v[164:167], v[48:51], v[184:199]
    v_mfma_f32_32x32x16_bf16 v[200:215], v[160:163], v[52:55], v[200:215]
    v_mfma_f32_32x32x16_bf16 v[216:231], v[164:167], v[52:55], v[216:231]
    s_mov_b32 s30, 18432
    buffer_load_dwordx4 v[40:43], v8, s[4:7], s30 offen
    buffer_load_dwordx4 v[44:47], v9, s[4:7], s30 offen
    ds_read_b64_tr_b16 v[160:161], v22 offset:0
    ds_read_b64_tr_b16 v[162:163], v22 offset:512
    ds_read_b64_tr_b16 v[164:165], v22 offset:256
    ds_read_b64_tr_b16 v[166:167], v22 offset:768
    s_waitcnt lgkmcnt(4)
    s_waitcnt vmcnt(30)
    v_mfma_f32_32x32x16_bf16 v[168:183], v[152:155], v[56:59], v[168:183]
    v_mfma_f32_32x32x16_bf16 v[184:199], v[156:159], v[56:59], v[184:199]
    v_mfma_f32_32x32x16_bf16 v[200:215], v[152:155], v[60:63], v[200:215]
    v_mfma_f32_32x32x16_bf16 v[216:231], v[156:159], v[60:63], v[216:231]
    s_mov_b32 s30, 19456
    buffer_load_dwordx4 v[48:51], v8, s[4:7], s30 offen
    buffer_load_dwordx4 v[52:55], v9, s[4:7], s30 offen
    ds_read_b64_tr_b16 v[152:153], v22 offset:8192
    ds_read_b64_tr_b16 v[154:155], v22 offset:8704
    ds_read_b64_tr_b16 v[156:157], v22 offset:8448
    ds_read_b64_tr_b16 v[158:159], v22 offset:8960
    s_waitcnt lgkmcnt(4)
    s_waitcnt vmcnt(30)
    v_mfma_f32_32x32x16_bf16 v[168:183], v[160:163], v[64:67], v[168:183]
    v_mfma_f32_32x32x16_bf16 v[184:199], v[164:167], v[64:67], v[184:199]
    v_mfma_f32_32x32x16_bf16 v[200:215], v[160:163], v[68:71], v[200:215]
    v_mfma_f32_32x32x16_bf16 v[216:231], v[164:167], v[68:71], v[216:231]
    s_mov_b32 s30, 20480
    buffer_load_dwordx4 v[56:59], v8, s[4:7], s30 offen
    buffer_load_dwordx4 v[60:63], v9, s[4:7], s30 offen
    ds_read_b64_tr_b16 v[160:161], v22 offset:16384
    ds_read_b64_tr_b16 v[162:163], v22 offset:16896
    ds_read_b64_tr_b16 v[164:165], v22 offset:16640
    ds_read_b64_tr_b16 v[166:167], v22 offset:17152
    s_waitcnt lgkmcnt(4)
    s_waitcnt vmcnt(30)
    v_mfma_f32_32x32x16_bf16 v[168:183], v[152:155], v[72:75], v[168:183]
    v_mfma_f32_32x32x16_bf16 v[184:199], v[156:159], v[72:75], v[184:199]
    v_mfma_f32_32x32x16_bf16 v[200:215], v[152:155], v[76:79], v[200:215]
    v_mfma_f32_32x32x16_bf16 v[216:231], v[156:159], v[76:79], v[216:231]
    s_mov_b32 s30, 21504
    buffer_load_dwordx4 v[64:67], v8, s[4:7], s30 offen
    buffer_load_dwordx4 v[68:71], v9, s[4:7], s30 offen
    ds_read_b64_tr_b16 v[152:153], v22 offset:24576
    ds_read_b64_tr_b16 v[154:155], v22 offset:25088
    ds_read_b64_tr_b16 v[156:157], v22 offset:24832
    ds_read_b64_tr_b16 v[158:159], v22 offset:25344
    s_waitcnt lgkmcnt(4)
    s_waitcnt vmcnt(30)
    v_mfma_f32_32x32x16_bf16 v[168:183], v[160:163], v[80:83], v[168:183]
    v_mfma_f32_32x32x16_bf16 v[184:199], v[164:167], v[80:83], v[184:199]
    v_mfma_f32_32x32x16_bf16 v[200:215], v[160:163], v[84:87], v[200:215]
    v_mfma_f32_32x32x16_bf16 v[216:231], v[164:167], v[84:87], v[216:231]
    s_mov_b32 s30, 22528
    buffer_load_dwordx4 v[72:75], v8, s[4:7], s30 offen
    buffer_load_dwordx4 v[76:79], v9, s[4:7], s30 offen
    ds_read_b64_tr_b16 v[160:161], v22 offset:32768
    ds_read_b64_tr_b16 v[162:163], v22 offset:33280
    ds_read_b64_tr_b16 v[164:165], v22 offset:33024
    ds_read_b64_tr_b16 v[166:167], v22 offset:33536
    s_waitcnt lgkmcnt(4)
    s_waitcnt vmcnt(30)
    v_mfma_f32_32x32x16_bf16 v[168:183], v[152:155], v[88:91], v[168:183]
    v_mfma_f32_32x32x16_bf16 v[184:199], v[156:159], v[88:91], v[184:199]
    v_mfma_f32_32x32x16_bf16 v[200:215], v[152:155], v[92:95], v[200:215]
    v_mfma_f32_32x32x16_bf16 v[216:231], v[156:159], v[92:95], v[216:231]
    s_mov_b32 s30, 23552
    buffer_load_dwordx4 v[80:83], v8, s[4:7], s30 offen
    buffer_load_dwordx4 v[84:87], v9, s[4:7], s30 offen
    ds_read_b64_tr_b16 v[152:153], v22 offset:40960
    ds_read_b64_tr_b16 v[154:155], v22 offset:41472
    ds_read_b64_tr_b16 v[156:157], v22 offset:41216
    ds_read_b64_tr_b16 v[158:159], v22 offset:41728
    s_waitcnt lgkmcnt(4)
    ds_write_b32 v4, v5
    s_waitcnt vmcnt(30)
    v_mfma_f32_32x32x16_bf16 v[168:183], v[160:163], v[96:99], v[168:183]
    v_mfma_f32_32x32x16_bf16 v[184:199], v[164:167], v[96:99], v[184:199]
    v_mfma_f32_32x32x16_bf16 v[200:215], v[160:163], v[100:103], v[200:215]
    v_mfma_f32_32x32x16_bf16 v[216:231], v[164:167], v[100:103], v[216:231]
    s_mov_b32 s30, 24576
    buffer_load_dwordx4 v[88:91], v8, s[4:7], s30 offen
    buffer_load_dwordx4 v[92:95], v9, s[4:7], s30 offen
    ds_read_b64_tr_b16 v[160:161], v22 offset:49152
    ds_read_b64_tr_b16 v[162:163], v22 offset:49664
    ds_read_b64_tr_b16 v[164:165], v22 offset:49408
    ds_read_b64_tr_b16 v[166:167], v22 offset:49920
    s_waitcnt lgkmcnt(4)
    s_waitcnt vmcnt(30)
    v_mfma_f32_32x32x16_bf16 v[168:183], v[152:155], v[104:107], v[168:183]
    v_mfma_f32_32x32x16_bf16 v[184:199], v[156:159], v[104:107], v[184:199]
    v_mfma_f32_32x32x16_bf16 v[200:215], v[152:155], v[108:111], v[200:215]
    v_mfma_f32_32x32x16_bf16 v[216:231], v[156:159], v[108:111], v[216:231]
    s_mov_b32 s30, 25600
    buffer_load_dwordx4 v[96:99], v8, s[4:7], s30 offen
    buffer_load_dwordx4 v[100:103], v9, s[4:7], s30 offen
    ds_read_b64_tr_b16 v[152:153], v22 offset:57344
    ds_read_b64_tr_b16 v[154:155], v22 offset:57856
    ds_read_b64_tr_b16 v[156:157], v22 offset:57600
    ds_read_b64_tr_b16 v[158:159], v22 offset:58112
    s_waitcnt lgkmcnt(4)
    s_waitcnt vmcnt(30)
    v_mfma_f32_32x32x16_bf16 v[168:183], v[160:163], v[112:115], v[168:183]
    v_mfma_f32_32x32x16_bf16 v[184:199], v[164:167], v[112:115], v[184:199]
    v_mfma_f32_32x32x16_bf16 v[200:215], v[160:163], v[116:119], v[200:215]
    v_mfma_f32_32x32x16_bf16 v[216:231], v[164:167], v[116:119], v[216:231]
    s_mov_b32 s30, 26624
    buffer_load_dwordx4 v[104:107], v8, s[4:7], s30 offen
    buffer_load_dwordx4 v[108:111], v9, s[4:7], s30 offen
    ds_read_b64_tr_b16 v[160:161], v23 offset:0
    ds_read_b64_tr_b16 v[162:163], v23 offset:512
    ds_read_b64_tr_b16 v[164:165], v23 offset:256
    ds_read_b64_tr_b16 v[166:167], v23 offset:768
    s_waitcnt lgkmcnt(4)
    s_waitcnt vmcnt(30)
    v_mfma_f32_32x32x16_bf16 v[168:183], v[152:155], v[120:123], v[168:183]
    v_mfma_f32_32x32x16_bf16 v[184:199], v[156:159], v[120:123], v[184:199]
    v_mfma_f32_32x32x16_bf16 v[200:215], v[152:155], v[124:127], v[200:215]
    v_mfma_f32_32x32x16_bf16 v[216:231], v[156:159], v[124:127], v[216:231]
    s_mov_b32 s30, 27648
    buffer_load_dwordx4 v[112:115], v8, s[4:7], s30 offen
    buffer_load_dwordx4 v[116:119], v9, s[4:7], s30 offen
    ds_read_b64_tr_b16 v[152:153], v23 offset:8192
    ds_read_b64_tr_b16 v[154:155], v23 offset:8704
    ds_read_b64_tr_b16 v[156:157], v23 offset:8448
    ds_read_b64_tr_b16 v[158:159], v23 offset:8960
    s_waitcnt lgkmcnt(4)
    s_waitcnt vmcnt(30)
    v_mfma_f32_32x32x16_bf16 v[168:183], v[160:163], v[128:131], v[168:183]
    v_mfma_f32_32x32x16_bf16 v[184:199], v[164:167], v[128:131], v[184:199]
    v_mfma_f32_32x32x16_bf16 v[200:215], v[160:163], v[132:135], v[200:215]
    v_mfma_f32_32x32x16_bf16 v[216:231], v[164:167], v[132:135], v[216:231]
    ds_read_b64_tr_b16 v[160:161], v11 offset:0
    ds_read_b64_tr_b16 v[162:163], v11 offset:512
    ds_read_b64_tr_b16 v[164:165], v11 offset:256
    ds_read_b64_tr_b16 v[166:167], v11 offset:768
    s_waitcnt lgkmcnt(4)
    s_waitcnt vmcnt(28)
    v_mfma_f32_32x32x16_bf16 v[168:183], v[152:155], v[136:139], v[168:183]
    v_mfma_f32_32x32x16_bf16 v[184:199], v[156:159], v[136:139], v[184:199]
    v_mfma_f32_32x32x16_bf16 v[200:215], v[152:155], v[140:143], v[200:215]
    v_mfma_f32_32x32x16_bf16 v[216:231], v[156:159], v[140:143], v[216:231]
    ds_read_b64_tr_b16 v[152:153], v11 offset:8192
    ds_read_b64_tr_b16 v[154:155], v11 offset:8704
    ds_read_b64_tr_b16 v[156:157], v11 offset:8448
    ds_read_b64_tr_b16 v[158:159], v11 offset:8960
    s_waitcnt lgkmcnt(4)
    s_waitcnt vmcnt(24)
    v_mfma_f32_32x32x16_bf16 v[168:183], v[160:163], v[144:147], v[168:183]
    v_mfma_f32_32x32x16_bf16 v[184:199], v[164:167], v[144:147], v[184:199]
    v_mfma_f32_32x32x16_bf16 v[200:215], v[160:163], v[148:151], v[200:215]
    v_mfma_f32_32x32x16_bf16 v[216:231], v[164:167], v[148:151], v[216:231]
    ds_read_b32 v6, v4 offset:4
    ds_read_b64_tr_b16 v[160:161], v11 offset:16384
    ds_read_b64_tr_b16 v[162:163], v11 offset:16896
    ds_read_b64_tr_b16 v[164:165], v11 offset:16640
    ds_read_b64_tr_b16 v[166:167], v11 offset:17152
    s_waitcnt lgkmcnt(4)
    s_waitcnt vmcnt(22)
    v_mfma_f32_32x32x16_bf16 v[168:183], v[152:155], v[24:27], v[168:183]
    v_mfma_f32_32x32x16_bf16 v[184:199], v[156:159], v[24:27], v[184:199]
    v_mfma_f32_32x32x16_bf16 v[200:215], v[152:155], v[28:31], v[200:215]
    v_mfma_f32_32x32x16_bf16 v[216:231], v[156:159], v[28:31], v[216:231]
    v_readfirstlane_b32 s31, v6
    s_cmp_eq_u32 s31, 1
    s_cbranch_scc1 P5_z2x
P5_z2:
    ds_read_b32 v6, v4 offset:4
    s_waitcnt lgkmcnt(0)
    v_readfirstlane_b32 s31, v6
    s_cmp_eq_u32 s31, 1
    s_cbranch_scc0 P5_z2
P5_z2x:
    ds_read_b64_tr_b16 v[152:153], v11 offset:24576
    ds_read_b64_tr_b16 v[154:155], v11 offset:25088
    ds_read_b64_tr_b16 v[156:157], v11 offset:24832
    ds_read_b64_tr_b16 v[158:159], v11 offset:25344
    s_waitcnt lgkmcnt(4)
    s_waitcnt vmcnt(20)
    v_mfma_f32_32x32x16_bf16 v[168:183], v[160:163], v[32:35], v[168:183]
    v_mfma_f32_32x32x16_bf16 v[184:199], v[164:167], v[32:35], v[184:199]
    v_mfma_f32_32x32x16_bf16 v[200:215], v[160:163], v[36:39], v[200:215]
    v_mfma_f32_32x32x16_bf16 v[216:231], v[164:167], v[36:39], v[216:231]
    ds_read_b64_tr_b16 v[160:161], v11 offset:32768
    ds_read_b64_tr_b16 v[162:163], v11 offset:33280
    ds_read_b64_tr_b16 v[164:165], v11 offset:33024
    ds_read_b64_tr_b16 v[166:167], v11 offset:33536
    s_waitcnt lgkmcnt(4)
    s_waitcnt vmcnt(18)
    v_mfma_f32_32x32x16_bf16 v[168:183], v[152:155], v[40:43], v[168:183]
    v_mfma_f32_32x32x16_bf16 v[184:199], v[156:159], v[40:43], v[184:199]
    v_mfma_f32_32x32x16_bf16 v[200:215], v[152:155], v[44:47], v[200:215]
    v_mfma_f32_32x32x16_bf16 v[216:231], v[156:159], v[44:47], v[216:231]
    ds_read_b64_tr_b16 v[152:153], v11 offset:40960
    ds_read_b64_tr_b16 v[154:155], v11 offset:41472
    ds_read_b64_tr_b16 v[156:157], v11 offset:41216
    ds_read_b64_tr_b16 v[158:159], v11 offset:41728
    s_waitcnt lgkmcnt(4)
    s_waitcnt vmcnt(16)
    v_mfma_f32_32x32x16_bf16 v[168:183], v[160:163], v[48:51], v[168:183]
    v_mfma_f32_32x32x16_bf16 v[184:199], v[164:167], v[48:51], v[184:199]
    v_mfma_f32_32x32x16_bf16 v[200:215], v[160:163], v[52:55], v[200:215]
    v_mfma_f32_32x32x16_bf16 v[216:231], v[164:167], v[52:55], v[216:231]
    ds_read_b64_tr_b16 v[160:161], v11 offset:49152
    ds_read_b64_tr_b16 v[162:163], v11 offset:49664
    ds_read_b64_tr_b16 v[164:165], v11 offset:49408
    ds_read_b64_tr_b16 v[166:167], v11 offset:49920
    s_waitcnt lgkmcnt(4)
    s_waitcnt vmcnt(14)
    v_mfma_f32_32x32x16_bf16 v[168:183], v[152:155], v[56:59], v[168:183]
    v_mfma_f32_32x32x16_bf16 v[184:199], v[156:159], v[56:59], v[184:199]
    v_mfma_f32_32x32x16_bf16 v[200:215], v[152:155], v[60:63], v[200:215]
    v_mfma_f32_32x32x16_bf16 v[216:231], v[156:159], v[60:63], v[216:231]
    ds_read_b64_tr_b16 v[152:153], v11 offset:57344
    ds_read_b64_tr_b16 v[154:155], v11 offset:57856
    ds_read_b64_tr_b16 v[156:157], v11 offset:57600
    ds_read_b64_tr_b16 v[158:159], v11 offset:58112
    s_waitcnt lgkmcnt(4)
    s_waitcnt vmcnt(12)
    v_mfma_f32_32x32x16_bf16 v[168:183], v[160:163], v[64:67], v[168:183]
    v_mfma_f32_32x32x16_bf16 v[184:199], v[164:167], v[64:67], v[184:199]
    v_mfma_f32_32x32x16_bf16 v[200:215], v[160:163], v[68:71], v[200:215]
    v_mfma_f32_32x32x16_bf16 v[216:231], v[164:167], v[68:71], v[216:231]
    ds_read_b64_tr_b16 v[160:161], v22 offset:0
    ds_read_b64_tr_b16 v[162:163], v22 offset:512
    ds_read_b64_tr_b16 v[164:165], v22 offset:256
    ds_read_b64_tr_b16 v[166:167], v22 offset:768
    s_waitcnt lgkmcnt(4)
    s_waitcnt vmcnt(10)
    v_mfma_f32_32x32x16_bf16 v[168:183], v[152:155], v[72:75], v[168:183]
    v_mfma_f32_32x32x16_bf16 v[184:199], v[156:159], v[72:75], v[184:199]
    v_mfma_f32_32x32x16_bf16 v[200:215], v[152:155], v[76:79], v[200:215]
    v_mfma_f32_32x32x16_bf16 v[216:231], v[156:159], v[76:79], v[216:231]
    ds_read_b64_tr_b16 v[152:153], v22 offset:8192
    ds_read_b64_tr_b16 v[154:155], v22 offset:8704
    ds_read_b64_tr_b16 v[156:157], v22 offset:8448
    ds_read_b64_tr_b16 v[158:159], v22 offset:8960
    s_waitcnt lgkmcnt(4)
    s_waitcnt vmcnt(8)
    v_mfma_f32_32x32x16_bf16 v[168:183], v[160:163], v[80:83], v[168:183]
    v_mfma_f32_32x32x16_bf16 v[184:199], v[164:167], v[80:83], v[184:199]
    v_mfma_f32_32x32x16_bf16 v[200:215], v[160:163], v[84:87], v[200:215]
    v_mfma_f32_32x32x16_bf16 v[216:231], v[164:167], v[84:87], v[216:231]
    ds_read_b64_tr_b16 v[160:161], v22 offset:16384
    ds_read_b64_tr_b16 v[162:163], v22 offset:16896
    ds_read_b64_tr_b16 v[164:165], v22 offset:16640
    ds_read_b64_tr_b16 v[166:167], v22 offset:17152
    s_waitcnt lgkmcnt(4)
    s_waitcnt vmcnt(6)
    v_mfma_f32_32x32x16_bf16 v[168:183], v[152:155], v[88:91], v[168:183]
    v_mfma_f32_32x32x16_bf16 v[184:199], v[156:159], v[88:91], v[184:199]
    v_mfma_f32_32x32x16_bf16 v[200:215], v[152:155], v[92:95], v[200:215]
    v_mfma_f32_32x32x16_bf16 v[216:231], v[156:159], v[92:95], v[216:231]
    ds_read_b64_tr_b16 v[152:153], v22 offset:24576
    ds_read_b64_tr_b16 v[154:155], v22 offset:25088
    ds_read_b64_tr_b16 v[156:157], v22 offset:24832
    ds_read_b64_tr_b16 v[158:159], v22 offset:25344
    s_waitcnt lgkmcnt(4)
    s_waitcnt vmcnt(4)
    v_mfma_f32_32x32x16_bf16 v[168:183], v[160:163], v[96:99], v[168:183]
    v_mfma_f32_32x32x16_bf16 v[184:199], v[164:167], v[96:99], v[184:199]
    v_mfma_f32_32x32x16_bf16 v[200:215], v[160:163], v[100:103], v[200:215]
    v_mfma_f32_32x32x16_bf16 v[216:231], v[164:167], v[100:103], v[216:231]
    ds_read_b64_tr_b16 v[160:161], v22 offset:32768
    ds_read_b64_tr_b16 v[162:163], v22 offset:33280
    ds_read_b64_tr_b16 v[164:165], v22 offset:33024
    ds_read_b64_tr_b16 v[166:167], v22 offset:33536
    s_waitcnt lgkmcnt(4)
    s_waitcnt vmcnt(2)
    v_mfma_f32_32x32x16_bf16 v[168:183], v[152:155], v[104:107], v[168:183]
    v_mfma_f32_32x32x16_bf16 v[184:199], v[156:159], v[104:107], v[184:199]
    v_mfma_f32_32x32x16_bf16 v[200:215], v[152:155], v[108:111], v[200:215]
    v_mfma_f32_32x32x16_bf16 v[216:231], v[156:159], v[108:111], v[216:231]
    s_waitcnt lgkmcnt(0)
    s_waitcnt vmcnt(0)
    v_mfma_f32_32x32x16_bf16 v[168:183], v[160:163], v[112:115], v[168:183]
    v_mfma_f32_32x32x16_bf16 v[184:199], v[164:167], v[112:115], v[184:199]
    v_mfma_f32_32x32x16_bf16 v[200:215], v[160:163], v[116:119], v[200:215]
    v_mfma_f32_32x32x16_bf16 v[216:231], v[164:167], v[116:119], v[216:231]
    s_nop 7
    s_nop 0
    ds_write_b128 v14, v[168:171] offset:0
    ds_write_b128 v15, v[172:175] offset:0
    ds_write_b128 v16, v[176:179] offset:0
    ds_write_b128 v17, v[180:183] offset:0
    ds_write_b128 v14, v[184:187] offset:128
    ds_write_b128 v15, v[188:191] offset:128
    ds_write_b128 v16, v[192:195] offset:128
    ds_write_b128 v17, v[196:199] offset:128
    ds_write_b128 v14, v[200:203] offset:32768
    ds_write_b128 v15, v[204:207] offset:32768
    ds_write_b128 v16, v[208:211] offset:32768
    ds_write_b128 v17, v[212:215] offset:32768
    ds_write_b128 v14, v[216:219] offset:32896
    ds_write_b128 v15, v[220:223] offset:32896
    ds_write_b128 v16, v[224:227] offset:32896
    ds_write_b128 v17, v[228:231] offset:32896
    s_waitcnt lgkmcnt(0)
    s_barrier
    ds_read_b128 v[168:171], v18 offset:0
    ds_read_b128 v[172:175], v19 offset:0
    ds_read_b128 v[176:179], v18 offset:2048
    ds_read_b128 v[180:183], v19 offset:2048
    ds_read_b128 v[184:187], v18 offset:4096
    ds_read_b128 v[188:191], v19 offset:4096
    ds_read_b128 v[192:195], v18 offset:6144
    ds_read_b128 v[196:199], v19 offset:6144
    ds_read_b128 v[200:203], v18 offset:8192
    ds_read_b128 v[204:207], v19 offset:8192
    ds_read_b128 v[208:211], v18 offset:10240
    ds_read_b128 v[212:215], v19 offset:10240
    ds_read_b128 v[216:219], v18 offset:12288
    ds_read_b128 v[220:223], v19 offset:12288
    ds_read_b128 v[224:227], v18 offset:14336
    ds_read_b128 v[228:231], v19 offset:14336
    s_waitcnt lgkmcnt(12)
    v_add_f32 v168, v168, v176
    v_add_f32 v169, v169, v177
    v_add_f32 v170, v170, v178
    v_add_f32 v171, v171, v179
    v_add_f32 v172, v172, v180
    v_add_f32 v173, v173, v181
    v_add_f32 v174, v174, v182
    v_add_f32 v175, v175, v183
    s_waitcnt lgkmcnt(8)
    v_add_f32 v184, v184, v192
    v_add_f32 v185, v185, v193
    v_add_f32 v186, v186, v194
    v_add_f32 v187, v187, v195
    v_add_f32 v188, v188, v196
    v_add_f32 v189, v189, v197
    v_add_f32 v190, v190, v198
    v_add_f32 v191, v191, v199
    v_add_f32 v168, v168, v184
    v_add_f32 v169, v169, v185
    v_add_f32 v170, v170, v186
    v_add_f32 v171, v171, v187
    v_add_f32 v172, v172, v188
    v_add_f32 v173, v173, v189
    v_add_f32 v174, v174, v190
    v_add_f32 v175, v175, v191
    s_waitcnt vmcnt(0)
    v_cvt_pk_bf16_f32 v244, v168, v169
    v_lshlrev_b32 v240, 16, v244
    v_and_b32 v241, 0xffff0000, v244
    v_lshlrev_b32 v242, 16, v232
    v_and_b32 v243, 0xffff0000, v232
    v_add_f32 v240, v240, v242
    v_add_f32 v241, v241, v243
    v_cvt_pk_bf16_f32 v248, v240, v241
    v_cvt_pk_bf16_f32 v244, v170, v171
    v_lshlrev_b32 v240, 16, v244
    v_and_b32 v241, 0xffff0000, v244
    v_lshlrev_b32 v242, 16, v233
    v_and_b32 v243, 0xffff0000, v233
    v_add_f32 v240, v240, v242
    v_add_f32 v241, v241, v243
    v_cvt_pk_bf16_f32 v249, v240, v241
    v_cvt_pk_bf16_f32 v244, v172, v173
    v_lshlrev_b32 v240, 16, v244
    v_and_b32 v241, 0xffff0000, v244
    v_lshlrev_b32 v242, 16, v234
    v_and_b32 v243, 0xffff0000, v234
    v_add_f32 v240, v240, v242
    v_add_f32 v241, v241, v243
    v_cvt_pk_bf16_f32 v250, v240, v241
    v_cvt_pk_bf16_f32 v244, v174, v175
    v_lshlrev_b32 v240, 16, v244
    v_and_b32 v241, 0xffff0000, v244
    v_lshlrev_b32 v242, 16, v235
    v_and_b32 v243, 0xffff0000, v235
    v_add_f32 v240, v240, v242
    v_add_f32 v241, v241, v243
    v_cvt_pk_bf16_f32 v251, v240, v241
    buffer_store_dwordx4 v[248:251], v12, s[16:19], 0 offen
    s_waitcnt lgkmcnt(4)
    v_add_f32 v200, v200, v208
    v_add_f32 v201, v201, v209
    v_add_f32 v202, v202, v210
    v_add_f32 v203, v203, v211
    v_add_f32 v204, v204, v212
    v_add_f32 v205, v205, v213
    v_add_f32 v206, v206, v214
    v_add_f32 v207, v207, v215
    s_waitcnt lgkmcnt(0)
    v_add_f32 v216, v216, v224
    v_add_f32 v217, v217, v225
    v_add_f32 v218, v218, v226
    v_add_f32 v219, v219, v227
    v_add_f32 v220, v220, v228
    v_add_f32 v221, v221, v229
    v_add_f32 v222, v222, v230
    v_add_f32 v223, v223, v231
    v_add_f32 v200, v200, v216
    v_add_f32 v201, v201, v217
    v_add_f32 v202, v202, v218
    v_add_f32 v203, v203, v219
    v_add_f32 v204, v204, v220
    v_add_f32 v205, v205, v221
    v_add_f32 v206, v206, v222
    v_add_f32 v207, v207, v223
    v_cvt_pk_bf16_f32 v244, v200, v201
    v_lshlrev_b32 v240, 16, v244
    v_and_b32 v241, 0xffff0000, v244
    v_lshlrev_b32 v242, 16, v236
    v_and_b32 v243, 0xffff0000, v236
    v_add_f32 v240, v240, v242
    v_add_f32 v241, v241, v243
    v_cvt_pk_bf16_f32 v252, v240, v241
    v_cvt_pk_bf16_f32 v244, v202, v203
    v_lshlrev_b32 v240, 16, v244
    v_and_b32 v241, 0xffff0000, v244
    v_lshlrev_b32 v242, 16, v237
    v_and_b32 v243, 0xffff0000, v237
    v_add_f32 v240, v240, v242
    v_add_f32 v241, v241, v243
    v_cvt_pk_bf16_f32 v253, v240, v241
    v_cvt_pk_bf16_f32 v244, v204, v205
    v_lshlrev_b32 v240, 16, v244
    v_and_b32 v241, 0xffff0000, v244
    v_lshlrev_b32 v242, 16, v238
    v_and_b32 v243, 0xffff0000, v238
    v_add_f32 v240, v240, v242
    v_add_f32 v241, v241, v243
    v_cvt_pk_bf16_f32 v254, v240, v241
    v_cvt_pk_bf16_f32 v244, v206, v207
    v_lshlrev_b32 v240, 16, v244
    v_and_b32 v241, 0xffff0000, v244
    v_lshlrev_b32 v242, 16, v239
    v_and_b32 v243, 0xffff0000, v239
    v_add_f32 v240, v240, v242
    v_add_f32 v241, v241, v243
    v_cvt_pk_bf16_f32 v255, v240, v241
    buffer_store_dwordx4 v[252:255], v12, s[16:19], s41 offen
    s_cmp_lg_u32 s100, 0
    s_cbranch_scc1 J_SLOW_next
    s_cmp_lg_u32 s96, 0
    s_cbranch_scc1 J_SLOW_end
KF_done:
    s_endpgm
J_LD3:
    s_nop 7
    s_nop 7
    v_and_b32 v1, 63, v0
    s_sleep 12
    s_load_dwordx2 s[16:17], s[0:1], 48
    s_mov_b32 s18, 0x1c0000
    s_mov_b32 s19, 0x00020000
    s_lshr_b32 s10, s2, 5
    s_lshl_b32 s10, s10, 7
    v_lshrrev_b32 v4, 5, v1
    v_lshlrev_b32 v4, 2, v4
    v_bfe_u32 v5, v1, 2, 2
    v_add_u32 v4, v4, v5
    v_lshlrev_b32 v4, 10, v4
    v_bfe_u32 v5, v1, 4, 1
    v_lshl_add_u32 v4, v5, 6, v4
    v_and_b32 v5, 3, v1
    v_lshl_add_u32 v4, v5, 4, v4
    v_add_u32 v17, s10, v4
    s_and_b32 s22, s3, 3
    s_mul_i32 s25, s22, 458752
    s_cmp_lt_u32 s3, 6
    s_cselect_b32 s10, 32, 40
    s_load_dwordx2 s[12:13], s[0:1], s10
    s_mov_b32 s14, 0x1c0000
    v_lshrrev_b32 v4, 2, v1
    v_mul_u32_u24 v4, 0xe00, v4
    v_lshrrev_b32 v5, 5, v1
    v_lshlrev_b32 v5, 1, v5
    v_and_b32 v8, 3, v1
    v_xor_b32 v5, v5, v8
    v_lshl_add_u32 v8, v5, 4, v4
    s_and_b32 s24, s3, 1
    s_mul_i32 s23, s24, 57344
    s_lshr_b32 s10, s2, 4
    s_mul_i32 s11, s10, 224
    s_add_u32 s23, s23, s11
    s_and_b32 s10, s10, 1
    s_lshl_b32 s10, s10, 5
    s_sub_u32 s23, s23, s10
    s_lshl_b32 s24, s24, 10
    s_bfe_u32 s10, s3, 0x10001
    s_lshl_b32 s10, s10, 13
    s_add_u32 s24, s24, s10
    s_lshr_b32 s10, s2, 4
    s_mul_i32 s10, s10, 448
    s_bfe_u32 s11, s3, 0x10001
    s_mul_i32 s30, s11, 7168
    s_add_u32 s10, s10, s30
    s_add_u32 s10, s10, 0x1440000
    s_mul_i32 s11, s11, 448
    s_add_u32 s11, s11, 155648
    v_and_b32 v4, 31, v1
    v_lshlrev_b32 v4, 4, v4
    v_add_u32 v6, s11, v4
    v_lshrrev_b32 v5, 5, v1
    v_mul_u32_u24 v5, 114688, v5
    v_add_u32 v4, v4, v5
    s_add_u32 s30, s10, 0
    buffer_load_dwordx4 v[32:35], v4, s[4:7], s30 offen
    s_add_u32 s30, s10, 14336
    buffer_load_dwordx4 v[36:39], v4, s[4:7], s30 offen
    s_add_u32 s30, s10, 28672
    buffer_load_dwordx4 v[40:43], v4, s[4:7], s30 offen
    s_add_u32 s30, s10, 43008
    buffer_load_dwordx4 v[44:47], v4, s[4:7], s30 offen
    s_add_u32 s30, s10, 57344
    buffer_load_dwordx4 v[48:51], v4, s[4:7], s30 offen
    s_add_u32 s30, s10, 71680
    buffer_load_dwordx4 v[52:55], v4, s[4:7], s30 offen
    s_add_u32 s30, s10, 86016
    buffer_load_dwordx4 v[56:59], v4, s[4:7], s30 offen
    s_add_u32 s30, s10, 100352
    buffer_load_dwordx4 v[60:63], v4, s[4:7], s30 offen
    s_waitcnt lgkmcnt(0)
    s_add_u32 s30, s23, 0
    s_add_u32 m0, s24, 73728
    s_nop 0
    buffer_load_dwordx4 v8, s[12:15], s30 offen lds
    s_add_u32 s30, s23, 64
    s_add_u32 m0, s24, 75776
    s_nop 0
    buffer_load_dwordx4 v8, s[12:15], s30 offen lds
    s_add_u32 s30, s23, 128
    s_add_u32 m0, s24, 77824
    s_nop 0
    buffer_load_dwordx4 v8, s[12:15], s30 offen lds
    s_add_u32 s30, s23, 192
    s_add_u32 m0, s24, 79872
    s_nop 0
    buffer_load_dwordx4 v8, s[12:15], s30 offen lds
    s_add_u32 s30, s23, 114688
    s_add_u32 m0, s24, 98304
    s_nop 0
    buffer_load_dwordx4 v8, s[12:15], s30 offen lds
    s_add_u32 s30, s23, 114752
    s_add_u32 m0, s24, 100352
    s_nop 0
    buffer_load_dwordx4 v8, s[12:15], s30 offen lds
    s_add_u32 s30, s23, 114816
    s_add_u32 m0, s24, 102400
    s_nop 0
    buffer_load_dwordx4 v8, s[12:15], s30 offen lds
    s_add_u32 s30, s23, 114880
    s_add_u32 m0, s24, 104448
    s_nop 0
    buffer_load_dwordx4 v8, s[12:15], s30 offen lds
    s_add_u32 s30, s23, 229376
    s_add_u32 m0, s24, 122880
    s_nop 0
    buffer_load_dwordx4 v8, s[12:15], s30 offen lds
    s_add_u32 s30, s23, 229440
    s_add_u32 m0, s24, 124928
    s_nop 0
    buffer_load_dwordx4 v8, s[12:15], s30 offen lds
    s_add_u32 s30, s23, 229504
    s_add_u32 m0, s24, 126976
    s_nop 0
    buffer_load_dwordx4 v8, s[12:15], s30 offen lds
    s_add_u32 s30, s23, 229568
    s_add_u32 m0, s24, 129024
    s_nop 0
    buffer_load_dwordx4 v8, s[12:15], s30 offen lds
    s_waitcnt lgkmcnt(0)
    s_add_u32 s30, s25, 294912
    buffer_load_dwordx4 v[64:67], v17, s[16:19], s30 offen
    s_add_u32 s30, s25, 303104
    buffer_load_dwordx4 v[68:71], v17, s[16:19], s30 offen
    s_add_u32 s30, s25, 311296
    buffer_load_dwordx4 v[72:75], v17, s[16:19], s30 offen
    s_add_u32 s30, s25, 319488
    buffer_load_dwordx4 v[76:79], v17, s[16:19], s30 offen
    s_add_u32 s30, s25, 327680
    buffer_load_dwordx4 v[80:83], v17, s[16:19], s30 offen
    s_add_u32 s30, s25, 335872
    buffer_load_dwordx4 v[84:87], v17, s[16:19], s30 offen
    s_add_u32 s30, s25, 344064
    buffer_load_dwordx4 v[88:91], v17, s[16:19], s30 offen
    s_add_u32 s30, s25, 352256
    buffer_load_dwordx4 v[92:95], v17, s[16:19], s30 offen
    s_add_u32 s30, s25, 360448
    buffer_load_dwordx4 v[96:99], v17, s[16:19], s30 offen
    s_add_u32 s30, s25, 368640
    buffer_load_dwordx4 v[100:103], v17, s[16:19], s30 offen
    s_barrier
    s_waitcnt vmcnt(28)
    v_add_f32 v32, v32, v36
    v_add_f32 v33, v33, v37
    v_add_f32 v34, v34, v38
    v_add_f32 v35, v35, v39
    s_waitcnt vmcnt(27)
    v_add_f32 v32, v32, v40
    v_add_f32 v33, v33, v41
    v_add_f32 v34, v34, v42
    v_add_f32 v35, v35, v43
    s_waitcnt vmcnt(26)
    v_add_f32 v32, v32, v44
    v_add_f32 v33, v33, v45
    v_add_f32 v34, v34, v46
    v_add_f32 v35, v35, v47
    s_waitcnt vmcnt(25)
    v_add_f32 v32, v32, v48
    v_add_f32 v33, v33, v49
    v_add_f32 v34, v34, v50
    v_add_f32 v35, v35, v51
    s_waitcnt vmcnt(24)
    v_add_f32 v32, v32, v52
    v_add_f32 v33, v33, v53
    v_add_f32 v34, v34, v54
    v_add_f32 v35, v35, v55
    s_waitcnt vmcnt(23)
    v_add_f32 v32, v32, v56
    v_add_f32 v33, v33, v57
    v_add_f32 v34, v34, v58
    v_add_f32 v35, v35, v59
    s_waitcnt vmcnt(22)
    v_add_f32 v32, v32, v60
    v_add_f32 v33, v33, v61
    v_add_f32 v34, v34, v62
    v_add_f32 v35, v35, v63
    v_mov_b32 v36, v32
    v_mov_b32 v37, v33
    v_mov_b32 v38, v34
    v_mov_b32 v39, v35
    v_permlane32_swap_b32 v32, v36
    v_permlane32_swap_b32 v33, v37
    v_permlane32_swap_b32 v34, v38
    v_permlane32_swap_b32 v35, v39
    v_add_f32 v32, v32, v36
    v_add_f32 v33, v33, v37
    v_add_f32 v34, v34, v38
    v_add_f32 v35, v35, v39
    s_mov_b64 exec, 0x0fffffff
    ds_write_b128 v6, v[32:35]
    s_mov_b64 exec, -1
    s_waitcnt lgkmcnt(0)
J_LD4:
    s_nop 7
    s_nop 7
    s_and_b32 s22, s3, 3
    s_cmp_lt_u32 s22, 2
    s_cselect_b32 s10, 32, 40
    s_load_dwordx2 s[16:17], s[0:1], s10
    s_load_dwordx2 s[12:13], s[0:1], 48
    v_and_b32 v1, 63, v0
    s_and_b32 s20, s2, 7
    s_lshl_b32 s20, s20, 1
    s_bfe_u32 s21, s2, 0x10003
    s_add_u32 s20, s20, s21
    s_lshl_b32 s23, s20, 17
    s_lshl_b32 s24, s22, 15
    s_add_u32 s23, s23, s24
    s_add_u32 s23, s23, 0x1200000
    v_lshlrev_b32 v4, 4, v1
    v_add_u32 v8, s23, v4
    s_lshl_b32 s29, s21, 6
    s_lshl_b32 s24, s22, 4
    s_add_u32 s29, s29, s24
    s_add_u32 s29, s29, s8
    s_add_u32 s29, s29, 384
    s_mov_b32 s48, 4096
    s_mov_b32 s49, 8192
    s_mov_b32 s50, 12288
    s_mov_b32 s51, 16384
    s_mov_b32 s52, 20480
    s_mov_b32 s53, 24576
    s_mov_b32 s54, 28672
    v_lshrrev_b32 v4, 2, v1
    v_mul_u32_u24 v4, 0xe00, v4
    v_lshrrev_b32 v5, 5, v1
    v_lshlrev_b32 v5, 1, v5
    v_and_b32 v16, 3, v1
    v_xor_b32 v5, v5, v16
    v_lshl_add_u32 v16, v5, 4, v4
    s_and_b32 s27, s3, 1
    s_mul_i32 s26, s27, 57344
    s_lshr_b32 s10, s2, 4
    s_mul_i32 s11, s10, 224
    s_add_u32 s26, s26, s11
    s_and_b32 s10, s10, 1
    s_lshl_b32 s10, s10, 5
    s_sub_u32 s26, s26, s10
    s_lshl_b32 s27, s27, 10
    s_bfe_u32 s10, s3, 0x10001
    s_lshl_b32 s10, s10, 13
    s_add_u32 s27, s27, s10
    s_lshl_b32 s28, s22, 11
    s_lshr_b32 s10, s2, 5
    s_lshl_b32 s10, s10, 7
    v_lshrrev_b32 v4, 5, v1
    v_lshlrev_b32 v4, 2, v4
    v_bfe_u32 v5, v1, 2, 2
    v_add_u32 v4, v4, v5
    v_lshlrev_b32 v4, 10, v4
    v_bfe_u32 v5, v1, 4, 1
    v_lshl_add_u32 v4, v5, 6, v4
    v_and_b32 v5, 3, v1
    v_lshl_add_u32 v4, v5, 4, v4
    v_add_u32 v17, s10, v4
    s_mul_i32 s25, s22, 458752
    v_lshlrev_b32 v18, 10, v1
    s_mov_b32 s40, 0x151e300
    s_waitcnt lgkmcnt(0)
    s_mov_b32 s18, 0x1c0000
    s_mov_b32 s19, 0x00020000
    s_mov_b32 s14, 0x1c0000
    s_mov_b32 s15, 0x00020000
    s_mov_b32 s30, 0
    s_mov_b64 exec, 1
LD4_poll:
    buffer_load_dwordx4 v[4:7], off, s[4:7], s29 sc1
    s_add_u32 s30, s30, 1
    s_waitcnt vmcnt(0)
    v_and_b32 v4, v4, v5
    v_and_b32 v6, v6, v7
    v_and_b32 v4, v4, v6
    s_nop 0
    v_readfirstlane_b32 s31, v4
    s_cmp_eq_u32 s31, 0x01010101
    s_cbranch_scc1 LD4_poll_x
    s_cmp_lt_u32 s30, 0x20000
    s_cbranch_scc1 LD4_poll
LD4_poll_x:
    s_mov_b64 exec, -1
    s_add_u32 m0, s28, 90112
    s_nop 0
    buffer_load_dwordx4 v8, s[4:7], 0 offen offset:0 lds
    s_add_u32 m0, s28, 91136
    s_nop 0
    buffer_load_dwordx4 v8, s[4:7], s51 offen offset:0 lds
    s_add_u32 m0, s28, 113664
    s_nop 0
    buffer_load_dwordx4 v8, s[4:7], 0 offen offset:1024 lds
    s_add_u32 m0, s28, 114688
    s_nop 0
    buffer_load_dwordx4 v8, s[4:7], s51 offen offset:1024 lds
    s_add_u32 m0, s28, 137216
    s_nop 0
    buffer_load_dwordx4 v8, s[4:7], 0 offen offset:2048 lds
    s_add_u32 m0, s28, 138240
    s_nop 0
    buffer_load_dwordx4 v8, s[4:7], s51 offen offset:2048 lds
    s_waitcnt vmcnt(4)
    s_barrier
    s_add_u32 m0, s28, 13312
    s_nop 0
    buffer_load_dwordx4 v8, s[4:7], 0 offen offset:3072 lds
    s_add_u32 m0, s28, 14336
    s_nop 0
    buffer_load_dwordx4 v8, s[4:7], s51 offen offset:3072 lds
    s_add_u32 s30, s26, 344064
    s_add_u32 m0, s27, 0
    s_nop 0
    buffer_load_dwordx4 v16, s[16:19], s30 offen lds
    s_add_u32 s30, s26, 344128
    s_add_u32 m0, s27, 2048
    s_nop 0
    buffer_load_dwordx4 v16, s[16:19], s30 offen lds
    s_add_u32 s30, s26, 344192
    s_add_u32 m0, s27, 4096
    s_nop 0
    buffer_load_dwordx4 v16, s[16:19], s30 offen lds
    s_add_u32 s30, s26, 344256
    s_add_u32 m0, s27, 6144
    s_nop 0
    buffer_load_dwordx4 v16, s[16:19], s30 offen lds
    s_add_u32 m0, s28, 40960
    s_nop 0
    buffer_load_dwordx4 v8, s[4:7], s48 offen offset:0 lds
    s_add_u32 m0, s28, 41984
    s_nop 0
    buffer_load_dwordx4 v8, s[4:7], s52 offen offset:0 lds
    s_add_u32 s30, s26, 458752
    s_add_u32 m0, s27, 24576
    s_nop 0
    buffer_load_dwordx4 v16, s[16:19], s30 offen lds
    s_add_u32 s30, s26, 458816
    s_add_u32 m0, s27, 26624
    s_nop 0
    buffer_load_dwordx4 v16, s[16:19], s30 offen lds
    s_add_u32 s30, s26, 458880
    s_add_u32 m0, s27, 28672
    s_nop 0
    buffer_load_dwordx4 v16, s[16:19], s30 offen lds
    s_add_u32 s30, s26, 458944
    s_add_u32 m0, s27, 30720
    s_nop 0
    buffer_load_dwordx4 v16, s[16:19], s30 offen lds
    s_waitcnt vmcnt(14)
    s_barrier
    s_add_u32 m0, s28, 64512
    s_nop 0
    buffer_load_dwordx4 v8, s[4:7], s48 offen offset:1024 lds
    s_add_u32 m0, s28, 65536
    s_nop 0
    buffer_load_dwordx4 v8, s[4:7], s52 offen offset:1024 lds
    s_add_u32 s30, s26, 573440
    s_add_u32 m0, s27, 49152
    s_nop 0
    buffer_load_dwordx4 v16, s[16:19], s30 offen lds
    s_add_u32 s30, s26, 573504
    s_add_u32 m0, s27, 51200
    s_nop 0
    buffer_load_dwordx4 v16, s[16:19], s30 offen lds
    s_add_u32 s30, s26, 573568
    s_add_u32 m0, s27, 53248
    s_nop 0
    buffer_load_dwordx4 v16, s[16:19], s30 offen lds
    s_add_u32 s30, s26, 573632
    s_add_u32 m0, s27, 55296
    s_nop 0
    buffer_load_dwordx4 v16, s[16:19], s30 offen lds
    s_add_u32 m0, s28, 88064
    s_nop 0
    buffer_load_dwordx4 v8, s[4:7], s48 offen offset:2048 lds
    s_add_u32 m0, s28, 89088
    s_nop 0
    buffer_load_dwordx4 v8, s[4:7], s52 offen offset:2048 lds
    s_add_u32 s30, s26, 688128
    s_add_u32 m0, s27, 73728
    s_nop 0
    buffer_load_dwordx4 v16, s[16:19], s30 offen lds
    s_add_u32 s30, s26, 688192
    s_add_u32 m0, s27, 75776
    s_nop 0
    buffer_load_dwordx4 v16, s[16:19], s30 offen lds
    s_add_u32 s30, s26, 688256
    s_add_u32 m0, s27, 77824
    s_nop 0
    buffer_load_dwordx4 v16, s[16:19], s30 offen lds
    s_add_u32 s30, s26, 688320
    s_add_u32 m0, s27, 79872
    s_nop 0
    buffer_load_dwordx4 v16, s[16:19], s30 offen lds
    s_waitcnt vmcnt(24)
    s_barrier
    s_add_u32 m0, s28, 111616
    s_nop 0
    buffer_load_dwordx4 v8, s[4:7], s48 offen offset:3072 lds
    s_add_u32 m0, s28, 112640
    s_nop 0
    buffer_load_dwordx4 v8, s[4:7], s52 offen offset:3072 lds
    s_add_u32 s30, s26, 802816
    s_add_u32 m0, s27, 98304
    s_nop 0
    buffer_load_dwordx4 v16, s[16:19], s30 offen lds
    s_add_u32 s30, s26, 802880
    s_add_u32 m0, s27, 100352
    s_nop 0
    buffer_load_dwordx4 v16, s[16:19], s30 offen lds
    s_add_u32 s30, s26, 802944
    s_add_u32 m0, s27, 102400
    s_nop 0
    buffer_load_dwordx4 v16, s[16:19], s30 offen lds
    s_add_u32 s30, s26, 803008
    s_add_u32 m0, s27, 104448
    s_nop 0
    buffer_load_dwordx4 v16, s[16:19], s30 offen lds
    s_waitcnt vmcnt(24)
    s_barrier
    s_add_u32 m0, s28, 139264
    s_nop 0
    buffer_load_dwordx4 v8, s[4:7], s49 offen offset:0 lds
    s_add_u32 m0, s28, 140288
    s_nop 0
    buffer_load_dwordx4 v8, s[4:7], s53 offen offset:0 lds
    s_add_u32 s30, s26, 917504
    s_add_u32 m0, s27, 122880
    s_nop 0
    buffer_load_dwordx4 v16, s[16:19], s30 offen lds
    s_add_u32 s30, s26, 917568
    s_add_u32 m0, s27, 124928
    s_nop 0
    buffer_load_dwordx4 v16, s[16:19], s30 offen lds
    s_add_u32 s30, s26, 917632
    s_add_u32 m0, s27, 126976
    s_nop 0
    buffer_load_dwordx4 v16, s[16:19], s30 offen lds
    s_add_u32 s30, s26, 917696
    s_add_u32 m0, s27, 129024
    s_nop 0
    buffer_load_dwordx4 v16, s[16:19], s30 offen lds
    s_waitcnt vmcnt(24)
    s_barrier
    s_add_u32 m0, s28, 15360
    s_nop 0
    buffer_load_dwordx4 v8, s[4:7], s49 offen offset:1024 lds
    s_add_u32 m0, s28, 16384
    s_nop 0
    buffer_load_dwordx4 v8, s[4:7], s53 offen offset:1024 lds
    s_add_u32 s30, s26, 1032192
    s_add_u32 m0, s27, 0
    s_nop 0
    buffer_load_dwordx4 v16, s[16:19], s30 offen lds
    s_add_u32 s30, s26, 1032256
    s_add_u32 m0, s27, 2048
    s_nop 0
    buffer_load_dwordx4 v16, s[16:19], s30 offen lds
    s_add_u32 s30, s26, 1032320
    s_add_u32 m0, s27, 4096
    s_nop 0
    buffer_load_dwordx4 v16, s[16:19], s30 offen lds
    s_add_u32 s30, s26, 1032384
    s_add_u32 m0, s27, 6144
    s_nop 0
    buffer_load_dwordx4 v16, s[16:19], s30 offen lds
    s_waitcnt vmcnt(24)
    s_barrier
    s_add_u32 m0, s28, 38912
    s_nop 0
    buffer_load_dwordx4 v8, s[4:7], s49 offen offset:2048 lds
    s_add_u32 m0, s28, 39936
    s_nop 0
    buffer_load_dwordx4 v8, s[4:7], s53 offen offset:2048 lds
    s_add_u32 s30, s26, 1146880
    s_add_u32 m0, s27, 24576
    s_nop 0
    buffer_load_dwordx4 v16, s[16:19], s30 offen lds
    s_add_u32 s30, s26, 1146944
    s_add_u32 m0, s27, 26624
    s_nop 0
    buffer_load_dwordx4 v16, s[16:19], s30 offen lds
    s_add_u32 s30, s26, 1147008
    s_add_u32 m0, s27, 28672
    s_nop 0
    buffer_load_dwordx4 v16, s[16:19], s30 offen lds
    s_add_u32 s30, s26, 1147072
    s_add_u32 m0, s27, 30720
    s_nop 0
    buffer_load_dwordx4 v16, s[16:19], s30 offen lds
    s_waitcnt vmcnt(24)
    s_barrier
    s_add_u32 m0, s28, 62464
    s_nop 0
    buffer_load_dwordx4 v8, s[4:7], s49 offen offset:3072 lds
    s_add_u32 m0, s28, 63488
    s_nop 0
    buffer_load_dwordx4 v8, s[4:7], s53 offen offset:3072 lds
    s_add_u32 s30, s26, 1261568
    s_add_u32 m0, s27, 49152
    s_nop 0
    buffer_load_dwordx4 v16, s[16:19], s30 offen lds
    s_add_u32 s30, s26, 1261632
    s_add_u32 m0, s27, 51200
    s_nop 0
    buffer_load_dwordx4 v16, s[16:19], s30 offen lds
    s_add_u32 s30, s26, 1261696
    s_add_u32 m0, s27, 53248
    s_nop 0
    buffer_load_dwordx4 v16, s[16:19], s30 offen lds
    s_add_u32 s30, s26, 1261760
    s_add_u32 m0, s27, 55296
    s_nop 0
    buffer_load_dwordx4 v16, s[16:19], s30 offen lds
    s_waitcnt vmcnt(24)
    s_barrier
    s_add_u32 m0, s28, 90112
    s_nop 0
    buffer_load_dwordx4 v8, s[4:7], s50 offen offset:0 lds
    s_add_u32 m0, s28, 91136
    s_nop 0
    buffer_load_dwordx4 v8, s[4:7], s54 offen offset:0 lds
    s_add_u32 s30, s26, 1376256
    s_add_u32 m0, s27, 73728
    s_nop 0
    buffer_load_dwordx4 v16, s[16:19], s30 offen lds
    s_add_u32 s30, s26, 1376320
    s_add_u32 m0, s27, 75776
    s_nop 0
    buffer_load_dwordx4 v16, s[16:19], s30 offen lds
    s_add_u32 s30, s26, 1376384
    s_add_u32 m0, s27, 77824
    s_nop 0
    buffer_load_dwordx4 v16, s[16:19], s30 offen lds
    s_add_u32 s30, s26, 1376448
    s_add_u32 m0, s27, 79872
    s_nop 0
    buffer_load_dwordx4 v16, s[16:19], s30 offen lds
    s_waitcnt vmcnt(24)
    s_barrier
    s_add_u32 m0, s28, 113664
    s_nop 0
    buffer_load_dwordx4 v8, s[4:7], s50 offen offset:1024 lds
    s_add_u32 m0, s28, 114688
    s_nop 0
    buffer_load_dwordx4 v8, s[4:7], s54 offen offset:1024 lds
    s_add_u32 s30, s26, 1490944
    s_add_u32 m0, s27, 98304
    s_nop 0
    buffer_load_dwordx4 v16, s[16:19], s30 offen lds
    s_add_u32 s30, s26, 1491008
    s_add_u32 m0, s27, 100352
    s_nop 0
    buffer_load_dwordx4 v16, s[16:19], s30 offen lds
    s_add_u32 s30, s26, 1491072
    s_add_u32 m0, s27, 102400
    s_nop 0
    buffer_load_dwordx4 v16, s[16:19], s30 offen lds
    s_add_u32 s30, s26, 1491136
    s_add_u32 m0, s27, 104448
    s_nop 0
    buffer_load_dwordx4 v16, s[16:19], s30 offen lds
    s_mov_b64 exec, 0xff
    buffer_load_dword v19, v18, s[4:7], s40 offen sc1
    s_mov_b64 exec, -1
    s_waitcnt vmcnt(25)
    s_barrier
    s_add_u32 m0, s28, 137216
    s_nop 0
    buffer_load_dwordx4 v8, s[4:7], s50 offen offset:2048 lds
    s_add_u32 m0, s28, 138240
    s_nop 0
    buffer_load_dwordx4 v8, s[4:7], s54 offen offset:2048 lds
    s_add_u32 s30, s26, 1605632
    s_add_u32 m0, s27, 122880
    s_nop 0
    buffer_load_dwordx4 v16, s[16:19], s30 offen lds
    s_add_u32 s30, s26, 1605696
    s_add_u32 m0, s27, 124928
    s_nop 0
    buffer_load_dwordx4 v16, s[16:19], s30 offen lds
    s_add_u32 s30, s26, 1605760
    s_add_u32 m0, s27, 126976
    s_nop 0
    buffer_load_dwordx4 v16, s[16:19], s30 offen lds
    s_add_u32 s30, s26, 1605824
    s_add_u32 m0, s27, 129024
    s_nop 0
    buffer_load_dwordx4 v16, s[16:19], s30 offen lds
    s_waitcnt vmcnt(25)
    s_barrier
    s_add_u32 m0, s28, 13312
    s_nop 0
    buffer_load_dwordx4 v8, s[4:7], s50 offen offset:3072 lds
    s_add_u32 m0, s28, 14336
    s_nop 0
    buffer_load_dwordx4 v8, s[4:7], s54 offen offset:3072 lds
    s_add_u32 s30, s26, 1720320
    s_add_u32 m0, s27, 0
    s_nop 0
    buffer_load_dwordx4 v16, s[16:19], s30 offen lds
    s_add_u32 s30, s26, 1720384
    s_add_u32 m0, s27, 2048
    s_nop 0
    buffer_load_dwordx4 v16, s[16:19], s30 offen lds
    s_add_u32 s30, s26, 1720448
    s_add_u32 m0, s27, 4096
    s_nop 0
    buffer_load_dwordx4 v16, s[16:19], s30 offen lds
    s_add_u32 s30, s26, 1720512
    s_add_u32 m0, s27, 6144
    s_nop 0
    buffer_load_dwordx4 v16, s[16:19], s30 offen lds
    s_waitcnt vmcnt(25)
    s_barrier
    s_add_u32 s30, s25, 0
    s_add_u32 m0, s28, 24576
    s_nop 0
    buffer_load_dwordx4 v17, s[12:15], s30 offen lds
    s_add_u32 s30, s25, 8192
    s_add_u32 m0, s28, 25600
    s_nop 0
    buffer_load_dwordx4 v17, s[12:15], s30 offen lds
    s_add_u32 s30, s25, 16384
    s_add_u32 m0, s28, 32768
    s_nop 0
    buffer_load_dwordx4 v17, s[12:15], s30 offen lds
    s_add_u32 s30, s25, 24576
    s_add_u32 m0, s28, 33792
    s_nop 0
    buffer_load_dwordx4 v17, s[12:15], s30 offen lds
    s_add_u32 s30, s25, 32768
    s_add_u32 m0, s28, 40960
    s_nop 0
    buffer_load_dwordx4 v17, s[12:15], s30 offen lds
    s_add_u32 s30, s25, 40960
    s_add_u32 m0, s28, 41984
    s_nop 0
    buffer_load_dwordx4 v17, s[12:15], s30 offen lds
    s_waitcnt vmcnt(25)
    s_barrier
    s_add_u32 s30, s25, 49152
    s_add_u32 m0, s28, 49152
    s_nop 0
    buffer_load_dwordx4 v17, s[12:15], s30 offen lds
    s_add_u32 s30, s25, 57344
    s_add_u32 m0, s28, 50176
    s_nop 0
    buffer_load_dwordx4 v17, s[12:15], s30 offen lds
    s_add_u32 s30, s25, 65536
    s_add_u32 m0, s28, 57344
    s_nop 0
    buffer_load_dwordx4 v17, s[12:15], s30 offen lds
    s_add_u32 s30, s25, 73728
    s_add_u32 m0, s28, 58368
    s_nop 0
    buffer_load_dwordx4 v17, s[12:15], s30 offen lds
    s_add_u32 s30, s25, 81920
    s_add_u32 m0, s28, 65536
    s_nop 0
    buffer_load_dwordx4 v17, s[12:15], s30 offen lds
    s_add_u32 s30, s25, 90112
    s_add_u32 m0, s28, 66560
    s_nop 0
    buffer_load_dwordx4 v17, s[12:15], s30 offen lds
    s_waitcnt vmcnt(25)
    s_barrier
    s_add_u32 s30, s25, 98304
    s_add_u32 m0, s28, 73728
    s_nop 0
    buffer_load_dwordx4 v17, s[12:15], s30 offen lds
    s_add_u32 s30, s25, 106496
    s_add_u32 m0, s28, 74752
    s_nop 0
    buffer_load_dwordx4 v17, s[12:15], s30 offen lds
    s_add_u32 s30, s25, 114688
    s_add_u32 m0, s28, 81920
    s_nop 0
    buffer_load_dwordx4 v17, s[12:15], s30 offen lds
    s_add_u32 s30, s25, 122880
    s_add_u32 m0, s28, 82944
    s_nop 0
    buffer_load_dwordx4 v17, s[12:15], s30 offen lds
    s_add_u32 s30, s25, 131072
    s_add_u32 m0, s28, 90112
    s_nop 0
    buffer_load_dwordx4 v17, s[12:15], s30 offen lds
    s_add_u32 s30, s25, 139264
    s_add_u32 m0, s28, 91136
    s_nop 0
    buffer_load_dwordx4 v17, s[12:15], s30 offen lds
    s_waitcnt vmcnt(24)
    s_barrier
    s_add_u32 s30, s25, 147456
    s_add_u32 m0, s28, 98304
    s_nop 0
    buffer_load_dwordx4 v17, s[12:15], s30 offen lds
    s_add_u32 s30, s25, 155648
    s_add_u32 m0, s28, 99328
    s_nop 0
    buffer_load_dwordx4 v17, s[12:15], s30 offen lds
    s_add_u32 s30, s25, 163840
    s_add_u32 m0, s28, 106496
    s_nop 0
    buffer_load_dwordx4 v17, s[12:15], s30 offen lds
    s_add_u32 s30, s25, 172032
    s_add_u32 m0, s28, 107520
    s_nop 0
    buffer_load_dwordx4 v17, s[12:15], s30 offen lds
    s_add_u32 s30, s25, 180224
    s_add_u32 m0, s28, 114688
    s_nop 0
    buffer_load_dwordx4 v17, s[12:15], s30 offen lds
    s_add_u32 s30, s25, 188416
    s_add_u32 m0, s28, 115712
    s_nop 0
    buffer_load_dwordx4 v17, s[12:15], s30 offen lds
    s_waitcnt vmcnt(24)
    s_barrier
    s_add_u32 s30, s25, 196608
    s_add_u32 m0, s28, 122880
    s_nop 0
    buffer_load_dwordx4 v17, s[12:15], s30 offen lds
    s_add_u32 s30, s25, 204800
    s_add_u32 m0, s28, 123904
    s_nop 0
    buffer_load_dwordx4 v17, s[12:15], s30 offen lds
    s_add_u32 s30, s25, 212992
    s_add_u32 m0, s28, 131072
    s_nop 0
    buffer_load_dwordx4 v17, s[12:15], s30 offen lds
    s_add_u32 s30, s25, 221184
    s_add_u32 m0, s28, 132096
    s_nop 0
    buffer_load_dwordx4 v17, s[12:15], s30 offen lds
    s_add_u32 s30, s25, 229376
    s_add_u32 m0, s28, 139264
    s_nop 0
    buffer_load_dwordx4 v17, s[12:15], s30 offen lds
    s_add_u32 s30, s25, 237568
    s_add_u32 m0, s28, 140288
    s_nop 0
    buffer_load_dwordx4 v17, s[12:15], s30 offen lds
    s_barrier
    s_cmp_lg_u32 s100, 0
    s_cbranch_scc1 J_SLOW_next
    s_add_u32 s30, s25, 245760
    s_add_u32 m0, s28, 0
    s_nop 0
    buffer_load_dwordx4 v17, s[12:15], s30 offen lds
    s_add_u32 s30, s25, 253952
    s_add_u32 m0, s28, 1024
    s_nop 0
    buffer_load_dwordx4 v17, s[12:15], s30 offen lds
    s_add_u32 s30, s25, 262144
    s_add_u32 m0, s28, 8192
    s_nop 0
    buffer_load_dwordx4 v17, s[12:15], s30 offen lds
    s_add_u32 s30, s25, 270336
    s_add_u32 m0, s28, 9216
    s_nop 0
    buffer_load_dwordx4 v17, s[12:15], s30 offen lds
    s_add_u32 s30, s25, 278528
    s_add_u32 m0, s28, 16384
    s_nop 0
    buffer_load_dwordx4 v17, s[12:15], s30 offen lds
    s_add_u32 s30, s25, 286720
    s_add_u32 m0, s28, 17408
    s_nop 0
    buffer_load_dwordx4 v17, s[12:15], s30 offen lds
    s_sleep 10
    s_add_u32 s30, s25, 376832
    buffer_load_dwordx4 v[104:107], v17, s[12:15], s30 offen
    s_add_u32 s30, s25, 385024
    buffer_load_dwordx4 v[108:111], v17, s[12:15], s30 offen
    s_sleep 10
    s_add_u32 s30, s25, 393216
    buffer_load_dwordx4 v[112:115], v17, s[12:15], s30 offen
    s_add_u32 s30, s25, 401408
    buffer_load_dwordx4 v[116:119], v17, s[12:15], s30 offen
    s_waitcnt vmcnt(52)
    s_mov_b64 exec, 0xff
    v_cmp_eq_u32 vcc, 0, v19
    s_mov_b64 exec, -1
    v_mov_b32 v5, 0x26400
    s_and_b32 s10, vcc_lo, 0xff
    v_mov_b32 v4, s10
    s_cmp_lg_u32 s3, 4
    s_cbranch_scc1 LD4_nw
    ds_write_b32 v5, v4 offset:4
LD4_nw:
    s_and_b32 s11, s3, 3
    s_lshl_b32 s11, s11, 3
    s_add_u32 s11, s11, 0x26480
    v_mov_b32 v23, s11
    v_mov_b32 v20, 0
    v_mov_b32 v21, 0
    ds_write_b64 v23, v[20:21]
    s_waitcnt lgkmcnt(0)
    s_waitcnt vmcnt(4)
    s_waitcnt lgkmcnt(0)
    s_barrier
    ds_read_b32 v4, v5 offset:4
    s_waitcnt lgkmcnt(0)
    v_readfirstlane_b32 s10, v4
    s_add_u32 s30, s25, 409600
    buffer_load_dwordx4 v[120:123], v17, s[12:15], s30 offen
    s_add_u32 s30, s25, 417792
    buffer_load_dwordx4 v[124:127], v17, s[12:15], s30 offen
    s_add_u32 s30, s25, 425984
    buffer_load_dwordx4 v[128:131], v17, s[12:15], s30 offen
    s_add_u32 s30, s25, 434176
    buffer_load_dwordx4 v[132:135], v17, s[12:15], s30 offen
    s_add_u32 s30, s25, 442368
    buffer_load_dwordx4 v[136:139], v17, s[12:15], s30 offen
    s_add_u32 s30, s25, 450560
    buffer_load_dwordx4 v[140:143], v17, s[12:15], s30 offen
    v_lshlrev_b32 v20, 4, v1
    v_add_u32 v20, s28, v20
    v_add_u32 v20, 24576, v20
    v_add_u32 v21, 40960, v20
    s_waitcnt vmcnt(0)
LD5_z:
    s_sleep 2
    ds_read_b32 v22, v23
    s_waitcnt lgkmcnt(0)
    v_readfirstlane_b32 s11, v22
    s_cmp_eq_u32 s11, 1
    s_cbranch_scc0 LD5_z
    ds_write_b128 v20, v[64:67] offset:0
    ds_write_b128 v20, v[68:71] offset:1024
    ds_write_b128 v20, v[72:75] offset:8192
    ds_write_b128 v20, v[76:79] offset:9216
    ds_write_b128 v20, v[80:83] offset:16384
    ds_write_b128 v20, v[84:87] offset:17408
    ds_write_b128 v20, v[88:91] offset:24576
    ds_write_b128 v20, v[92:95] offset:25600
    ds_write_b128 v20, v[96:99] offset:32768
    ds_write_b128 v20, v[100:103] offset:33792
    ds_write_b128 v21, v[104:107] offset:0
    ds_write_b128 v21, v[108:111] offset:1024
    ds_write_b128 v21, v[112:115] offset:8192
    ds_write_b128 v21, v[116:119] offset:9216
    ds_write_b128 v21, v[120:123] offset:16384
    ds_write_b128 v21, v[124:127] offset:17408
    ds_write_b128 v21, v[128:131] offset:24576
    ds_write_b128 v21, v[132:135] offset:25600
    ds_write_b128 v21, v[136:139] offset:32768
    ds_write_b128 v21, v[140:143] offset:33792
    s_waitcnt lgkmcnt(0)
    ds_write_b32 v23, v22 offset:4
    s_waitcnt lgkmcnt(0)
    s_cmp_lg_u32 s10, 0
    s_cbranch_scc1 LD4_steal
    s_endpgm
LD4_steal:
    s_barrier
    s_branch J_SLOW_end
J_SLOW_start:
    s_nop 7
    s_nop 7
    s_lshr_b32 s11, s2, 3
    s_lshl_b32 s9, 1, s11
    s_bitcmp1_b32 s10, 0
    s_cselect_b32 s9, 0, s9
    s_mov_b32 s100, 1
    s_mov_b32 s97, 48
J_SLOW_claim:
    s_nop 7
    s_nop 7
    s_waitcnt vmcnt(0) lgkmcnt(0)
    s_barrier
    s_cmp_lg_u32 s3, 0
    s_cbranch_scc1 SL_c9
    s_mov_b64 exec, 1
    s_mov_b32 s30, 0
    s_mov_b32 s31, 0
J_SL_c1:
    s_nop 7
    s_nop 7
    v_mov_b32 v4, 0
    buffer_atomic_or v4, off, s[4:7], s8 sc0
    s_add_u32 s31, s31, 1
    s_waitcnt vmcnt(0)
    v_readfirstlane_b32 s10, v4
    s_mov_b32 s11, -1
    s_cmp_eq_u32 s10, -1
    s_cbranch_scc1 SL_c8
    s_cmp_gt_u32 s31, 4096
    s_cbranch_scc1 SL_c8
    s_cmp_eq_u32 s9, 0
    s_cbranch_scc1 SL_c2
    s_cmp_ge_u32 s30, s97
    s_cbranch_scc1 SL_c2
    s_add_u32 s30, s30, 1
    s_sleep 16
    s_branch J_SL_c1
SL_c2:
    s_ff0_i32_b32 s11, s10
    s_lshl_b32 s10, 1, s11
    v_mov_b32 v4, s10
    buffer_atomic_or v4, off, s[4:7], s8 sc0
    s_waitcnt vmcnt(0)
    v_readfirstlane_b32 s12, v4
    s_and_b32 s12, s12, s10
    s_cmp_lg_u32 s12, 0
    s_cbranch_scc1 J_SL_c1
SL_c8:
    v_mov_b32 v4, s11
    v_mov_b32 v5, 0x26400
    ds_write_b32 v5, v4 offset:8
    s_mov_b64 exec, -1
    s_waitcnt lgkmcnt(0)
SL_c9:
    v_mov_b32 v5, 0x26400
    s_barrier
    ds_read_b32 v4, v5 offset:8
    s_waitcnt lgkmcnt(0)
    v_readfirstlane_b32 s10, v4
    s_cmp_eq_u32 s10, -1
    s_cbranch_scc1 SL_ph
    s_and_b32 s10, s10, 31
    s_lshl_b32 s11, 1, s10
    s_or_b32 s9, s9, s11
    s_and_b32 s2, s2, 7
    s_lshl_b32 s10, s10, 3
    s_or_b32 s2, s2, s10
    s_branch J_P2
SL_ph:
    s_mov_b32 s100, 3
    s_mov_b32 s101, s9
J_SLOW_next:
    s_nop 7
    s_nop 7
    s_waitcnt vmcnt(0) lgkmcnt(0)
    s_barrier
    s_cmp_lg_u32 s101, 0
    s_cbranch_scc1 SL_n1
    s_add_u32 s100, s100, 1
    s_mov_b32 s101, s9
    s_cmp_gt_u32 s100, 5
    s_cbranch_scc1 J_SLOW_end
    s_branch J_SLOW_next
SL_n1:
    s_ff1_i32_b32 s10, s101
    s_bitset0_b32 s101, s10
    s_and_b32 s2, s2, 7
    s_lshl_b32 s10, s10, 3
    s_or_b32 s2, s2, s10
    v_and_b32 v1, 63, v0
    s_cmp_ge_u32 s3, 4
    s_cbranch_scc1 SL_ld
    s_cmp_eq_u32 s100, 4
    s_cbranch_scc1 J_P4
    s_cmp_eq_u32 s100, 5
    s_cbranch_scc1 J_P5
    s_load_dwordx2 s[12:13], s[0:1], 16
    s_mov_b32 s14, 0x80000
    s_mov_b32 s15, 0x00020000
    s_waitcnt lgkmcnt(0)
    s_lshr_b32 s10, s2, 5
    s_lshl_b32 s10, s10, 7
    v_lshrrev_b32 v4, 5, v1
    v_lshlrev_b32 v4, 2, v4
    v_bfe_u32 v5, v1, 2, 2
    v_add_u32 v4, v4, v5
    v_lshlrev_b32 v4, 10, v4
    v_bfe_u32 v5, v1, 4, 1
    v_lshl_add_u32 v4, v5, 6, v4
    v_and_b32 v5, 3, v1
    v_lshl_add_u32 v4, v5, 4, v4
    v_add_u32 v8, s10, v4
    s_lshl_b32 s10, s3, 17
    s_lshl_b32 s11, s3, 14
    s_add_u32 s30, s10, 0
    s_add_u32 m0, s11, 0
    s_nop 0
    buffer_load_dwordx4 v8, s[12:15], s30 offen lds
    s_add_u32 s30, s10, 8192
    s_add_u32 m0, s11, 1024
    s_nop 0
    buffer_load_dwordx4 v8, s[12:15], s30 offen lds
    s_add_u32 s30, s10, 16384
    s_add_u32 m0, s11, 2048
    s_nop 0
    buffer_load_dwordx4 v8, s[12:15], s30 offen lds
    s_add_u32 s30, s10, 24576
    s_add_u32 m0, s11, 3072
    s_nop 0
    buffer_load_dwordx4 v8, s[12:15], s30 offen lds
    s_add_u32 s30, s10, 32768
    s_add_u32 m0, s11, 4096
    s_nop 0
    buffer_load_dwordx4 v8, s[12:15], s30 offen lds
    s_add_u32 s30, s10, 40960
    s_add_u32 m0, s11, 5120
    s_nop 0
    buffer_load_dwordx4 v8, s[12:15], s30 offen lds
    s_add_u32 s30, s10, 49152
    s_add_u32 m0, s11, 6144
    s_nop 0
    buffer_load_dwordx4 v8, s[12:15], s30 offen lds
    s_add_u32 s30, s10, 57344
    s_add_u32 m0, s11, 7168
    s_nop 0
    buffer_load_dwordx4 v8, s[12:15], s30 offen lds
    s_add_u32 s30, s10, 65536
    s_add_u32 m0, s11, 8192
    s_nop 0
    buffer_load_dwordx4 v8, s[12:15], s30 offen lds
    s_add_u32 s30, s10, 73728
    s_add_u32 m0, s11, 9216
    s_nop 0
    buffer_load_dwordx4 v8, s[12:15], s30 offen lds
    s_add_u32 s30, s10, 81920
    s_add_u32 m0, s11, 10240
    s_nop 0
    buffer_load_dwordx4 v8, s[12:15], s30 offen lds
    s_add_u32 s30, s10, 90112
    s_add_u32 m0, s11, 11264
    s_nop 0
    buffer_load_dwordx4 v8, s[12:15], s30 offen lds
    s_add_u32 s30, s10, 98304
    s_add_u32 m0, s11, 12288
    s_nop 0
    buffer_load_dwordx4 v8, s[12:15], s30 offen lds
    s_add_u32 s30, s10, 106496
    s_add_u32 m0, s11, 13312
    s_nop 0
    buffer_load_dwordx4 v8, s[12:15], s30 offen lds
    s_add_u32 s30, s10, 114688
    s_add_u32 m0, s11, 14336
    s_nop 0
    buffer_load_dwordx4 v8, s[12:15], s30 offen lds
    s_add_u32 s30, s10, 122880
    s_add_u32 m0, s11, 15360
    s_nop 0
    buffer_load_dwordx4 v8, s[12:15], s30 offen lds
    s_waitcnt vmcnt(0)
    s_branch J_P3
SL_ld:
    s_cmp_eq_u32 s100, 3
    s_cbranch_scc1 SL_l3
    s_cmp_eq_u32 s100, 5
    s_cbranch_scc1 SL_l5
    s_cmp_lt_u32 s3, 6
    s_cselect_b32 s10, 32, 40
    s_load_dwordx2 s[12:13], s[0:1], s10
    s_mov_b32 s14, 0x1c0000
    s_mov_b32 s15, 0x00020000
    v_lshrrev_b32 v4, 2, v1
    v_mul_u32_u24 v4, 0xe00, v4
    v_lshrrev_b32 v5, 5, v1
    v_lshlrev_b32 v5, 1, v5
    v_and_b32 v8, 3, v1
    v_xor_b32 v5, v5, v8
    v_lshl_add_u32 v8, v5, 4, v4
    s_and_b32 s24, s3, 1
    s_mul_i32 s23, s24, 57344
    s_lshr_b32 s10, s2, 4
    s_mul_i32 s11, s10, 224
    s_add_u32 s23, s23, s11
    s_and_b32 s10, s10, 1
    s_lshl_b32 s10, s10, 5
    s_sub_u32 s23, s23, s10
    s_lshl_b32 s24, s24, 10
    s_bfe_u32 s10, s3, 0x10001
    s_lshl_b32 s10, s10, 13
    s_add_u32 s24, s24, s10
    s_waitcnt lgkmcnt(0)
    s_add_u32 s30, s23, 0
    s_add_u32 m0, s24, 73728
    s_nop 0
    buffer_load_dwordx4 v8, s[12:15], s30 offen lds
    s_add_u32 s30, s23, 64
    s_add_u32 m0, s24, 75776
    s_nop 0
    buffer_load_dwordx4 v8, s[12:15], s30 offen lds
    s_add_u32 s30, s23, 128
    s_add_u32 m0, s24, 77824
    s_nop 0
    buffer_load_dwordx4 v8, s[12:15], s30 offen lds
    s_add_u32 s30, s23, 192
    s_add_u32 m0, s24, 79872
    s_nop 0
    buffer_load_dwordx4 v8, s[12:15], s30 offen lds
    s_add_u32 s30, s23, 114688
    s_add_u32 m0, s24, 98304
    s_nop 0
    buffer_load_dwordx4 v8, s[12:15], s30 offen lds
    s_add_u32 s30, s23, 114752
    s_add_u32 m0, s24, 100352
    s_nop 0
    buffer_load_dwordx4 v8, s[12:15], s30 offen lds
    s_add_u32 s30, s23, 114816
    s_add_u32 m0, s24, 102400
    s_nop 0
    buffer_load_dwordx4 v8, s[12:15], s30 offen lds
    s_add_u32 s30, s23, 114880
    s_add_u32 m0, s24, 104448
    s_nop 0
    buffer_load_dwordx4 v8, s[12:15], s30 offen lds
    s_add_u32 s30, s23, 229376
    s_add_u32 m0, s24, 122880
    s_nop 0
    buffer_load_dwordx4 v8, s[12:15], s30 offen lds
    s_add_u32 s30, s23, 229440
    s_add_u32 m0, s24, 124928
    s_nop 0
    buffer_load_dwordx4 v8, s[12:15], s30 offen lds
    s_add_u32 s30, s23, 229504
    s_add_u32 m0, s24, 126976
    s_nop 0
    buffer_load_dwordx4 v8, s[12:15], s30 offen lds
    s_add_u32 s30, s23, 229568
    s_add_u32 m0, s24, 129024
    s_nop 0
    buffer_load_dwordx4 v8, s[12:15], s30 offen lds
    s_lshr_b32 s10, s2, 4
    s_mul_i32 s10, s10, 448
    s_bfe_u32 s11, s3, 0x10001
    s_mul_i32 s30, s11, 7168
    s_add_u32 s10, s10, s30
    s_add_u32 s10, s10, 0x1440000
    s_mul_i32 s11, s11, 448
    s_add_u32 s11, s11, 155648
    v_and_b32 v4, 31, v1
    v_lshlrev_b32 v4, 4, v4
    v_add_u32 v6, s11, v4
    v_lshrrev_b32 v5, 5, v1
    v_mul_u32_u24 v5, 114688, v5
    v_add_u32 v4, v4, v5
    s_add_u32 s30, s10, 0
    buffer_load_dwordx4 v[32:35], v4, s[4:7], s30 offen
    s_add_u32 s30, s10, 14336
    buffer_load_dwordx4 v[36:39], v4, s[4:7], s30 offen
    s_add_u32 s30, s10, 28672
    buffer_load_dwordx4 v[40:43], v4, s[4:7], s30 offen
    s_add_u32 s30, s10, 43008
    buffer_load_dwordx4 v[44:47], v4, s[4:7], s30 offen
    s_add_u32 s30, s10, 57344
    buffer_load_dwordx4 v[48:51], v4, s[4:7], s30 offen
    s_add_u32 s30, s10, 71680
    buffer_load_dwordx4 v[52:55], v4, s[4:7], s30 offen
    s_add_u32 s30, s10, 86016
    buffer_load_dwordx4 v[56:59], v4, s[4:7], s30 offen
    s_add_u32 s30, s10, 100352
    buffer_load_dwordx4 v[60:63], v4, s[4:7], s30 offen
    s_waitcnt vmcnt(6)
    v_add_f32 v32, v32, v36
    v_add_f32 v33, v33, v37
    v_add_f32 v34, v34, v38
    v_add_f32 v35, v35, v39
    s_waitcnt vmcnt(5)
    v_add_f32 v32, v32, v40
    v_add_f32 v33, v33, v41
    v_add_f32 v34, v34, v42
    v_add_f32 v35, v35, v43
    s_waitcnt vmcnt(4)
    v_add_f32 v32, v32, v44
    v_add_f32 v33, v33, v45
    v_add_f32 v34, v34, v46
    v_add_f32 v35, v35, v47
    s_waitcnt vmcnt(3)
    v_add_f32 v32, v32, v48
    v_add_f32 v33, v33, v49
    v_add_f32 v34, v34, v50
    v_add_f32 v35, v35, v51
    s_waitcnt vmcnt(2)
    v_add_f32 v32, v32, v52
    v_add_f32 v33, v33, v53
    v_add_f32 v34, v34, v54
    v_add_f32 v35, v35, v55
    s_waitcnt vmcnt(1)
    v_add_f32 v32, v32, v56
    v_add_f32 v33, v33, v57
    v_add_f32 v34, v34, v58
    v_add_f32 v35, v35, v59
    s_waitcnt vmcnt(0)
    v_add_f32 v32, v32, v60
    v_add_f32 v33, v33, v61
    v_add_f32 v34, v34, v62
    v_add_f32 v35, v35, v63
    v_mov_b32 v36, v32
    v_mov_b32 v37, v33
    v_mov_b32 v38, v34
    v_mov_b32 v39, v35
    v_permlane32_swap_b32 v32, v36
    v_permlane32_swap_b32 v33, v37
    v_permlane32_swap_b32 v34, v38
    v_permlane32_swap_b32 v35, v39
    v_add_f32 v32, v32, v36
    v_add_f32 v33, v33, v37
    v_add_f32 v34, v34, v38
    v_add_f32 v35, v35, v39
    s_mov_b64 exec, 0x0fffffff
    ds_write_b128 v6, v[32:35]
    s_mov_b64 exec, -1
    s_waitcnt lgkmcnt(0)
    s_branch J_LD4
SL_l5:
    s_load_dwordx2 s[12:13], s[0:1], 48
    s_mov_b32 s14, 0x1c0000
    s_mov_b32 s15, 0x00020000
    s_lshr_b32 s10, s2, 5
    s_lshl_b32 s10, s10, 7
    v_lshrrev_b32 v4, 5, v1
    v_lshlrev_b32 v4, 2, v4
    v_bfe_u32 v5, v1, 2, 2
    v_add_u32 v4, v4, v5
    v_lshlrev_b32 v4, 10, v4
    v_bfe_u32 v5, v1, 4, 1
    v_lshl_add_u32 v4, v5, 6, v4
    v_and_b32 v5, 3, v1
    v_lshl_add_u32 v4, v5, 4, v4
    v_add_u32 v8, s10, v4
    s_and_b32 s22, s3, 3
    s_mul_i32 s25, s22, 458752
    s_lshl_b32 s28, s22, 11
    s_waitcnt lgkmcnt(0)
    s_add_u32 s30, s25, 0
    s_add_u32 m0, s28, 24576
    s_nop 0
    buffer_load_dwordx4 v8, s[12:15], s30 offen lds
    s_add_u32 s30, s25, 8192
    s_add_u32 m0, s28, 25600
    s_nop 0
    buffer_load_dwordx4 v8, s[12:15], s30 offen lds
    s_add_u32 s30, s25, 16384
    s_add_u32 m0, s28, 32768
    s_nop 0
    buffer_load_dwordx4 v8, s[12:15], s30 offen lds
    s_add_u32 s30, s25, 24576
    s_add_u32 m0, s28, 33792
    s_nop 0
    buffer_load_dwordx4 v8, s[12:15], s30 offen lds
    s_add_u32 s30, s25, 32768
    s_add_u32 m0, s28, 40960
    s_nop 0
    buffer_load_dwordx4 v8, s[12:15], s30 offen lds
    s_add_u32 s30, s25, 40960
    s_add_u32 m0, s28, 41984
    s_nop 0
    buffer_load_dwordx4 v8, s[12:15], s30 offen lds
    s_add_u32 s30, s25, 49152
    s_add_u32 m0, s28, 49152
    s_nop 0
    buffer_load_dwordx4 v8, s[12:15], s30 offen lds
    s_add_u32 s30, s25, 57344
    s_add_u32 m0, s28, 50176
    s_nop 0
    buffer_load_dwordx4 v8, s[12:15], s30 offen lds
    s_add_u32 s30, s25, 65536
    s_add_u32 m0, s28, 57344
    s_nop 0
    buffer_load_dwordx4 v8, s[12:15], s30 offen lds
    s_add_u32 s30, s25, 73728
    s_add_u32 m0, s28, 58368
    s_nop 0
    buffer_load_dwordx4 v8, s[12:15], s30 offen lds
    s_add_u32 s30, s25, 81920
    s_add_u32 m0, s28, 65536
    s_nop 0
    buffer_load_dwordx4 v8, s[12:15], s30 offen lds
    s_add_u32 s30, s25, 90112
    s_add_u32 m0, s28, 66560
    s_nop 0
    buffer_load_dwordx4 v8, s[12:15], s30 offen lds
    s_add_u32 s30, s25, 98304
    s_add_u32 m0, s28, 73728
    s_nop 0
    buffer_load_dwordx4 v8, s[12:15], s30 offen lds
    s_add_u32 s30, s25, 106496
    s_add_u32 m0, s28, 74752
    s_nop 0
    buffer_load_dwordx4 v8, s[12:15], s30 offen lds
    s_add_u32 s30, s25, 114688
    s_add_u32 m0, s28, 81920
    s_nop 0
    buffer_load_dwordx4 v8, s[12:15], s30 offen lds
    s_add_u32 s30, s25, 122880
    s_add_u32 m0, s28, 82944
    s_nop 0
    buffer_load_dwordx4 v8, s[12:15], s30 offen lds
    s_add_u32 s30, s25, 131072
    s_add_u32 m0, s28, 90112
    s_nop 0
    buffer_load_dwordx4 v8, s[12:15], s30 offen lds
    s_add_u32 s30, s25, 139264
    s_add_u32 m0, s28, 91136
    s_nop 0
    buffer_load_dwordx4 v8, s[12:15], s30 offen lds
    s_add_u32 s30, s25, 147456
    s_add_u32 m0, s28, 98304
    s_nop 0
    buffer_load_dwordx4 v8, s[12:15], s30 offen lds
    s_add_u32 s30, s25, 155648
    s_add_u32 m0, s28, 99328
    s_nop 0
    buffer_load_dwordx4 v8, s[12:15], s30 offen lds
    s_add_u32 s30, s25, 163840
    s_add_u32 m0, s28, 106496
    s_nop 0
    buffer_load_dwordx4 v8, s[12:15], s30 offen lds
    s_add_u32 s30, s25, 172032
    s_add_u32 m0, s28, 107520
    s_nop 0
    buffer_load_dwordx4 v8, s[12:15], s30 offen lds
    s_add_u32 s30, s25, 180224
    s_add_u32 m0, s28, 114688
    s_nop 0
    buffer_load_dwordx4 v8, s[12:15], s30 offen lds
    s_add_u32 s30, s25, 188416
    s_add_u32 m0, s28, 115712
    s_nop 0
    buffer_load_dwordx4 v8, s[12:15], s30 offen lds
    s_add_u32 s30, s25, 196608
    s_add_u32 m0, s28, 122880
    s_nop 0
    buffer_load_dwordx4 v8, s[12:15], s30 offen lds
    s_add_u32 s30, s25, 204800
    s_add_u32 m0, s28, 123904
    s_nop 0
    buffer_load_dwordx4 v8, s[12:15], s30 offen lds
    s_add_u32 s30, s25, 212992
    s_add_u32 m0, s28, 131072
    s_nop 0
    buffer_load_dwordx4 v8, s[12:15], s30 offen lds
    s_add_u32 s30, s25, 221184
    s_add_u32 m0, s28, 132096
    s_nop 0
    buffer_load_dwordx4 v8, s[12:15], s30 offen lds
    s_add_u32 s30, s25, 229376
    s_add_u32 m0, s28, 139264
    s_nop 0
    buffer_load_dwordx4 v8, s[12:15], s30 offen lds
    s_add_u32 s30, s25, 237568
    s_add_u32 m0, s28, 140288
    s_nop 0
    buffer_load_dwordx4 v8, s[12:15], s30 offen lds
    s_add_u32 s30, s25, 245760
    s_add_u32 m0, s28, 0
    s_nop 0
    buffer_load_dwordx4 v8, s[12:15], s30 offen lds
    s_add_u32 s30, s25, 253952
    s_add_u32 m0, s28, 1024
    s_nop 0
    buffer_load_dwordx4 v8, s[12:15], s30 offen lds
    s_add_u32 s30, s25, 262144
    s_add_u32 m0, s28, 8192
    s_nop 0
    buffer_load_dwordx4 v8, s[12:15], s30 offen lds
    s_add_u32 s30, s25, 270336
    s_add_u32 m0, s28, 9216
    s_nop 0
    buffer_load_dwordx4 v8, s[12:15], s30 offen lds
    s_add_u32 s30, s25, 278528
    s_add_u32 m0, s28, 16384
    s_nop 0
    buffer_load_dwordx4 v8, s[12:15], s30 offen lds
    s_add_u32 s30, s25, 286720
    s_add_u32 m0, s28, 17408
    s_nop 0
    buffer_load_dwordx4 v8, s[12:15], s30 offen lds
    s_add_u32 s30, s25, 294912
    buffer_load_dwordx4 v[64:67], v8, s[12:15], s30 offen
    s_add_u32 s30, s25, 303104
    buffer_load_dwordx4 v[68:71], v8, s[12:15], s30 offen
    s_add_u32 s30, s25, 311296
    buffer_load_dwordx4 v[72:75], v8, s[12:15], s30 offen
    s_add_u32 s30, s25, 319488
    buffer_load_dwordx4 v[76:79], v8, s[12:15], s30 offen
    s_add_u32 s30, s25, 327680
    buffer_load_dwordx4 v[80:83], v8, s[12:15], s30 offen
    s_add_u32 s30, s25, 335872
    buffer_load_dwordx4 v[84:87], v8, s[12:15], s30 offen
    s_add_u32 s30, s25, 344064
    buffer_load_dwordx4 v[88:91], v8, s[12:15], s30 offen
    s_add_u32 s30, s25, 352256
    buffer_load_dwordx4 v[92:95], v8, s[12:15], s30 offen
    s_add_u32 s30, s25, 360448
    buffer_load_dwordx4 v[96:99], v8, s[12:15], s30 offen
    s_add_u32 s30, s25, 368640
    buffer_load_dwordx4 v[100:103], v8, s[12:15], s30 offen
    s_add_u32 s30, s25, 376832
    buffer_load_dwordx4 v[104:107], v8, s[12:15], s30 offen
    s_add_u32 s30, s25, 385024
    buffer_load_dwordx4 v[108:111], v8, s[12:15], s30 offen
    s_add_u32 s30, s25, 393216
    buffer_load_dwordx4 v[112:115], v8, s[12:15], s30 offen
    s_add_u32 s30, s25, 401408
    buffer_load_dwordx4 v[116:119], v8, s[12:15], s30 offen
    s_add_u32 s30, s25, 409600
    buffer_load_dwordx4 v[120:123], v8, s[12:15], s30 offen
    s_add_u32 s30, s25, 417792
    buffer_load_dwordx4 v[124:127], v8, s[12:15], s30 offen
    s_add_u32 s30, s25, 425984
    buffer_load_dwordx4 v[128:131], v8, s[12:15], s30 offen
    s_add_u32 s30, s25, 434176
    buffer_load_dwordx4 v[132:135], v8, s[12:15], s30 offen
    s_add_u32 s30, s25, 442368
    buffer_load_dwordx4 v[136:139], v8, s[12:15], s30 offen
    s_add_u32 s30, s25, 450560
    buffer_load_dwordx4 v[140:143], v8, s[12:15], s30 offen
    s_and_b32 s11, s3, 3
    s_lshl_b32 s11, s11, 3
    s_add_u32 s11, s11, 0x26480
    v_mov_b32 v23, s11
    v_mov_b32 v20, 0
    v_mov_b32 v21, 0
    ds_write_b64 v23, v[20:21]
    s_waitcnt lgkmcnt(0)
    s_waitcnt vmcnt(0)
    s_barrier
    v_lshlrev_b32 v20, 4, v1
    v_add_u32 v20, s28, v20
    v_add_u32 v20, 24576, v20
    v_add_u32 v21, 40960, v20
    s_waitcnt vmcnt(0)
SL5_z:
    s_sleep 2
    ds_read_b32 v22, v23
    s_waitcnt lgkmcnt(0)
    v_readfirstlane_b32 s11, v22
    s_cmp_eq_u32 s11, 1
    s_cbranch_scc0 SL5_z
    ds_write_b128 v20, v[64:67] offset:0
    ds_write_b128 v20, v[68:71] offset:1024
    ds_write_b128 v20, v[72:75] offset:8192
    ds_write_b128 v20, v[76:79] offset:9216
    ds_write_b128 v20, v[80:83] offset:16384
    ds_write_b128 v20, v[84:87] offset:17408
    ds_write_b128 v20, v[88:91] offset:24576
    ds_write_b128 v20, v[92:95] offset:25600
    ds_write_b128 v20, v[96:99] offset:32768
    ds_write_b128 v20, v[100:103] offset:33792
    ds_write_b128 v21, v[104:107] offset:0
    ds_write_b128 v21, v[108:111] offset:1024
    ds_write_b128 v21, v[112:115] offset:8192
    ds_write_b128 v21, v[116:119] offset:9216
    ds_write_b128 v21, v[120:123] offset:16384
    ds_write_b128 v21, v[124:127] offset:17408
    ds_write_b128 v21, v[128:131] offset:24576
    ds_write_b128 v21, v[132:135] offset:25600
    ds_write_b128 v21, v[136:139] offset:32768
    ds_write_b128 v21, v[140:143] offset:33792
    s_waitcnt lgkmcnt(0)
    ds_write_b32 v23, v22 offset:4
    s_waitcnt lgkmcnt(0)
SL_l3:
    s_barrier
    s_branch J_SLOW_next
J_SLOW_end:
    s_nop 7
    s_nop 7
    s_waitcnt vmcnt(0) lgkmcnt(0)
    s_barrier
    s_cmp_lg_u32 s3, 0
    s_cbranch_scc1 SL_e9
    v_and_b32 v1, 63, v0
    v_lshlrev_b32 v6, 10, v1
    s_mov_b32 s11, 0x151e300
    s_mov_b64 exec, 0xff
    buffer_load_dword v4, v6, s[4:7], s11 offen sc1
    s_waitcnt vmcnt(0)
    v_cmp_eq_u32 vcc, 0, v4
    s_mov_b64 exec, 1
    s_and_b32 s10, vcc_lo, 0xff
    s_ff1_i32_b32 s10, s10
    s_cmp_eq_u32 s10, -1
    s_cbranch_scc1 SL_e8
    s_lshl_b32 s12, s10, 10
    s_add_u32 s11, s11, s12
    v_mov_b32 v4, 1
    buffer_store_dword v4, off, s[4:7], s11 sc1
    s_waitcnt vmcnt(0)
SL_e8:
    v_mov_b32 v4, s10
    v_mov_b32 v5, 0x26400
    ds_write_b32 v5, v4 offset:12
    s_mov_b64 exec, -1
    s_waitcnt lgkmcnt(0)
SL_e9:
    v_mov_b32 v5, 0x26400
    s_barrier
    ds_read_b32 v4, v5 offset:12
    s_waitcnt lgkmcnt(0)
    v_readfirstlane_b32 s10, v4
    s_cmp_eq_u32 s10, -1
    s_cbranch_scc1 KF_done
    s_and_b32 s2, s10, 7
    s_lshl_b32 s8, s98, 3
    s_add_u32 s8, s8, s2
    s_lshl_b32 s8, s8, 10
    s_add_u32 s8, s8, 0x1500000
    s_mov_b32 s9, 0
    s_mov_b32 s100, 1
    s_mov_b32 s97, 0
    s_branch J_SLOW_claim
KF_END:
    s_endpgm
.section .rodata,"a"
.p2align 6
.amdhsa_kernel k1_kernel
  .amdhsa_next_free_vgpr 216
  .amdhsa_next_free_sgpr 102
  .amdhsa_accum_offset 216
  .amdhsa_group_segment_fixed_size 0
  .amdhsa_kernarg_size 80
  .amdhsa_user_sgpr_count 2
  .amdhsa_user_sgpr_kernarg_segment_ptr 1
  .amdhsa_system_sgpr_workgroup_id_x 1
.end_amdhsa_kernel
.p2align 6
.amdhsa_kernel kf_kernel
  .amdhsa_next_free_vgpr 256
  .amdhsa_next_free_sgpr 102
  .amdhsa_accum_offset 256
  .amdhsa_group_segment_fixed_size 0
  .amdhsa_kernarg_size 80
  .amdhsa_user_sgpr_count 2
  .amdhsa_user_sgpr_kernarg_segment_ptr 1
  .amdhsa_system_sgpr_workgroup_id_x 1
.end_amdhsa_kernel
```
